```python
import torch

def _softmax(x, axis=-1):
    return torch.softmax(x, dim=axis)
def _gelu(x):
    return torch.nn.functional.gelu(x, approximate="tanh")
def _silu(x):
    return torch.nn.functional.silu(x)
def _sigmoid(x):
    return torch.sigmoid(x)
def _layernorm(x, axis=-1, eps=1e-5):
    m = x.mean(dim=axis, keepdim=True)
    v = x.var(dim=axis, keepdim=True, unbiased=False)
    return (x - m) / torch.sqrt(v + eps)
def _scatter_add(tgt, idx, src, axis=0):
    return tgt.clone().index_add_(axis, idx, src)
def _segment_sum(src, seg, n):
    out = torch.zeros((n,) + src.shape[1:], dtype=src.dtype)
    return out.index_add_(0, seg, src)
def _pad(x, pw):
    flat = tuple(v for pair in reversed(pw) for v in pair)
    return torch.nn.functional.pad(x, flat)

kernel_name = 'parallel_sum__linear_kernel_hedgehog__dense_activation_silu__prompt'

def setup_inputs():

    _w = (lambda a: (lambda t: t.to(torch.bfloat16) if t.is_floating_point() else t)(torch.as_tensor(a)))
    def _A_setup():
        B, S, D, H = 1, 2048, 576, 32
        Dh = D // H
        return {
            "x": _w((lambda *s: torch.randn(*s, dtype=torch.bfloat16) * 0.05)(B, S, D)),
            "wqkv": _w((lambda *s: torch.randn(*s, dtype=torch.bfloat16) * 0.2)(D, 3 * D)),
            "w_phi": _w((lambda *s: torch.randn(*s, dtype=torch.bfloat16) * 0.2)(H, Dh, Dh) * (Dh ** -0.5)),
            "wo": _w((lambda *s: torch.randn(*s, dtype=torch.bfloat16) * 0.05)(D, D)),
        }
    _A_in = _A_setup()

    def _B_setup():
        B, S, D, F = 1, 2048, 576, 4608
        return {
            "x": _w((lambda *s: torch.randn(*s, dtype=torch.bfloat16) * 0.05)(B, S, D)),
            "w1": _w((lambda *s: torch.randn(*s, dtype=torch.bfloat16) * 1.6)(D, F) * (D ** -0.5)),
            "w2": _w((lambda *s: torch.randn(*s, dtype=torch.bfloat16) * 0.1)(F, D) * (F ** -0.5)),
        }
    _B_in = _B_setup()

    return {
        "A_x": _A_in["x"],
        "A_wqkv": _A_in["wqkv"],
        "A_w_phi": _A_in["w_phi"],
        "A_wo": _A_in["wo"],
        "B_x": _B_in["x"],
        "B_w1": _B_in["w1"],
        "B_w2": _B_in["w2"],
    }

def reference(A_x, A_wqkv, A_w_phi, A_wo, B_x, B_w1, B_w2):
    def _A_ref(x, wqkv, w_phi, wo):
        B, S, D = x.shape
        H = 32; Dh = D // H
        qkv = (lambda x, *d: x.permute(*d))((x @ wqkv).reshape(B, S, 3, H, Dh), 2, 0, 3, 1, 4)
        q, k, v = qkv[0], qkv[1], qkv[2]
        pq = torch.einsum("bhsd,hdf->bhsf", q, w_phi)
        pk = torch.einsum("bhsd,hdf->bhsf", k, w_phi)
        phi_q = torch.concatenate([_softmax(pq, axis=-1), _softmax(-pq, axis=-1)], axis=-1)
        phi_k = torch.concatenate([_softmax(pk, axis=-1), _softmax(-pk, axis=-1)], axis=-1)
        kv = torch.einsum("bhsf,bhsd->bhfd", phi_k, v)
        z  = torch.einsum("bhsf->bhf", phi_k)
        num = torch.einsum("bhqf,bhfd->bhqd", phi_q, kv)
        den = torch.einsum("bhqf,bhf->bhq", phi_q, z)[..., None] + 1e-6
        o = num / den
        return (lambda x, *d: x.permute(*d))(o, 0, 2, 1, 3).reshape(B, S, D) @ wo

    def _B_ref(x, w1, w2):
        h = torch.einsum("bsd,df->bsf", x, w1)
        h = _silu(h)
        out = torch.einsum("bsf,fd->bsd", h, w2)
        return out

    x = A_x
    xn = _layernorm(x, axis=-1)
    return x + _A_ref(xn, A_wqkv, A_w_phi, A_wo) + _B_ref(xn, B_w1, B_w2)
```

```asm
; @launch kernel=ln_kernel grid=(512,1,1) block=(256,1,1) lds=0
; @launch kernel=gemm1_kernel grid=(256,1,1) block=(512,1,1) lds=147456
; @launch kernel=attn_kv_kernel grid=(256,1,1) block=(256,1,1) lds=55296
; @launch kernel=attn_o_kernel grid=(256,1,1) block=(256,1,1) lds=51200
; @launch kernel=gemm2_kernel grid=(240,1,1) block=(512,1,1) lds=98304
; @launch kernel=combine_kernel grid=(256,1,1) block=(384,1,1) lds=0
.amdgcn_target "amdgcn-amd-amdhsa--gfx950"
.text
.globl ln_kernel
.p2align 8
.type ln_kernel,@function
ln_kernel:
    s_load_dwordx2 s[4:5], s[0:1], 0
    s_load_dwordx2 s[6:7], s[0:1], 72
    s_cmp_ge_u32 s2, 512
    s_cbranch_scc1 L_ln_end
    v_lshrrev_b32 v2, 6, v0
    v_and_b32 v1, 63, v0
    s_lshl_b32 s3, s2, 2
    v_add_u32 v2, s3, v2
    s_movk_i32 s3, 1152
    v_mul_lo_u32 v2, v2, s3
    s_waitcnt lgkmcnt(0)
    s_mov_b32 s8, s4
    s_mov_b32 s9, s5
    s_mov_b32 s10, 2359296
    s_mov_b32 s11, 0x00020000
    s_mov_b32 s12, s6
    s_mov_b32 s13, s7
    s_mov_b32 s14, 2359296
    s_mov_b32 s15, 0x00020000
    v_lshl_add_u32 v3, v1, 4, v2
    v_lshlrev_b32 v4, 2, v1
    v_add_u32 v4, 1024, v4
    v_add_u32 v4, v4, v2
    v_mov_b32 v12, 0
    v_cmp_gt_u32 vcc, 32, v1
    buffer_load_dwordx4 v[8:11], v3, s[8:11], 0 offen
    s_and_saveexec_b64 s[16:17], vcc
    buffer_load_dword v12, v4, s[8:11], 0 offen
    s_mov_b64 exec, s[16:17]
    s_waitcnt vmcnt(0)
    v_lshlrev_b32 v16, 16, v8
    v_and_b32 v17, 0xffff0000, v8
    v_lshlrev_b32 v18, 16, v9
    v_and_b32 v19, 0xffff0000, v9
    v_lshlrev_b32 v20, 16, v10
    v_and_b32 v21, 0xffff0000, v10
    v_lshlrev_b32 v22, 16, v11
    v_and_b32 v23, 0xffff0000, v11
    v_lshlrev_b32 v24, 16, v12
    v_and_b32 v25, 0xffff0000, v12
    v_add_f32 v26, v16, v17
    v_add_f32 v26, v26, v18
    v_add_f32 v26, v26, v19
    v_add_f32 v26, v26, v20
    v_add_f32 v26, v26, v21
    v_add_f32 v26, v26, v22
    v_add_f32 v26, v26, v23
    v_add_f32 v26, v26, v24
    v_add_f32 v26, v26, v25
    s_nop 1
    v_add_f32_dpp v26, v26, v26 row_shr:1 row_mask:0xf bank_mask:0xf bound_ctrl:0
    s_nop 1
    v_add_f32_dpp v26, v26, v26 row_shr:2 row_mask:0xf bank_mask:0xf bound_ctrl:0
    s_nop 1
    v_add_f32_dpp v26, v26, v26 row_shr:4 row_mask:0xf bank_mask:0xf bound_ctrl:0
    s_nop 1
    v_add_f32_dpp v26, v26, v26 row_shr:8 row_mask:0xf bank_mask:0xf bound_ctrl:0
    s_nop 1
    v_add_f32_dpp v26, v26, v26 row_bcast:15 row_mask:0xa bank_mask:0xf
    s_nop 1
    v_add_f32_dpp v26, v26, v26 row_bcast:31 row_mask:0xc bank_mask:0xf
    s_nop 1
    v_readlane_b32 s18, v26, 63
    s_nop 3
    v_mov_b32 v27, s18
    v_mul_f32 v27, 0x3ae38e39, v27
    v_mov_b32 v26, 0
    v_sub_f32 v28, v16, v27
    v_fmac_f32 v26, v28, v28
    v_sub_f32 v28, v17, v27
    v_fmac_f32 v26, v28, v28
    v_sub_f32 v28, v18, v27
    v_fmac_f32 v26, v28, v28
    v_sub_f32 v28, v19, v27
    v_fmac_f32 v26, v28, v28
    v_sub_f32 v28, v20, v27
    v_fmac_f32 v26, v28, v28
    v_sub_f32 v28, v21, v27
    v_fmac_f32 v26, v28, v28
    v_sub_f32 v28, v22, v27
    v_fmac_f32 v26, v28, v28
    v_sub_f32 v28, v23, v27
    v_fmac_f32 v26, v28, v28
    v_sub_f32 v28, v24, v27
    v_mul_f32 v29, v28, v28
    v_sub_f32 v28, v25, v27
    v_fmac_f32 v29, v28, v28
    v_cndmask_b32 v29, 0, v29, vcc
    v_add_f32 v26, v26, v29
    s_nop 1
    v_add_f32_dpp v26, v26, v26 row_shr:1 row_mask:0xf bank_mask:0xf bound_ctrl:0
    s_nop 1
    v_add_f32_dpp v26, v26, v26 row_shr:2 row_mask:0xf bank_mask:0xf bound_ctrl:0
    s_nop 1
    v_add_f32_dpp v26, v26, v26 row_shr:4 row_mask:0xf bank_mask:0xf bound_ctrl:0
    s_nop 1
    v_add_f32_dpp v26, v26, v26 row_shr:8 row_mask:0xf bank_mask:0xf bound_ctrl:0
    s_nop 1
    v_add_f32_dpp v26, v26, v26 row_bcast:15 row_mask:0xa bank_mask:0xf
    s_nop 1
    v_add_f32_dpp v26, v26, v26 row_bcast:31 row_mask:0xc bank_mask:0xf
    s_nop 1
    v_readlane_b32 s19, v26, 63
    s_nop 3
    v_mov_b32 v28, s19
    v_mul_f32 v28, 0x3ae38e39, v28
    v_cvt_pk_bf16_f32 v27, v27, v28
    v_and_b32 v28, 0xffff0000, v27
    v_lshlrev_b32 v27, 16, v27
    v_add_f32 v28, 0x3727c5ac, v28
    v_cvt_pk_bf16_f32 v28, v28, v28
    v_lshlrev_b32 v28, 16, v28
    v_sqrt_f32 v28, v28
    s_nop 0
    v_cvt_pk_bf16_f32 v28, v28, v28
    v_lshlrev_b32 v28, 16, v28
    v_rcp_f32 v29, v28
    s_nop 0
    v_sub_f32 v16, v16, v27
    v_sub_f32 v17, v17, v27
    v_cvt_pk_bf16_f32 v30, v16, v17
    v_lshlrev_b32 v16, 16, v30
    v_and_b32 v17, 0xffff0000, v30
    v_mul_f32 v30, v16, v29
    v_fma_f32 v31, -v30, v28, v16
    v_fma_f32 v16, v31, v29, v30
    v_mul_f32 v30, v17, v29
    v_fma_f32 v31, -v30, v28, v17
    v_fma_f32 v17, v31, v29, v30
    v_cvt_pk_bf16_f32 v8, v16, v17
    v_sub_f32 v18, v18, v27
    v_sub_f32 v19, v19, v27
    v_cvt_pk_bf16_f32 v30, v18, v19
    v_lshlrev_b32 v18, 16, v30
    v_and_b32 v19, 0xffff0000, v30
    v_mul_f32 v30, v18, v29
    v_fma_f32 v31, -v30, v28, v18
    v_fma_f32 v18, v31, v29, v30
    v_mul_f32 v30, v19, v29
    v_fma_f32 v31, -v30, v28, v19
    v_fma_f32 v19, v31, v29, v30
    v_cvt_pk_bf16_f32 v9, v18, v19
    v_sub_f32 v20, v20, v27
    v_sub_f32 v21, v21, v27
    v_cvt_pk_bf16_f32 v30, v20, v21
    v_lshlrev_b32 v20, 16, v30
    v_and_b32 v21, 0xffff0000, v30
    v_mul_f32 v30, v20, v29
    v_fma_f32 v31, -v30, v28, v20
    v_fma_f32 v20, v31, v29, v30
    v_mul_f32 v30, v21, v29
    v_fma_f32 v31, -v30, v28, v21
    v_fma_f32 v21, v31, v29, v30
    v_cvt_pk_bf16_f32 v10, v20, v21
    v_sub_f32 v22, v22, v27
    v_sub_f32 v23, v23, v27
    v_cvt_pk_bf16_f32 v30, v22, v23
    v_lshlrev_b32 v22, 16, v30
    v_and_b32 v23, 0xffff0000, v30
    v_mul_f32 v30, v22, v29
    v_fma_f32 v31, -v30, v28, v22
    v_fma_f32 v22, v31, v29, v30
    v_mul_f32 v30, v23, v29
    v_fma_f32 v31, -v30, v28, v23
    v_fma_f32 v23, v31, v29, v30
    v_cvt_pk_bf16_f32 v11, v22, v23
    v_sub_f32 v24, v24, v27
    v_sub_f32 v25, v25, v27
    v_cvt_pk_bf16_f32 v30, v24, v25
    v_lshlrev_b32 v24, 16, v30
    v_and_b32 v25, 0xffff0000, v30
    v_mul_f32 v30, v24, v29
    v_fma_f32 v31, -v30, v28, v24
    v_fma_f32 v24, v31, v29, v30
    v_mul_f32 v30, v25, v29
    v_fma_f32 v31, -v30, v28, v25
    v_fma_f32 v25, v31, v29, v30
    v_cvt_pk_bf16_f32 v12, v24, v25
    buffer_store_dwordx4 v[8:11], v3, s[12:15], 0 offen
    s_and_saveexec_b64 s[16:17], vcc
    buffer_store_dword v12, v4, s[12:15], 0 offen
    s_mov_b64 exec, s[16:17]
L_ln_end:
    s_endpgm
.globl gemm1_kernel
.p2align 8
.type gemm1_kernel,@function
gemm1_kernel:
    s_load_dwordx2 s[34:35], s[0:1], 8
    s_load_dwordx2 s[36:37], s[0:1], 40
    s_load_dwordx2 s[38:39], s[0:1], 72
    s_cmp_ge_u32 s2, 256
    s_cbranch_scc1 L_g1_end
    s_and_b32 s40, s2, 7
    s_lshr_b32 s41, s2, 3
    s_and_b32 s42, s41, 1
    s_lshl_b32 s40, s40, 1
    s_add_u32 s40, s40, s42
    s_lshr_b32 s41, s41, 1
    s_waitcnt lgkmcnt(0)
    s_mov_b32 s4, s38
    s_mov_b32 s5, s39
    s_mov_b32 s6, 2359296
    s_mov_b32 s7, 0x00020000
    s_mul_i32 s47, s40, 7
    s_sub_u32 s48, s40, 4
    s_mul_i32 s48, s48, 6
    s_cmp_lt_u32 s40, 4
    s_cselect_b32 s47, s47, s48
    s_cselect_b32 s8, s34, s36
    s_cselect_b32 s9, s35, s37
    s_mov_b32 s10, 1990656
    s_mov_b32 s33, 5308416
    s_cselect_b32 s10, s10, s33
    s_mov_b32 s11, 0x00020000
    s_mov_b32 s46, 3456
    s_mov_b32 s33, 9216
    s_cselect_b32 s46, s46, s33
    s_mov_b32 s48, 29360128
    s_mov_b32 s33, 4195456
    s_cselect_b32 s48, s48, s33
    s_mov_b32 s14, 7077888
    s_mov_b32 s33, 21232512
    s_cselect_b32 s14, s14, s33
    s_mov_b32 s50, 3456
    s_mov_b32 s33, 10368
    s_cselect_b32 s50, s50, s33
    s_mov_b32 s51, 0
    s_mov_b32 s33, 1
    s_cselect_b32 s51, s51, s33
    s_mov_b32 s15, 0x00020000
    s_add_u32 s12, s38, s48
    s_addc_u32 s13, s39, 0
    v_and_b32 v1, 63, v0
    v_lshrrev_b32 v10, 6, v0
    s_nop 0
    v_readfirstlane_b32 s30, v10
    v_lshrrev_b32 v10, 3, v1
    v_and_b32 v11, 7, v1
    v_xor_b32 v11, v11, v10
    v_lshlrev_b32 v11, 4, v11
    s_mov_b32 s31, 1152
    v_mul_lo_u32 v2, v10, s31
    v_add_u32 v2, v2, v11
    v_lshrrev_b32 v11, 4, v1
    v_and_b32 v11, 1, v11
    s_and_b32 s31, s30, 1
    s_lshl_b32 s31, s31, 1
    v_or_b32 v11, s31, v11
    v_bfe_u32 v12, v1, 1, 2
    v_xor_b32 v12, v12, v11
    v_lshlrev_b32 v12, 5, v12
    v_and_b32 v13, 1, v1
    v_lshl_add_u32 v12, v13, 4, v12
    v_mul_lo_u32 v3, v10, s46
    v_add_u32 v3, v3, v12
    v_and_b32 v10, 15, v1
    v_lshrrev_b32 v11, 4, v1
    v_and_b32 v12, 7, v10
    v_xor_b32 v12, v12, v11
    s_lshr_b32 s31, s30, 2
    s_lshl_b32 s31, s31, 13
    v_lshlrev_b32 v13, 7, v10
    v_add_u32 v13, s31, v13
    v_lshl_add_u32 v4, v12, 4, v13
    v_xor_b32 v12, 4, v12
    v_lshl_add_u32 v5, v12, 4, v13
    v_bfe_u32 v10, v1, 2, 2
    v_lshrrev_b32 v12, 1, v10
    v_and_b32 v13, 1, v11
    v_lshl_or_b32 v12, v13, 1, v12
    s_and_b32 s31, s30, 3
    v_xor_b32 v12, s31, v12
    v_lshlrev_b32 v12, 5, v12
    v_lshl_add_u32 v13, v11, 3, v10
    v_lshl_add_u32 v12, v13, 7, v12
    v_and_b32 v13, 3, v1
    v_lshl_add_u32 v12, v13, 3, v12
    v_add_u32 v6, 32768, v12
    v_add_u32 v7, 61440, v12
    v_add_u32 v8, 90112, v12
    v_add_u32 v9, 118784, v12
    s_lshl_b32 s28, s30, 10
    s_and_b32 s31, s30, 3
    s_mul_i32 s32, s31, s46
    s_lshl_b32 s32, s32, 3
    s_add_u32 s33, s30, 0
    s_lshr_b32 s33, s33, 2
    s_min_u32 s33, s33, 6
    s_lshl_b32 s20, s33, 7
    s_add_u32 s20, s20, s32
    s_lshl_b32 s24, s33, 12
    s_lshl_b32 s33, s31, 10
    s_add_u32 s24, s24, s33
    s_add_u32 s33, s30, 8
    s_lshr_b32 s33, s33, 2
    s_min_u32 s33, s33, 6
    s_lshl_b32 s21, s33, 7
    s_add_u32 s21, s21, s32
    s_lshl_b32 s25, s33, 12
    s_lshl_b32 s33, s31, 10
    s_add_u32 s25, s25, s33
    s_add_u32 s33, s30, 16
    s_lshr_b32 s33, s33, 2
    s_min_u32 s33, s33, 6
    s_lshl_b32 s22, s33, 7
    s_add_u32 s22, s22, s32
    s_lshl_b32 s26, s33, 12
    s_lshl_b32 s33, s31, 10
    s_add_u32 s26, s26, s33
    s_add_u32 s33, s30, 24
    s_lshr_b32 s33, s33, 2
    s_min_u32 s33, s33, 6
    s_lshl_b32 s23, s33, 7
    s_add_u32 s23, s23, s32
    s_lshl_b32 s27, s33, 12
    s_lshl_b32 s33, s31, 10
    s_add_u32 s27, s27, s33
    s_lshl_b32 s31, s41, 7
    s_lshl_b32 s32, s30, 3
    s_add_u32 s31, s31, s32
    s_mul_i32 s16, s31, 1152
    s_mov_b32 s29, 73728
    s_lshl_b32 s17, s47, 7
    s_lshl_b32 s18, s46, 5
    v_accvgpr_write_b32 a0, 0
    v_accvgpr_write_b32 a1, 0
    v_accvgpr_write_b32 a2, 0
    v_accvgpr_write_b32 a3, 0
    v_accvgpr_write_b32 a4, 0
    v_accvgpr_write_b32 a5, 0
    v_accvgpr_write_b32 a6, 0
    v_accvgpr_write_b32 a7, 0
    v_accvgpr_write_b32 a8, 0
    v_accvgpr_write_b32 a9, 0
    v_accvgpr_write_b32 a10, 0
    v_accvgpr_write_b32 a11, 0
    v_accvgpr_write_b32 a12, 0
    v_accvgpr_write_b32 a13, 0
    v_accvgpr_write_b32 a14, 0
    v_accvgpr_write_b32 a15, 0
    v_accvgpr_write_b32 a16, 0
    v_accvgpr_write_b32 a17, 0
    v_accvgpr_write_b32 a18, 0
    v_accvgpr_write_b32 a19, 0
    v_accvgpr_write_b32 a20, 0
    v_accvgpr_write_b32 a21, 0
    v_accvgpr_write_b32 a22, 0
    v_accvgpr_write_b32 a23, 0
    v_accvgpr_write_b32 a24, 0
    v_accvgpr_write_b32 a25, 0
    v_accvgpr_write_b32 a26, 0
    v_accvgpr_write_b32 a27, 0
    v_accvgpr_write_b32 a28, 0
    v_accvgpr_write_b32 a29, 0
    v_accvgpr_write_b32 a30, 0
    v_accvgpr_write_b32 a31, 0
    v_accvgpr_write_b32 a32, 0
    v_accvgpr_write_b32 a33, 0
    v_accvgpr_write_b32 a34, 0
    v_accvgpr_write_b32 a35, 0
    v_accvgpr_write_b32 a36, 0
    v_accvgpr_write_b32 a37, 0
    v_accvgpr_write_b32 a38, 0
    v_accvgpr_write_b32 a39, 0
    v_accvgpr_write_b32 a40, 0
    v_accvgpr_write_b32 a41, 0
    v_accvgpr_write_b32 a42, 0
    v_accvgpr_write_b32 a43, 0
    v_accvgpr_write_b32 a44, 0
    v_accvgpr_write_b32 a45, 0
    v_accvgpr_write_b32 a46, 0
    v_accvgpr_write_b32 a47, 0
    v_accvgpr_write_b32 a48, 0
    v_accvgpr_write_b32 a49, 0
    v_accvgpr_write_b32 a50, 0
    v_accvgpr_write_b32 a51, 0
    v_accvgpr_write_b32 a52, 0
    v_accvgpr_write_b32 a53, 0
    v_accvgpr_write_b32 a54, 0
    v_accvgpr_write_b32 a55, 0
    v_accvgpr_write_b32 a56, 0
    v_accvgpr_write_b32 a57, 0
    v_accvgpr_write_b32 a58, 0
    v_accvgpr_write_b32 a59, 0
    v_accvgpr_write_b32 a60, 0
    v_accvgpr_write_b32 a61, 0
    v_accvgpr_write_b32 a62, 0
    v_accvgpr_write_b32 a63, 0
    v_accvgpr_write_b32 a64, 0
    v_accvgpr_write_b32 a65, 0
    v_accvgpr_write_b32 a66, 0
    v_accvgpr_write_b32 a67, 0
    v_accvgpr_write_b32 a68, 0
    v_accvgpr_write_b32 a69, 0
    v_accvgpr_write_b32 a70, 0
    v_accvgpr_write_b32 a71, 0
    v_accvgpr_write_b32 a72, 0
    v_accvgpr_write_b32 a73, 0
    v_accvgpr_write_b32 a74, 0
    v_accvgpr_write_b32 a75, 0
    v_accvgpr_write_b32 a76, 0
    v_accvgpr_write_b32 a77, 0
    v_accvgpr_write_b32 a78, 0
    v_accvgpr_write_b32 a79, 0
    v_accvgpr_write_b32 a80, 0
    v_accvgpr_write_b32 a81, 0
    v_accvgpr_write_b32 a82, 0
    v_accvgpr_write_b32 a83, 0
    v_accvgpr_write_b32 a84, 0
    v_accvgpr_write_b32 a85, 0
    v_accvgpr_write_b32 a86, 0
    v_accvgpr_write_b32 a87, 0
    v_accvgpr_write_b32 a88, 0
    v_accvgpr_write_b32 a89, 0
    v_accvgpr_write_b32 a90, 0
    v_accvgpr_write_b32 a91, 0
    v_accvgpr_write_b32 a92, 0
    v_accvgpr_write_b32 a93, 0
    v_accvgpr_write_b32 a94, 0
    v_accvgpr_write_b32 a95, 0
    v_accvgpr_write_b32 a96, 0
    v_accvgpr_write_b32 a97, 0
    v_accvgpr_write_b32 a98, 0
    v_accvgpr_write_b32 a99, 0
    v_accvgpr_write_b32 a100, 0
    v_accvgpr_write_b32 a101, 0
    v_accvgpr_write_b32 a102, 0
    v_accvgpr_write_b32 a103, 0
    v_accvgpr_write_b32 a104, 0
    v_accvgpr_write_b32 a105, 0
    v_accvgpr_write_b32 a106, 0
    v_accvgpr_write_b32 a107, 0
    v_accvgpr_write_b32 a108, 0
    v_accvgpr_write_b32 a109, 0
    v_accvgpr_write_b32 a110, 0
    v_accvgpr_write_b32 a111, 0
    s_cmp_lt_u32 s40, 3
    s_cbranch_scc0 L_g1_np6
    s_add_u32 m0, s24, 32768
    s_add_u32 s19, s17, s20
    buffer_load_dwordx4 v3, s[8:11], s19 offen lds
    s_add_u32 m0, s25, 32768
    s_add_u32 s19, s17, s21
    buffer_load_dwordx4 v3, s[8:11], s19 offen lds
    s_add_u32 m0, s26, 32768
    s_add_u32 s19, s17, s22
    buffer_load_dwordx4 v3, s[8:11], s19 offen lds
    s_add_u32 m0, s27, 32768
    s_add_u32 s19, s17, s23
    buffer_load_dwordx4 v3, s[8:11], s19 offen lds
    s_add_u32 s17, s17, s18
    s_add_u32 m0, s28, 0
    s_add_u32 s19, s16, 0
    buffer_load_dwordx4 v2, s[4:7], s19 offen lds
    s_add_u32 m0, s28, 8192
    s_add_u32 s19, s16, 0
    s_add_u32 s19, s19, s29
    buffer_load_dwordx4 v2, s[4:7], s19 offen lds
    s_add_u32 m0, s24, 61440
    s_add_u32 s19, s17, s20
    buffer_load_dwordx4 v3, s[8:11], s19 offen lds
    s_add_u32 m0, s25, 61440
    s_add_u32 s19, s17, s21
    buffer_load_dwordx4 v3, s[8:11], s19 offen lds
    s_add_u32 m0, s26, 61440
    s_add_u32 s19, s17, s22
    buffer_load_dwordx4 v3, s[8:11], s19 offen lds
    s_add_u32 m0, s27, 61440
    s_add_u32 s19, s17, s23
    buffer_load_dwordx4 v3, s[8:11], s19 offen lds
    s_add_u32 s17, s17, s18
    s_add_u32 m0, s28, 16384
    s_add_u32 s19, s16, 128
    buffer_load_dwordx4 v2, s[4:7], s19 offen lds
    s_add_u32 m0, s28, 24576
    s_add_u32 s19, s16, 128
    s_add_u32 s19, s19, s29
    buffer_load_dwordx4 v2, s[4:7], s19 offen lds
    s_add_u32 m0, s24, 90112
    s_add_u32 s19, s17, s20
    buffer_load_dwordx4 v3, s[8:11], s19 offen lds
    s_add_u32 m0, s25, 90112
    s_add_u32 s19, s17, s21
    buffer_load_dwordx4 v3, s[8:11], s19 offen lds
    s_add_u32 m0, s26, 90112
    s_add_u32 s19, s17, s22
    buffer_load_dwordx4 v3, s[8:11], s19 offen lds
    s_add_u32 m0, s27, 90112
    s_add_u32 s19, s17, s23
    buffer_load_dwordx4 v3, s[8:11], s19 offen lds
    s_add_u32 s17, s17, s18
    s_add_u32 m0, s24, 118784
    s_add_u32 s19, s17, s20
    buffer_load_dwordx4 v3, s[8:11], s19 offen lds
    s_add_u32 m0, s25, 118784
    s_add_u32 s19, s17, s21
    buffer_load_dwordx4 v3, s[8:11], s19 offen lds
    s_add_u32 m0, s26, 118784
    s_add_u32 s19, s17, s22
    buffer_load_dwordx4 v3, s[8:11], s19 offen lds
    s_add_u32 m0, s27, 118784
    s_add_u32 s19, s17, s23
    buffer_load_dwordx4 v3, s[8:11], s19 offen lds
    s_add_u32 s17, s17, s18
    s_waitcnt vmcnt(10)
    s_barrier
    ds_read_b128 v[16:19], v4 offset:0
    ds_read_b128 v[20:23], v4 offset:2048
    ds_read_b128 v[24:27], v4 offset:4096
    ds_read_b128 v[28:31], v4 offset:6144
    ds_read_b64_tr_b16 v[32:33], v6 offset:0
    ds_read_b64_tr_b16 v[34:35], v6 offset:512
    ds_read_b64_tr_b16 v[36:37], v6 offset:4096
    ds_read_b64_tr_b16 v[38:39], v6 offset:4608
    ds_read_b64_tr_b16 v[40:41], v6 offset:8192
    ds_read_b64_tr_b16 v[42:43], v6 offset:8704
    ds_read_b64_tr_b16 v[44:45], v6 offset:12288
    ds_read_b64_tr_b16 v[46:47], v6 offset:12800
    ds_read_b64_tr_b16 v[48:49], v6 offset:16384
    ds_read_b64_tr_b16 v[50:51], v6 offset:16896
    ds_read_b64_tr_b16 v[52:53], v6 offset:20480
    ds_read_b64_tr_b16 v[54:55], v6 offset:20992
    ds_read_b64_tr_b16 v[56:57], v6 offset:24576
    ds_read_b64_tr_b16 v[58:59], v6 offset:25088
    s_waitcnt lgkmcnt(0)
    s_barrier
    v_mfma_f32_16x16x32_bf16 a[0:3], v[32:35], v[16:19], a[0:3]
    v_mfma_f32_16x16x32_bf16 a[4:7], v[32:35], v[20:23], a[4:7]
    ds_read_b128 v[60:63], v5 offset:0
    v_mfma_f32_16x16x32_bf16 a[8:11], v[32:35], v[24:27], a[8:11]
    ds_read_b128 v[64:67], v5 offset:2048
    v_mfma_f32_16x16x32_bf16 a[12:15], v[32:35], v[28:31], a[12:15]
    ds_read_b128 v[68:71], v5 offset:4096
    v_mfma_f32_16x16x32_bf16 a[16:19], v[36:39], v[16:19], a[16:19]
    v_mfma_f32_16x16x32_bf16 a[20:23], v[36:39], v[20:23], a[20:23]
    ds_read_b128 v[72:75], v5 offset:6144
    v_mfma_f32_16x16x32_bf16 a[24:27], v[36:39], v[24:27], a[24:27]
    ds_read_b64_tr_b16 v[76:77], v7 offset:0
    v_mfma_f32_16x16x32_bf16 a[28:31], v[36:39], v[28:31], a[28:31]
    ds_read_b64_tr_b16 v[78:79], v7 offset:512
    v_mfma_f32_16x16x32_bf16 a[32:35], v[40:43], v[16:19], a[32:35]
    ds_read_b64_tr_b16 v[80:81], v7 offset:4096
    v_mfma_f32_16x16x32_bf16 a[36:39], v[40:43], v[20:23], a[36:39]
    v_mfma_f32_16x16x32_bf16 a[40:43], v[40:43], v[24:27], a[40:43]
    ds_read_b64_tr_b16 v[82:83], v7 offset:4608
    v_mfma_f32_16x16x32_bf16 a[44:47], v[40:43], v[28:31], a[44:47]
    ds_read_b64_tr_b16 v[84:85], v7 offset:8192
    v_mfma_f32_16x16x32_bf16 a[48:51], v[44:47], v[16:19], a[48:51]
    ds_read_b64_tr_b16 v[86:87], v7 offset:8704
    v_mfma_f32_16x16x32_bf16 a[52:55], v[44:47], v[20:23], a[52:55]
    ds_read_b64_tr_b16 v[88:89], v7 offset:12288
    v_mfma_f32_16x16x32_bf16 a[56:59], v[44:47], v[24:27], a[56:59]
    v_mfma_f32_16x16x32_bf16 a[60:63], v[44:47], v[28:31], a[60:63]
    ds_read_b64_tr_b16 v[90:91], v7 offset:12800
    v_mfma_f32_16x16x32_bf16 a[64:67], v[48:51], v[16:19], a[64:67]
    ds_read_b64_tr_b16 v[92:93], v7 offset:16384
    v_mfma_f32_16x16x32_bf16 a[68:71], v[48:51], v[20:23], a[68:71]
    ds_read_b64_tr_b16 v[94:95], v7 offset:16896
    v_mfma_f32_16x16x32_bf16 a[72:75], v[48:51], v[24:27], a[72:75]
    v_mfma_f32_16x16x32_bf16 a[76:79], v[48:51], v[28:31], a[76:79]
    ds_read_b64_tr_b16 v[96:97], v7 offset:20480
    v_mfma_f32_16x16x32_bf16 a[80:83], v[52:55], v[16:19], a[80:83]
    ds_read_b64_tr_b16 v[98:99], v7 offset:20992
    v_mfma_f32_16x16x32_bf16 a[84:87], v[52:55], v[20:23], a[84:87]
    ds_read_b64_tr_b16 v[100:101], v7 offset:24576
    v_mfma_f32_16x16x32_bf16 a[88:91], v[52:55], v[24:27], a[88:91]
    ds_read_b64_tr_b16 v[102:103], v7 offset:25088
    v_mfma_f32_16x16x32_bf16 a[92:95], v[52:55], v[28:31], a[92:95]
    v_mfma_f32_16x16x32_bf16 a[96:99], v[56:59], v[16:19], a[96:99]
    s_add_u32 m0, s24, 32768
    s_add_u32 s19, s17, s20
    buffer_load_dwordx4 v3, s[8:11], s19 offen lds
    v_mfma_f32_16x16x32_bf16 a[100:103], v[56:59], v[20:23], a[100:103]
    s_add_u32 m0, s25, 32768
    s_add_u32 s19, s17, s21
    buffer_load_dwordx4 v3, s[8:11], s19 offen lds
    v_mfma_f32_16x16x32_bf16 a[104:107], v[56:59], v[24:27], a[104:107]
    s_add_u32 m0, s26, 32768
    s_add_u32 s19, s17, s22
    buffer_load_dwordx4 v3, s[8:11], s19 offen lds
    v_mfma_f32_16x16x32_bf16 a[108:111], v[56:59], v[28:31], a[108:111]
    s_add_u32 m0, s27, 32768
    s_add_u32 s19, s17, s23
    buffer_load_dwordx4 v3, s[8:11], s19 offen lds
    s_add_u32 s17, s17, s18
    s_waitcnt vmcnt(8) lgkmcnt(0)
    s_barrier
    v_mfma_f32_16x16x32_bf16 a[0:3], v[76:79], v[60:63], a[0:3]
    v_mfma_f32_16x16x32_bf16 a[4:7], v[76:79], v[64:67], a[4:7]
    ds_read_b128 v[16:19], v4 offset:16384
    v_mfma_f32_16x16x32_bf16 a[8:11], v[76:79], v[68:71], a[8:11]
    ds_read_b128 v[20:23], v4 offset:18432
    v_mfma_f32_16x16x32_bf16 a[12:15], v[76:79], v[72:75], a[12:15]
    ds_read_b128 v[24:27], v4 offset:20480
    v_mfma_f32_16x16x32_bf16 a[16:19], v[80:83], v[60:63], a[16:19]
    ds_read_b128 v[28:31], v4 offset:22528
    v_mfma_f32_16x16x32_bf16 a[20:23], v[80:83], v[64:67], a[20:23]
    ds_read_b64_tr_b16 v[32:33], v8 offset:0
    v_mfma_f32_16x16x32_bf16 a[24:27], v[80:83], v[68:71], a[24:27]
    ds_read_b64_tr_b16 v[34:35], v8 offset:512
    v_mfma_f32_16x16x32_bf16 a[28:31], v[80:83], v[72:75], a[28:31]
    v_mfma_f32_16x16x32_bf16 a[32:35], v[84:87], v[60:63], a[32:35]
    ds_read_b64_tr_b16 v[36:37], v8 offset:4096
    v_mfma_f32_16x16x32_bf16 a[36:39], v[84:87], v[64:67], a[36:39]
    ds_read_b64_tr_b16 v[38:39], v8 offset:4608
    v_mfma_f32_16x16x32_bf16 a[40:43], v[84:87], v[68:71], a[40:43]
    ds_read_b64_tr_b16 v[40:41], v8 offset:8192
    v_mfma_f32_16x16x32_bf16 a[44:47], v[84:87], v[72:75], a[44:47]
    ds_read_b64_tr_b16 v[42:43], v8 offset:8704
    v_mfma_f32_16x16x32_bf16 a[48:51], v[88:91], v[60:63], a[48:51]
    ds_read_b64_tr_b16 v[44:45], v8 offset:12288
    v_mfma_f32_16x16x32_bf16 a[52:55], v[88:91], v[64:67], a[52:55]
    ds_read_b64_tr_b16 v[46:47], v8 offset:12800
    v_mfma_f32_16x16x32_bf16 a[56:59], v[88:91], v[68:71], a[56:59]
    v_mfma_f32_16x16x32_bf16 a[60:63], v[88:91], v[72:75], a[60:63]
    ds_read_b64_tr_b16 v[48:49], v8 offset:16384
    v_mfma_f32_16x16x32_bf16 a[64:67], v[92:95], v[60:63], a[64:67]
    ds_read_b64_tr_b16 v[50:51], v8 offset:16896
    v_mfma_f32_16x16x32_bf16 a[68:71], v[92:95], v[64:67], a[68:71]
    ds_read_b64_tr_b16 v[52:53], v8 offset:20480
    v_mfma_f32_16x16x32_bf16 a[72:75], v[92:95], v[68:71], a[72:75]
    ds_read_b64_tr_b16 v[54:55], v8 offset:20992
    v_mfma_f32_16x16x32_bf16 a[76:79], v[92:95], v[72:75], a[76:79]
    ds_read_b64_tr_b16 v[56:57], v8 offset:24576
    v_mfma_f32_16x16x32_bf16 a[80:83], v[96:99], v[60:63], a[80:83]
    ds_read_b64_tr_b16 v[58:59], v8 offset:25088
    v_mfma_f32_16x16x32_bf16 a[84:87], v[96:99], v[64:67], a[84:87]
    v_mfma_f32_16x16x32_bf16 a[88:91], v[96:99], v[68:71], a[88:91]
    s_add_u32 m0, s24, 61440
    s_add_u32 s19, s17, s20
    buffer_load_dwordx4 v3, s[8:11], s19 offen lds
    v_mfma_f32_16x16x32_bf16 a[92:95], v[96:99], v[72:75], a[92:95]
    s_add_u32 m0, s25, 61440
    s_add_u32 s19, s17, s21
    buffer_load_dwordx4 v3, s[8:11], s19 offen lds
    v_mfma_f32_16x16x32_bf16 a[96:99], v[100:103], v[60:63], a[96:99]
    s_add_u32 m0, s26, 61440
    s_add_u32 s19, s17, s22
    buffer_load_dwordx4 v3, s[8:11], s19 offen lds
    v_mfma_f32_16x16x32_bf16 a[100:103], v[100:103], v[64:67], a[100:103]
    s_add_u32 m0, s27, 61440
    s_add_u32 s19, s17, s23
    buffer_load_dwordx4 v3, s[8:11], s19 offen lds
    s_add_u32 s17, s17, s18
    v_mfma_f32_16x16x32_bf16 a[104:107], v[100:103], v[68:71], a[104:107]
    s_add_u32 m0, s28, 0
    s_add_u32 s19, s16, 256
    buffer_load_dwordx4 v2, s[4:7], s19 offen lds
    v_mfma_f32_16x16x32_bf16 a[108:111], v[100:103], v[72:75], a[108:111]
    s_add_u32 m0, s28, 8192
    s_add_u32 s19, s16, 256
    s_add_u32 s19, s19, s29
    buffer_load_dwordx4 v2, s[4:7], s19 offen lds
    s_waitcnt vmcnt(10) lgkmcnt(0)
    s_barrier
    v_mfma_f32_16x16x32_bf16 a[0:3], v[32:35], v[16:19], a[0:3]
    v_mfma_f32_16x16x32_bf16 a[4:7], v[32:35], v[20:23], a[4:7]
    ds_read_b128 v[60:63], v5 offset:16384
    v_mfma_f32_16x16x32_bf16 a[8:11], v[32:35], v[24:27], a[8:11]
    ds_read_b128 v[64:67], v5 offset:18432
    v_mfma_f32_16x16x32_bf16 a[12:15], v[32:35], v[28:31], a[12:15]
    ds_read_b128 v[68:71], v5 offset:20480
    v_mfma_f32_16x16x32_bf16 a[16:19], v[36:39], v[16:19], a[16:19]
    v_mfma_f32_16x16x32_bf16 a[20:23], v[36:39], v[20:23], a[20:23]
    ds_read_b128 v[72:75], v5 offset:22528
    v_mfma_f32_16x16x32_bf16 a[24:27], v[36:39], v[24:27], a[24:27]
    ds_read_b64_tr_b16 v[76:77], v9 offset:0
    v_mfma_f32_16x16x32_bf16 a[28:31], v[36:39], v[28:31], a[28:31]
    ds_read_b64_tr_b16 v[78:79], v9 offset:512
    v_mfma_f32_16x16x32_bf16 a[32:35], v[40:43], v[16:19], a[32:35]
    ds_read_b64_tr_b16 v[80:81], v9 offset:4096
    v_mfma_f32_16x16x32_bf16 a[36:39], v[40:43], v[20:23], a[36:39]
    v_mfma_f32_16x16x32_bf16 a[40:43], v[40:43], v[24:27], a[40:43]
    ds_read_b64_tr_b16 v[82:83], v9 offset:4608
    v_mfma_f32_16x16x32_bf16 a[44:47], v[40:43], v[28:31], a[44:47]
    ds_read_b64_tr_b16 v[84:85], v9 offset:8192
    v_mfma_f32_16x16x32_bf16 a[48:51], v[44:47], v[16:19], a[48:51]
    ds_read_b64_tr_b16 v[86:87], v9 offset:8704
    v_mfma_f32_16x16x32_bf16 a[52:55], v[44:47], v[20:23], a[52:55]
    ds_read_b64_tr_b16 v[88:89], v9 offset:12288
    v_mfma_f32_16x16x32_bf16 a[56:59], v[44:47], v[24:27], a[56:59]
    v_mfma_f32_16x16x32_bf16 a[60:63], v[44:47], v[28:31], a[60:63]
    ds_read_b64_tr_b16 v[90:91], v9 offset:12800
    v_mfma_f32_16x16x32_bf16 a[64:67], v[48:51], v[16:19], a[64:67]
    ds_read_b64_tr_b16 v[92:93], v9 offset:16384
    v_mfma_f32_16x16x32_bf16 a[68:71], v[48:51], v[20:23], a[68:71]
    ds_read_b64_tr_b16 v[94:95], v9 offset:16896
    v_mfma_f32_16x16x32_bf16 a[72:75], v[48:51], v[24:27], a[72:75]
    v_mfma_f32_16x16x32_bf16 a[76:79], v[48:51], v[28:31], a[76:79]
    ds_read_b64_tr_b16 v[96:97], v9 offset:20480
    v_mfma_f32_16x16x32_bf16 a[80:83], v[52:55], v[16:19], a[80:83]
    ds_read_b64_tr_b16 v[98:99], v9 offset:20992
    v_mfma_f32_16x16x32_bf16 a[84:87], v[52:55], v[20:23], a[84:87]
    ds_read_b64_tr_b16 v[100:101], v9 offset:24576
    v_mfma_f32_16x16x32_bf16 a[88:91], v[52:55], v[24:27], a[88:91]
    ds_read_b64_tr_b16 v[102:103], v9 offset:25088
    v_mfma_f32_16x16x32_bf16 a[92:95], v[52:55], v[28:31], a[92:95]
    v_mfma_f32_16x16x32_bf16 a[96:99], v[56:59], v[16:19], a[96:99]
    s_add_u32 m0, s24, 90112
    s_add_u32 s19, s17, s20
    buffer_load_dwordx4 v3, s[8:11], s19 offen lds
    v_mfma_f32_16x16x32_bf16 a[100:103], v[56:59], v[20:23], a[100:103]
    s_add_u32 m0, s25, 90112
    s_add_u32 s19, s17, s21
    buffer_load_dwordx4 v3, s[8:11], s19 offen lds
    v_mfma_f32_16x16x32_bf16 a[104:107], v[56:59], v[24:27], a[104:107]
    s_add_u32 m0, s26, 90112
    s_add_u32 s19, s17, s22
    buffer_load_dwordx4 v3, s[8:11], s19 offen lds
    v_mfma_f32_16x16x32_bf16 a[108:111], v[56:59], v[28:31], a[108:111]
    s_add_u32 m0, s27, 90112
    s_add_u32 s19, s17, s23
    buffer_load_dwordx4 v3, s[8:11], s19 offen lds
    s_add_u32 s17, s17, s18
    s_waitcnt vmcnt(4) lgkmcnt(0)
    s_barrier
    v_mfma_f32_16x16x32_bf16 a[0:3], v[76:79], v[60:63], a[0:3]
    v_mfma_f32_16x16x32_bf16 a[4:7], v[76:79], v[64:67], a[4:7]
    ds_read_b128 v[16:19], v4 offset:0
    v_mfma_f32_16x16x32_bf16 a[8:11], v[76:79], v[68:71], a[8:11]
    ds_read_b128 v[20:23], v4 offset:2048
    v_mfma_f32_16x16x32_bf16 a[12:15], v[76:79], v[72:75], a[12:15]
    ds_read_b128 v[24:27], v4 offset:4096
    v_mfma_f32_16x16x32_bf16 a[16:19], v[80:83], v[60:63], a[16:19]
    ds_read_b128 v[28:31], v4 offset:6144
    v_mfma_f32_16x16x32_bf16 a[20:23], v[80:83], v[64:67], a[20:23]
    ds_read_b64_tr_b16 v[32:33], v6 offset:0
    v_mfma_f32_16x16x32_bf16 a[24:27], v[80:83], v[68:71], a[24:27]
    ds_read_b64_tr_b16 v[34:35], v6 offset:512
    v_mfma_f32_16x16x32_bf16 a[28:31], v[80:83], v[72:75], a[28:31]
    v_mfma_f32_16x16x32_bf16 a[32:35], v[84:87], v[60:63], a[32:35]
    ds_read_b64_tr_b16 v[36:37], v6 offset:4096
    v_mfma_f32_16x16x32_bf16 a[36:39], v[84:87], v[64:67], a[36:39]
    ds_read_b64_tr_b16 v[38:39], v6 offset:4608
    v_mfma_f32_16x16x32_bf16 a[40:43], v[84:87], v[68:71], a[40:43]
    ds_read_b64_tr_b16 v[40:41], v6 offset:8192
    v_mfma_f32_16x16x32_bf16 a[44:47], v[84:87], v[72:75], a[44:47]
    ds_read_b64_tr_b16 v[42:43], v6 offset:8704
    v_mfma_f32_16x16x32_bf16 a[48:51], v[88:91], v[60:63], a[48:51]
    ds_read_b64_tr_b16 v[44:45], v6 offset:12288
    v_mfma_f32_16x16x32_bf16 a[52:55], v[88:91], v[64:67], a[52:55]
    ds_read_b64_tr_b16 v[46:47], v6 offset:12800
    v_mfma_f32_16x16x32_bf16 a[56:59], v[88:91], v[68:71], a[56:59]
    v_mfma_f32_16x16x32_bf16 a[60:63], v[88:91], v[72:75], a[60:63]
    ds_read_b64_tr_b16 v[48:49], v6 offset:16384
    v_mfma_f32_16x16x32_bf16 a[64:67], v[92:95], v[60:63], a[64:67]
    ds_read_b64_tr_b16 v[50:51], v6 offset:16896
    v_mfma_f32_16x16x32_bf16 a[68:71], v[92:95], v[64:67], a[68:71]
    ds_read_b64_tr_b16 v[52:53], v6 offset:20480
    v_mfma_f32_16x16x32_bf16 a[72:75], v[92:95], v[68:71], a[72:75]
    ds_read_b64_tr_b16 v[54:55], v6 offset:20992
    v_mfma_f32_16x16x32_bf16 a[76:79], v[92:95], v[72:75], a[76:79]
    ds_read_b64_tr_b16 v[56:57], v6 offset:24576
    v_mfma_f32_16x16x32_bf16 a[80:83], v[96:99], v[60:63], a[80:83]
    ds_read_b64_tr_b16 v[58:59], v6 offset:25088
    v_mfma_f32_16x16x32_bf16 a[84:87], v[96:99], v[64:67], a[84:87]
    v_mfma_f32_16x16x32_bf16 a[88:91], v[96:99], v[68:71], a[88:91]
    s_add_u32 m0, s24, 118784
    s_add_u32 s19, s17, s20
    buffer_load_dwordx4 v3, s[8:11], s19 offen lds
    v_mfma_f32_16x16x32_bf16 a[92:95], v[96:99], v[72:75], a[92:95]
    s_add_u32 m0, s25, 118784
    s_add_u32 s19, s17, s21
    buffer_load_dwordx4 v3, s[8:11], s19 offen lds
    v_mfma_f32_16x16x32_bf16 a[96:99], v[100:103], v[60:63], a[96:99]
    s_add_u32 m0, s26, 118784
    s_add_u32 s19, s17, s22
    buffer_load_dwordx4 v3, s[8:11], s19 offen lds
    v_mfma_f32_16x16x32_bf16 a[100:103], v[100:103], v[64:67], a[100:103]
    s_add_u32 m0, s27, 118784
    s_add_u32 s19, s17, s23
    buffer_load_dwordx4 v3, s[8:11], s19 offen lds
    s_add_u32 s17, s17, s18
    v_mfma_f32_16x16x32_bf16 a[104:107], v[100:103], v[68:71], a[104:107]
    s_add_u32 m0, s28, 16384
    s_add_u32 s19, s16, 384
    buffer_load_dwordx4 v2, s[4:7], s19 offen lds
    v_mfma_f32_16x16x32_bf16 a[108:111], v[100:103], v[72:75], a[108:111]
    s_add_u32 m0, s28, 24576
    s_add_u32 s19, s16, 384
    s_add_u32 s19, s19, s29
    buffer_load_dwordx4 v2, s[4:7], s19 offen lds
    s_waitcnt vmcnt(10) lgkmcnt(0)
    s_barrier
    v_mfma_f32_16x16x32_bf16 a[0:3], v[32:35], v[16:19], a[0:3]
    v_mfma_f32_16x16x32_bf16 a[4:7], v[32:35], v[20:23], a[4:7]
    ds_read_b128 v[60:63], v5 offset:0
    v_mfma_f32_16x16x32_bf16 a[8:11], v[32:35], v[24:27], a[8:11]
    ds_read_b128 v[64:67], v5 offset:2048
    v_mfma_f32_16x16x32_bf16 a[12:15], v[32:35], v[28:31], a[12:15]
    ds_read_b128 v[68:71], v5 offset:4096
    v_mfma_f32_16x16x32_bf16 a[16:19], v[36:39], v[16:19], a[16:19]
    v_mfma_f32_16x16x32_bf16 a[20:23], v[36:39], v[20:23], a[20:23]
    ds_read_b128 v[72:75], v5 offset:6144
    v_mfma_f32_16x16x32_bf16 a[24:27], v[36:39], v[24:27], a[24:27]
    ds_read_b64_tr_b16 v[76:77], v7 offset:0
    v_mfma_f32_16x16x32_bf16 a[28:31], v[36:39], v[28:31], a[28:31]
    ds_read_b64_tr_b16 v[78:79], v7 offset:512
    v_mfma_f32_16x16x32_bf16 a[32:35], v[40:43], v[16:19], a[32:35]
    ds_read_b64_tr_b16 v[80:81], v7 offset:4096
    v_mfma_f32_16x16x32_bf16 a[36:39], v[40:43], v[20:23], a[36:39]
    v_mfma_f32_16x16x32_bf16 a[40:43], v[40:43], v[24:27], a[40:43]
    ds_read_b64_tr_b16 v[82:83], v7 offset:4608
    v_mfma_f32_16x16x32_bf16 a[44:47], v[40:43], v[28:31], a[44:47]
    ds_read_b64_tr_b16 v[84:85], v7 offset:8192
    v_mfma_f32_16x16x32_bf16 a[48:51], v[44:47], v[16:19], a[48:51]
    ds_read_b64_tr_b16 v[86:87], v7 offset:8704
    v_mfma_f32_16x16x32_bf16 a[52:55], v[44:47], v[20:23], a[52:55]
    ds_read_b64_tr_b16 v[88:89], v7 offset:12288
    v_mfma_f32_16x16x32_bf16 a[56:59], v[44:47], v[24:27], a[56:59]
    v_mfma_f32_16x16x32_bf16 a[60:63], v[44:47], v[28:31], a[60:63]
    ds_read_b64_tr_b16 v[90:91], v7 offset:12800
    v_mfma_f32_16x16x32_bf16 a[64:67], v[48:51], v[16:19], a[64:67]
    ds_read_b64_tr_b16 v[92:93], v7 offset:16384
    v_mfma_f32_16x16x32_bf16 a[68:71], v[48:51], v[20:23], a[68:71]
    ds_read_b64_tr_b16 v[94:95], v7 offset:16896
    v_mfma_f32_16x16x32_bf16 a[72:75], v[48:51], v[24:27], a[72:75]
    v_mfma_f32_16x16x32_bf16 a[76:79], v[48:51], v[28:31], a[76:79]
    ds_read_b64_tr_b16 v[96:97], v7 offset:20480
    v_mfma_f32_16x16x32_bf16 a[80:83], v[52:55], v[16:19], a[80:83]
    ds_read_b64_tr_b16 v[98:99], v7 offset:20992
    v_mfma_f32_16x16x32_bf16 a[84:87], v[52:55], v[20:23], a[84:87]
    ds_read_b64_tr_b16 v[100:101], v7 offset:24576
    v_mfma_f32_16x16x32_bf16 a[88:91], v[52:55], v[24:27], a[88:91]
    ds_read_b64_tr_b16 v[102:103], v7 offset:25088
    v_mfma_f32_16x16x32_bf16 a[92:95], v[52:55], v[28:31], a[92:95]
    v_mfma_f32_16x16x32_bf16 a[96:99], v[56:59], v[16:19], a[96:99]
    s_add_u32 m0, s24, 32768
    s_add_u32 s19, s17, s20
    buffer_load_dwordx4 v3, s[8:11], s19 offen lds
    v_mfma_f32_16x16x32_bf16 a[100:103], v[56:59], v[20:23], a[100:103]
    s_add_u32 m0, s25, 32768
    s_add_u32 s19, s17, s21
    buffer_load_dwordx4 v3, s[8:11], s19 offen lds
    v_mfma_f32_16x16x32_bf16 a[104:107], v[56:59], v[24:27], a[104:107]
    s_add_u32 m0, s26, 32768
    s_add_u32 s19, s17, s22
    buffer_load_dwordx4 v3, s[8:11], s19 offen lds
    v_mfma_f32_16x16x32_bf16 a[108:111], v[56:59], v[28:31], a[108:111]
    s_add_u32 m0, s27, 32768
    s_add_u32 s19, s17, s23
    buffer_load_dwordx4 v3, s[8:11], s19 offen lds
    s_add_u32 s17, s17, s18
    s_waitcnt vmcnt(4) lgkmcnt(0)
    s_barrier
    v_mfma_f32_16x16x32_bf16 a[0:3], v[76:79], v[60:63], a[0:3]
    v_mfma_f32_16x16x32_bf16 a[4:7], v[76:79], v[64:67], a[4:7]
    ds_read_b128 v[16:19], v4 offset:16384
    v_mfma_f32_16x16x32_bf16 a[8:11], v[76:79], v[68:71], a[8:11]
    ds_read_b128 v[20:23], v4 offset:18432
    v_mfma_f32_16x16x32_bf16 a[12:15], v[76:79], v[72:75], a[12:15]
    ds_read_b128 v[24:27], v4 offset:20480
    v_mfma_f32_16x16x32_bf16 a[16:19], v[80:83], v[60:63], a[16:19]
    ds_read_b128 v[28:31], v4 offset:22528
    v_mfma_f32_16x16x32_bf16 a[20:23], v[80:83], v[64:67], a[20:23]
    ds_read_b64_tr_b16 v[32:33], v8 offset:0
    v_mfma_f32_16x16x32_bf16 a[24:27], v[80:83], v[68:71], a[24:27]
    ds_read_b64_tr_b16 v[34:35], v8 offset:512
    v_mfma_f32_16x16x32_bf16 a[28:31], v[80:83], v[72:75], a[28:31]
    v_mfma_f32_16x16x32_bf16 a[32:35], v[84:87], v[60:63], a[32:35]
    ds_read_b64_tr_b16 v[36:37], v8 offset:4096
    v_mfma_f32_16x16x32_bf16 a[36:39], v[84:87], v[64:67], a[36:39]
    ds_read_b64_tr_b16 v[38:39], v8 offset:4608
    v_mfma_f32_16x16x32_bf16 a[40:43], v[84:87], v[68:71], a[40:43]
    ds_read_b64_tr_b16 v[40:41], v8 offset:8192
    v_mfma_f32_16x16x32_bf16 a[44:47], v[84:87], v[72:75], a[44:47]
    ds_read_b64_tr_b16 v[42:43], v8 offset:8704
    v_mfma_f32_16x16x32_bf16 a[48:51], v[88:91], v[60:63], a[48:51]
    ds_read_b64_tr_b16 v[44:45], v8 offset:12288
    v_mfma_f32_16x16x32_bf16 a[52:55], v[88:91], v[64:67], a[52:55]
    ds_read_b64_tr_b16 v[46:47], v8 offset:12800
    v_mfma_f32_16x16x32_bf16 a[56:59], v[88:91], v[68:71], a[56:59]
    v_mfma_f32_16x16x32_bf16 a[60:63], v[88:91], v[72:75], a[60:63]
    ds_read_b64_tr_b16 v[48:49], v8 offset:16384
    v_mfma_f32_16x16x32_bf16 a[64:67], v[92:95], v[60:63], a[64:67]
    ds_read_b64_tr_b16 v[50:51], v8 offset:16896
    v_mfma_f32_16x16x32_bf16 a[68:71], v[92:95], v[64:67], a[68:71]
    ds_read_b64_tr_b16 v[52:53], v8 offset:20480
    v_mfma_f32_16x16x32_bf16 a[72:75], v[92:95], v[68:71], a[72:75]
    ds_read_b64_tr_b16 v[54:55], v8 offset:20992
    v_mfma_f32_16x16x32_bf16 a[76:79], v[92:95], v[72:75], a[76:79]
    ds_read_b64_tr_b16 v[56:57], v8 offset:24576
    v_mfma_f32_16x16x32_bf16 a[80:83], v[96:99], v[60:63], a[80:83]
    ds_read_b64_tr_b16 v[58:59], v8 offset:25088
    v_mfma_f32_16x16x32_bf16 a[84:87], v[96:99], v[64:67], a[84:87]
    v_mfma_f32_16x16x32_bf16 a[88:91], v[96:99], v[68:71], a[88:91]
    s_add_u32 m0, s24, 61440
    s_add_u32 s19, s17, s20
    buffer_load_dwordx4 v3, s[8:11], s19 offen lds
    v_mfma_f32_16x16x32_bf16 a[92:95], v[96:99], v[72:75], a[92:95]
    s_add_u32 m0, s25, 61440
    s_add_u32 s19, s17, s21
    buffer_load_dwordx4 v3, s[8:11], s19 offen lds
    v_mfma_f32_16x16x32_bf16 a[96:99], v[100:103], v[60:63], a[96:99]
    s_add_u32 m0, s26, 61440
    s_add_u32 s19, s17, s22
    buffer_load_dwordx4 v3, s[8:11], s19 offen lds
    v_mfma_f32_16x16x32_bf16 a[100:103], v[100:103], v[64:67], a[100:103]
    s_add_u32 m0, s27, 61440
    s_add_u32 s19, s17, s23
    buffer_load_dwordx4 v3, s[8:11], s19 offen lds
    s_add_u32 s17, s17, s18
    v_mfma_f32_16x16x32_bf16 a[104:107], v[100:103], v[68:71], a[104:107]
    s_add_u32 m0, s28, 0
    s_add_u32 s19, s16, 512
    buffer_load_dwordx4 v2, s[4:7], s19 offen lds
    v_mfma_f32_16x16x32_bf16 a[108:111], v[100:103], v[72:75], a[108:111]
    s_add_u32 m0, s28, 8192
    s_add_u32 s19, s16, 512
    s_add_u32 s19, s19, s29
    buffer_load_dwordx4 v2, s[4:7], s19 offen lds
    s_waitcnt vmcnt(10) lgkmcnt(0)
    s_barrier
    v_mfma_f32_16x16x32_bf16 a[0:3], v[32:35], v[16:19], a[0:3]
    v_mfma_f32_16x16x32_bf16 a[4:7], v[32:35], v[20:23], a[4:7]
    ds_read_b128 v[60:63], v5 offset:16384
    v_mfma_f32_16x16x32_bf16 a[8:11], v[32:35], v[24:27], a[8:11]
    ds_read_b128 v[64:67], v5 offset:18432
    v_mfma_f32_16x16x32_bf16 a[12:15], v[32:35], v[28:31], a[12:15]
    ds_read_b128 v[68:71], v5 offset:20480
    v_mfma_f32_16x16x32_bf16 a[16:19], v[36:39], v[16:19], a[16:19]
    v_mfma_f32_16x16x32_bf16 a[20:23], v[36:39], v[20:23], a[20:23]
    ds_read_b128 v[72:75], v5 offset:22528
    v_mfma_f32_16x16x32_bf16 a[24:27], v[36:39], v[24:27], a[24:27]
    ds_read_b64_tr_b16 v[76:77], v9 offset:0
    v_mfma_f32_16x16x32_bf16 a[28:31], v[36:39], v[28:31], a[28:31]
    ds_read_b64_tr_b16 v[78:79], v9 offset:512
    v_mfma_f32_16x16x32_bf16 a[32:35], v[40:43], v[16:19], a[32:35]
    ds_read_b64_tr_b16 v[80:81], v9 offset:4096
    v_mfma_f32_16x16x32_bf16 a[36:39], v[40:43], v[20:23], a[36:39]
    v_mfma_f32_16x16x32_bf16 a[40:43], v[40:43], v[24:27], a[40:43]
    ds_read_b64_tr_b16 v[82:83], v9 offset:4608
    v_mfma_f32_16x16x32_bf16 a[44:47], v[40:43], v[28:31], a[44:47]
    ds_read_b64_tr_b16 v[84:85], v9 offset:8192
    v_mfma_f32_16x16x32_bf16 a[48:51], v[44:47], v[16:19], a[48:51]
    ds_read_b64_tr_b16 v[86:87], v9 offset:8704
    v_mfma_f32_16x16x32_bf16 a[52:55], v[44:47], v[20:23], a[52:55]
    ds_read_b64_tr_b16 v[88:89], v9 offset:12288
    v_mfma_f32_16x16x32_bf16 a[56:59], v[44:47], v[24:27], a[56:59]
    v_mfma_f32_16x16x32_bf16 a[60:63], v[44:47], v[28:31], a[60:63]
    ds_read_b64_tr_b16 v[90:91], v9 offset:12800
    v_mfma_f32_16x16x32_bf16 a[64:67], v[48:51], v[16:19], a[64:67]
    ds_read_b64_tr_b16 v[92:93], v9 offset:16384
    v_mfma_f32_16x16x32_bf16 a[68:71], v[48:51], v[20:23], a[68:71]
    ds_read_b64_tr_b16 v[94:95], v9 offset:16896
    v_mfma_f32_16x16x32_bf16 a[72:75], v[48:51], v[24:27], a[72:75]
    v_mfma_f32_16x16x32_bf16 a[76:79], v[48:51], v[28:31], a[76:79]
    ds_read_b64_tr_b16 v[96:97], v9 offset:20480
    v_mfma_f32_16x16x32_bf16 a[80:83], v[52:55], v[16:19], a[80:83]
    ds_read_b64_tr_b16 v[98:99], v9 offset:20992
    v_mfma_f32_16x16x32_bf16 a[84:87], v[52:55], v[20:23], a[84:87]
    ds_read_b64_tr_b16 v[100:101], v9 offset:24576
    v_mfma_f32_16x16x32_bf16 a[88:91], v[52:55], v[24:27], a[88:91]
    ds_read_b64_tr_b16 v[102:103], v9 offset:25088
    v_mfma_f32_16x16x32_bf16 a[92:95], v[52:55], v[28:31], a[92:95]
    v_mfma_f32_16x16x32_bf16 a[96:99], v[56:59], v[16:19], a[96:99]
    s_add_u32 m0, s24, 90112
    s_add_u32 s19, s17, s20
    buffer_load_dwordx4 v3, s[8:11], s19 offen lds
    v_mfma_f32_16x16x32_bf16 a[100:103], v[56:59], v[20:23], a[100:103]
    s_add_u32 m0, s25, 90112
    s_add_u32 s19, s17, s21
    buffer_load_dwordx4 v3, s[8:11], s19 offen lds
    v_mfma_f32_16x16x32_bf16 a[104:107], v[56:59], v[24:27], a[104:107]
    s_add_u32 m0, s26, 90112
    s_add_u32 s19, s17, s22
    buffer_load_dwordx4 v3, s[8:11], s19 offen lds
    v_mfma_f32_16x16x32_bf16 a[108:111], v[56:59], v[28:31], a[108:111]
    s_add_u32 m0, s27, 90112
    s_add_u32 s19, s17, s23
    buffer_load_dwordx4 v3, s[8:11], s19 offen lds
    s_add_u32 s17, s17, s18
    s_waitcnt vmcnt(4) lgkmcnt(0)
    s_barrier
    v_mfma_f32_16x16x32_bf16 a[0:3], v[76:79], v[60:63], a[0:3]
    v_mfma_f32_16x16x32_bf16 a[4:7], v[76:79], v[64:67], a[4:7]
    ds_read_b128 v[16:19], v4 offset:0
    v_mfma_f32_16x16x32_bf16 a[8:11], v[76:79], v[68:71], a[8:11]
    ds_read_b128 v[20:23], v4 offset:2048
    v_mfma_f32_16x16x32_bf16 a[12:15], v[76:79], v[72:75], a[12:15]
    ds_read_b128 v[24:27], v4 offset:4096
    v_mfma_f32_16x16x32_bf16 a[16:19], v[80:83], v[60:63], a[16:19]
    ds_read_b128 v[28:31], v4 offset:6144
    v_mfma_f32_16x16x32_bf16 a[20:23], v[80:83], v[64:67], a[20:23]
    ds_read_b64_tr_b16 v[32:33], v6 offset:0
    v_mfma_f32_16x16x32_bf16 a[24:27], v[80:83], v[68:71], a[24:27]
    ds_read_b64_tr_b16 v[34:35], v6 offset:512
    v_mfma_f32_16x16x32_bf16 a[28:31], v[80:83], v[72:75], a[28:31]
    v_mfma_f32_16x16x32_bf16 a[32:35], v[84:87], v[60:63], a[32:35]
    ds_read_b64_tr_b16 v[36:37], v6 offset:4096
    v_mfma_f32_16x16x32_bf16 a[36:39], v[84:87], v[64:67], a[36:39]
    ds_read_b64_tr_b16 v[38:39], v6 offset:4608
    v_mfma_f32_16x16x32_bf16 a[40:43], v[84:87], v[68:71], a[40:43]
    ds_read_b64_tr_b16 v[40:41], v6 offset:8192
    v_mfma_f32_16x16x32_bf16 a[44:47], v[84:87], v[72:75], a[44:47]
    ds_read_b64_tr_b16 v[42:43], v6 offset:8704
    v_mfma_f32_16x16x32_bf16 a[48:51], v[88:91], v[60:63], a[48:51]
    ds_read_b64_tr_b16 v[44:45], v6 offset:12288
    v_mfma_f32_16x16x32_bf16 a[52:55], v[88:91], v[64:67], a[52:55]
    ds_read_b64_tr_b16 v[46:47], v6 offset:12800
    v_mfma_f32_16x16x32_bf16 a[56:59], v[88:91], v[68:71], a[56:59]
    v_mfma_f32_16x16x32_bf16 a[60:63], v[88:91], v[72:75], a[60:63]
    ds_read_b64_tr_b16 v[48:49], v6 offset:16384
    v_mfma_f32_16x16x32_bf16 a[64:67], v[92:95], v[60:63], a[64:67]
    ds_read_b64_tr_b16 v[50:51], v6 offset:16896
    v_mfma_f32_16x16x32_bf16 a[68:71], v[92:95], v[64:67], a[68:71]
    ds_read_b64_tr_b16 v[52:53], v6 offset:20480
    v_mfma_f32_16x16x32_bf16 a[72:75], v[92:95], v[68:71], a[72:75]
    ds_read_b64_tr_b16 v[54:55], v6 offset:20992
    v_mfma_f32_16x16x32_bf16 a[76:79], v[92:95], v[72:75], a[76:79]
    ds_read_b64_tr_b16 v[56:57], v6 offset:24576
    v_mfma_f32_16x16x32_bf16 a[80:83], v[96:99], v[60:63], a[80:83]
    ds_read_b64_tr_b16 v[58:59], v6 offset:25088
    v_mfma_f32_16x16x32_bf16 a[84:87], v[96:99], v[64:67], a[84:87]
    v_mfma_f32_16x16x32_bf16 a[88:91], v[96:99], v[68:71], a[88:91]
    s_add_u32 m0, s24, 118784
    s_add_u32 s19, s17, s20
    buffer_load_dwordx4 v3, s[8:11], s19 offen lds
    v_mfma_f32_16x16x32_bf16 a[92:95], v[96:99], v[72:75], a[92:95]
    s_add_u32 m0, s25, 118784
    s_add_u32 s19, s17, s21
    buffer_load_dwordx4 v3, s[8:11], s19 offen lds
    v_mfma_f32_16x16x32_bf16 a[96:99], v[100:103], v[60:63], a[96:99]
    s_add_u32 m0, s26, 118784
    s_add_u32 s19, s17, s22
    buffer_load_dwordx4 v3, s[8:11], s19 offen lds
    v_mfma_f32_16x16x32_bf16 a[100:103], v[100:103], v[64:67], a[100:103]
    s_add_u32 m0, s27, 118784
    s_add_u32 s19, s17, s23
    buffer_load_dwordx4 v3, s[8:11], s19 offen lds
    s_add_u32 s17, s17, s18
    v_mfma_f32_16x16x32_bf16 a[104:107], v[100:103], v[68:71], a[104:107]
    s_add_u32 m0, s28, 16384
    s_add_u32 s19, s16, 640
    buffer_load_dwordx4 v2, s[4:7], s19 offen lds
    v_mfma_f32_16x16x32_bf16 a[108:111], v[100:103], v[72:75], a[108:111]
    s_add_u32 m0, s28, 24576
    s_add_u32 s19, s16, 640
    s_add_u32 s19, s19, s29
    buffer_load_dwordx4 v2, s[4:7], s19 offen lds
    s_waitcnt vmcnt(10) lgkmcnt(0)
    s_barrier
    v_mfma_f32_16x16x32_bf16 a[0:3], v[32:35], v[16:19], a[0:3]
    v_mfma_f32_16x16x32_bf16 a[4:7], v[32:35], v[20:23], a[4:7]
    ds_read_b128 v[60:63], v5 offset:0
    v_mfma_f32_16x16x32_bf16 a[8:11], v[32:35], v[24:27], a[8:11]
    ds_read_b128 v[64:67], v5 offset:2048
    v_mfma_f32_16x16x32_bf16 a[12:15], v[32:35], v[28:31], a[12:15]
    ds_read_b128 v[68:71], v5 offset:4096
    v_mfma_f32_16x16x32_bf16 a[16:19], v[36:39], v[16:19], a[16:19]
    v_mfma_f32_16x16x32_bf16 a[20:23], v[36:39], v[20:23], a[20:23]
    ds_read_b128 v[72:75], v5 offset:6144
    v_mfma_f32_16x16x32_bf16 a[24:27], v[36:39], v[24:27], a[24:27]
    ds_read_b64_tr_b16 v[76:77], v7 offset:0
    v_mfma_f32_16x16x32_bf16 a[28:31], v[36:39], v[28:31], a[28:31]
    ds_read_b64_tr_b16 v[78:79], v7 offset:512
    v_mfma_f32_16x16x32_bf16 a[32:35], v[40:43], v[16:19], a[32:35]
    ds_read_b64_tr_b16 v[80:81], v7 offset:4096
    v_mfma_f32_16x16x32_bf16 a[36:39], v[40:43], v[20:23], a[36:39]
    v_mfma_f32_16x16x32_bf16 a[40:43], v[40:43], v[24:27], a[40:43]
    ds_read_b64_tr_b16 v[82:83], v7 offset:4608
    v_mfma_f32_16x16x32_bf16 a[44:47], v[40:43], v[28:31], a[44:47]
    ds_read_b64_tr_b16 v[84:85], v7 offset:8192
    v_mfma_f32_16x16x32_bf16 a[48:51], v[44:47], v[16:19], a[48:51]
    ds_read_b64_tr_b16 v[86:87], v7 offset:8704
    v_mfma_f32_16x16x32_bf16 a[52:55], v[44:47], v[20:23], a[52:55]
    ds_read_b64_tr_b16 v[88:89], v7 offset:12288
    v_mfma_f32_16x16x32_bf16 a[56:59], v[44:47], v[24:27], a[56:59]
    v_mfma_f32_16x16x32_bf16 a[60:63], v[44:47], v[28:31], a[60:63]
    ds_read_b64_tr_b16 v[90:91], v7 offset:12800
    v_mfma_f32_16x16x32_bf16 a[64:67], v[48:51], v[16:19], a[64:67]
    ds_read_b64_tr_b16 v[92:93], v7 offset:16384
    v_mfma_f32_16x16x32_bf16 a[68:71], v[48:51], v[20:23], a[68:71]
    ds_read_b64_tr_b16 v[94:95], v7 offset:16896
    v_mfma_f32_16x16x32_bf16 a[72:75], v[48:51], v[24:27], a[72:75]
    v_mfma_f32_16x16x32_bf16 a[76:79], v[48:51], v[28:31], a[76:79]
    ds_read_b64_tr_b16 v[96:97], v7 offset:20480
    v_mfma_f32_16x16x32_bf16 a[80:83], v[52:55], v[16:19], a[80:83]
    ds_read_b64_tr_b16 v[98:99], v7 offset:20992
    v_mfma_f32_16x16x32_bf16 a[84:87], v[52:55], v[20:23], a[84:87]
    ds_read_b64_tr_b16 v[100:101], v7 offset:24576
    v_mfma_f32_16x16x32_bf16 a[88:91], v[52:55], v[24:27], a[88:91]
    ds_read_b64_tr_b16 v[102:103], v7 offset:25088
    v_mfma_f32_16x16x32_bf16 a[92:95], v[52:55], v[28:31], a[92:95]
    v_mfma_f32_16x16x32_bf16 a[96:99], v[56:59], v[16:19], a[96:99]
    s_add_u32 m0, s24, 32768
    s_add_u32 s19, s17, s20
    buffer_load_dwordx4 v3, s[8:11], s19 offen lds
    v_mfma_f32_16x16x32_bf16 a[100:103], v[56:59], v[20:23], a[100:103]
    s_add_u32 m0, s25, 32768
    s_add_u32 s19, s17, s21
    buffer_load_dwordx4 v3, s[8:11], s19 offen lds
    v_mfma_f32_16x16x32_bf16 a[104:107], v[56:59], v[24:27], a[104:107]
    s_add_u32 m0, s26, 32768
    s_add_u32 s19, s17, s22
    buffer_load_dwordx4 v3, s[8:11], s19 offen lds
    v_mfma_f32_16x16x32_bf16 a[108:111], v[56:59], v[28:31], a[108:111]
    s_add_u32 m0, s27, 32768
    s_add_u32 s19, s17, s23
    buffer_load_dwordx4 v3, s[8:11], s19 offen lds
    s_add_u32 s17, s17, s18
    s_waitcnt vmcnt(4) lgkmcnt(0)
    s_barrier
    v_mfma_f32_16x16x32_bf16 a[0:3], v[76:79], v[60:63], a[0:3]
    v_mfma_f32_16x16x32_bf16 a[4:7], v[76:79], v[64:67], a[4:7]
    ds_read_b128 v[16:19], v4 offset:16384
    v_mfma_f32_16x16x32_bf16 a[8:11], v[76:79], v[68:71], a[8:11]
    ds_read_b128 v[20:23], v4 offset:18432
    v_mfma_f32_16x16x32_bf16 a[12:15], v[76:79], v[72:75], a[12:15]
    ds_read_b128 v[24:27], v4 offset:20480
    v_mfma_f32_16x16x32_bf16 a[16:19], v[80:83], v[60:63], a[16:19]
    ds_read_b128 v[28:31], v4 offset:22528
    v_mfma_f32_16x16x32_bf16 a[20:23], v[80:83], v[64:67], a[20:23]
    ds_read_b64_tr_b16 v[32:33], v8 offset:0
    v_mfma_f32_16x16x32_bf16 a[24:27], v[80:83], v[68:71], a[24:27]
    ds_read_b64_tr_b16 v[34:35], v8 offset:512
    v_mfma_f32_16x16x32_bf16 a[28:31], v[80:83], v[72:75], a[28:31]
    v_mfma_f32_16x16x32_bf16 a[32:35], v[84:87], v[60:63], a[32:35]
    ds_read_b64_tr_b16 v[36:37], v8 offset:4096
    v_mfma_f32_16x16x32_bf16 a[36:39], v[84:87], v[64:67], a[36:39]
    ds_read_b64_tr_b16 v[38:39], v8 offset:4608
    v_mfma_f32_16x16x32_bf16 a[40:43], v[84:87], v[68:71], a[40:43]
    ds_read_b64_tr_b16 v[40:41], v8 offset:8192
    v_mfma_f32_16x16x32_bf16 a[44:47], v[84:87], v[72:75], a[44:47]
    ds_read_b64_tr_b16 v[42:43], v8 offset:8704
    v_mfma_f32_16x16x32_bf16 a[48:51], v[88:91], v[60:63], a[48:51]
    ds_read_b64_tr_b16 v[44:45], v8 offset:12288
    v_mfma_f32_16x16x32_bf16 a[52:55], v[88:91], v[64:67], a[52:55]
    ds_read_b64_tr_b16 v[46:47], v8 offset:12800
    v_mfma_f32_16x16x32_bf16 a[56:59], v[88:91], v[68:71], a[56:59]
    v_mfma_f32_16x16x32_bf16 a[60:63], v[88:91], v[72:75], a[60:63]
    ds_read_b64_tr_b16 v[48:49], v8 offset:16384
    v_mfma_f32_16x16x32_bf16 a[64:67], v[92:95], v[60:63], a[64:67]
    ds_read_b64_tr_b16 v[50:51], v8 offset:16896
    v_mfma_f32_16x16x32_bf16 a[68:71], v[92:95], v[64:67], a[68:71]
    ds_read_b64_tr_b16 v[52:53], v8 offset:20480
    v_mfma_f32_16x16x32_bf16 a[72:75], v[92:95], v[68:71], a[72:75]
    ds_read_b64_tr_b16 v[54:55], v8 offset:20992
    v_mfma_f32_16x16x32_bf16 a[76:79], v[92:95], v[72:75], a[76:79]
    ds_read_b64_tr_b16 v[56:57], v8 offset:24576
    v_mfma_f32_16x16x32_bf16 a[80:83], v[96:99], v[60:63], a[80:83]
    ds_read_b64_tr_b16 v[58:59], v8 offset:25088
    v_mfma_f32_16x16x32_bf16 a[84:87], v[96:99], v[64:67], a[84:87]
    v_mfma_f32_16x16x32_bf16 a[88:91], v[96:99], v[68:71], a[88:91]
    s_add_u32 m0, s24, 61440
    s_add_u32 s19, s17, s20
    buffer_load_dwordx4 v3, s[8:11], s19 offen lds
    v_mfma_f32_16x16x32_bf16 a[92:95], v[96:99], v[72:75], a[92:95]
    s_add_u32 m0, s25, 61440
    s_add_u32 s19, s17, s21
    buffer_load_dwordx4 v3, s[8:11], s19 offen lds
    v_mfma_f32_16x16x32_bf16 a[96:99], v[100:103], v[60:63], a[96:99]
    s_add_u32 m0, s26, 61440
    s_add_u32 s19, s17, s22
    buffer_load_dwordx4 v3, s[8:11], s19 offen lds
    v_mfma_f32_16x16x32_bf16 a[100:103], v[100:103], v[64:67], a[100:103]
    s_add_u32 m0, s27, 61440
    s_add_u32 s19, s17, s23
    buffer_load_dwordx4 v3, s[8:11], s19 offen lds
    s_add_u32 s17, s17, s18
    v_mfma_f32_16x16x32_bf16 a[104:107], v[100:103], v[68:71], a[104:107]
    s_add_u32 m0, s28, 0
    s_add_u32 s19, s16, 768
    buffer_load_dwordx4 v2, s[4:7], s19 offen lds
    v_mfma_f32_16x16x32_bf16 a[108:111], v[100:103], v[72:75], a[108:111]
    s_add_u32 m0, s28, 8192
    s_add_u32 s19, s16, 768
    s_add_u32 s19, s19, s29
    buffer_load_dwordx4 v2, s[4:7], s19 offen lds
    s_waitcnt vmcnt(10) lgkmcnt(0)
    s_barrier
    v_mfma_f32_16x16x32_bf16 a[0:3], v[32:35], v[16:19], a[0:3]
    v_mfma_f32_16x16x32_bf16 a[4:7], v[32:35], v[20:23], a[4:7]
    ds_read_b128 v[60:63], v5 offset:16384
    v_mfma_f32_16x16x32_bf16 a[8:11], v[32:35], v[24:27], a[8:11]
    ds_read_b128 v[64:67], v5 offset:18432
    v_mfma_f32_16x16x32_bf16 a[12:15], v[32:35], v[28:31], a[12:15]
    ds_read_b128 v[68:71], v5 offset:20480
    v_mfma_f32_16x16x32_bf16 a[16:19], v[36:39], v[16:19], a[16:19]
    v_mfma_f32_16x16x32_bf16 a[20:23], v[36:39], v[20:23], a[20:23]
    ds_read_b128 v[72:75], v5 offset:22528
    v_mfma_f32_16x16x32_bf16 a[24:27], v[36:39], v[24:27], a[24:27]
    ds_read_b64_tr_b16 v[76:77], v9 offset:0
    v_mfma_f32_16x16x32_bf16 a[28:31], v[36:39], v[28:31], a[28:31]
    ds_read_b64_tr_b16 v[78:79], v9 offset:512
    v_mfma_f32_16x16x32_bf16 a[32:35], v[40:43], v[16:19], a[32:35]
    ds_read_b64_tr_b16 v[80:81], v9 offset:4096
    v_mfma_f32_16x16x32_bf16 a[36:39], v[40:43], v[20:23], a[36:39]
    v_mfma_f32_16x16x32_bf16 a[40:43], v[40:43], v[24:27], a[40:43]
    ds_read_b64_tr_b16 v[82:83], v9 offset:4608
    v_mfma_f32_16x16x32_bf16 a[44:47], v[40:43], v[28:31], a[44:47]
    ds_read_b64_tr_b16 v[84:85], v9 offset:8192
    v_mfma_f32_16x16x32_bf16 a[48:51], v[44:47], v[16:19], a[48:51]
    ds_read_b64_tr_b16 v[86:87], v9 offset:8704
    v_mfma_f32_16x16x32_bf16 a[52:55], v[44:47], v[20:23], a[52:55]
    ds_read_b64_tr_b16 v[88:89], v9 offset:12288
    v_mfma_f32_16x16x32_bf16 a[56:59], v[44:47], v[24:27], a[56:59]
    v_mfma_f32_16x16x32_bf16 a[60:63], v[44:47], v[28:31], a[60:63]
    ds_read_b64_tr_b16 v[90:91], v9 offset:12800
    v_mfma_f32_16x16x32_bf16 a[64:67], v[48:51], v[16:19], a[64:67]
    ds_read_b64_tr_b16 v[92:93], v9 offset:16384
    v_mfma_f32_16x16x32_bf16 a[68:71], v[48:51], v[20:23], a[68:71]
    ds_read_b64_tr_b16 v[94:95], v9 offset:16896
    v_mfma_f32_16x16x32_bf16 a[72:75], v[48:51], v[24:27], a[72:75]
    v_mfma_f32_16x16x32_bf16 a[76:79], v[48:51], v[28:31], a[76:79]
    ds_read_b64_tr_b16 v[96:97], v9 offset:20480
    v_mfma_f32_16x16x32_bf16 a[80:83], v[52:55], v[16:19], a[80:83]
    ds_read_b64_tr_b16 v[98:99], v9 offset:20992
    v_mfma_f32_16x16x32_bf16 a[84:87], v[52:55], v[20:23], a[84:87]
    ds_read_b64_tr_b16 v[100:101], v9 offset:24576
    v_mfma_f32_16x16x32_bf16 a[88:91], v[52:55], v[24:27], a[88:91]
    ds_read_b64_tr_b16 v[102:103], v9 offset:25088
    v_mfma_f32_16x16x32_bf16 a[92:95], v[52:55], v[28:31], a[92:95]
    v_mfma_f32_16x16x32_bf16 a[96:99], v[56:59], v[16:19], a[96:99]
    s_add_u32 m0, s24, 90112
    s_add_u32 s19, s17, s20
    buffer_load_dwordx4 v3, s[8:11], s19 offen lds
    v_mfma_f32_16x16x32_bf16 a[100:103], v[56:59], v[20:23], a[100:103]
    s_add_u32 m0, s25, 90112
    s_add_u32 s19, s17, s21
    buffer_load_dwordx4 v3, s[8:11], s19 offen lds
    v_mfma_f32_16x16x32_bf16 a[104:107], v[56:59], v[24:27], a[104:107]
    s_add_u32 m0, s26, 90112
    s_add_u32 s19, s17, s22
    buffer_load_dwordx4 v3, s[8:11], s19 offen lds
    v_mfma_f32_16x16x32_bf16 a[108:111], v[56:59], v[28:31], a[108:111]
    s_add_u32 m0, s27, 90112
    s_add_u32 s19, s17, s23
    buffer_load_dwordx4 v3, s[8:11], s19 offen lds
    s_add_u32 s17, s17, s18
    s_waitcnt vmcnt(4) lgkmcnt(0)
    s_barrier
    v_mfma_f32_16x16x32_bf16 a[0:3], v[76:79], v[60:63], a[0:3]
    v_mfma_f32_16x16x32_bf16 a[4:7], v[76:79], v[64:67], a[4:7]
    ds_read_b128 v[16:19], v4 offset:0
    v_mfma_f32_16x16x32_bf16 a[8:11], v[76:79], v[68:71], a[8:11]
    ds_read_b128 v[20:23], v4 offset:2048
    v_mfma_f32_16x16x32_bf16 a[12:15], v[76:79], v[72:75], a[12:15]
    ds_read_b128 v[24:27], v4 offset:4096
    v_mfma_f32_16x16x32_bf16 a[16:19], v[80:83], v[60:63], a[16:19]
    ds_read_b128 v[28:31], v4 offset:6144
    v_mfma_f32_16x16x32_bf16 a[20:23], v[80:83], v[64:67], a[20:23]
    ds_read_b64_tr_b16 v[32:33], v6 offset:0
    v_mfma_f32_16x16x32_bf16 a[24:27], v[80:83], v[68:71], a[24:27]
    ds_read_b64_tr_b16 v[34:35], v6 offset:512
    v_mfma_f32_16x16x32_bf16 a[28:31], v[80:83], v[72:75], a[28:31]
    v_mfma_f32_16x16x32_bf16 a[32:35], v[84:87], v[60:63], a[32:35]
    ds_read_b64_tr_b16 v[36:37], v6 offset:4096
    v_mfma_f32_16x16x32_bf16 a[36:39], v[84:87], v[64:67], a[36:39]
    ds_read_b64_tr_b16 v[38:39], v6 offset:4608
    v_mfma_f32_16x16x32_bf16 a[40:43], v[84:87], v[68:71], a[40:43]
    ds_read_b64_tr_b16 v[40:41], v6 offset:8192
    v_mfma_f32_16x16x32_bf16 a[44:47], v[84:87], v[72:75], a[44:47]
    ds_read_b64_tr_b16 v[42:43], v6 offset:8704
    v_mfma_f32_16x16x32_bf16 a[48:51], v[88:91], v[60:63], a[48:51]
    ds_read_b64_tr_b16 v[44:45], v6 offset:12288
    v_mfma_f32_16x16x32_bf16 a[52:55], v[88:91], v[64:67], a[52:55]
    ds_read_b64_tr_b16 v[46:47], v6 offset:12800
    v_mfma_f32_16x16x32_bf16 a[56:59], v[88:91], v[68:71], a[56:59]
    v_mfma_f32_16x16x32_bf16 a[60:63], v[88:91], v[72:75], a[60:63]
    ds_read_b64_tr_b16 v[48:49], v6 offset:16384
    v_mfma_f32_16x16x32_bf16 a[64:67], v[92:95], v[60:63], a[64:67]
    ds_read_b64_tr_b16 v[50:51], v6 offset:16896
    v_mfma_f32_16x16x32_bf16 a[68:71], v[92:95], v[64:67], a[68:71]
    ds_read_b64_tr_b16 v[52:53], v6 offset:20480
    v_mfma_f32_16x16x32_bf16 a[72:75], v[92:95], v[68:71], a[72:75]
    ds_read_b64_tr_b16 v[54:55], v6 offset:20992
    v_mfma_f32_16x16x32_bf16 a[76:79], v[92:95], v[72:75], a[76:79]
    ds_read_b64_tr_b16 v[56:57], v6 offset:24576
    v_mfma_f32_16x16x32_bf16 a[80:83], v[96:99], v[60:63], a[80:83]
    ds_read_b64_tr_b16 v[58:59], v6 offset:25088
    v_mfma_f32_16x16x32_bf16 a[84:87], v[96:99], v[64:67], a[84:87]
    v_mfma_f32_16x16x32_bf16 a[88:91], v[96:99], v[68:71], a[88:91]
    s_add_u32 m0, s24, 118784
    s_add_u32 s19, s17, s20
    buffer_load_dwordx4 v3, s[8:11], s19 offen lds
    v_mfma_f32_16x16x32_bf16 a[92:95], v[96:99], v[72:75], a[92:95]
    s_add_u32 m0, s25, 118784
    s_add_u32 s19, s17, s21
    buffer_load_dwordx4 v3, s[8:11], s19 offen lds
    v_mfma_f32_16x16x32_bf16 a[96:99], v[100:103], v[60:63], a[96:99]
    s_add_u32 m0, s26, 118784
    s_add_u32 s19, s17, s22
    buffer_load_dwordx4 v3, s[8:11], s19 offen lds
    v_mfma_f32_16x16x32_bf16 a[100:103], v[100:103], v[64:67], a[100:103]
    s_add_u32 m0, s27, 118784
    s_add_u32 s19, s17, s23
    buffer_load_dwordx4 v3, s[8:11], s19 offen lds
    s_add_u32 s17, s17, s18
    v_mfma_f32_16x16x32_bf16 a[104:107], v[100:103], v[68:71], a[104:107]
    s_add_u32 m0, s28, 16384
    s_add_u32 s19, s16, 896
    buffer_load_dwordx4 v2, s[4:7], s19 offen lds
    v_mfma_f32_16x16x32_bf16 a[108:111], v[100:103], v[72:75], a[108:111]
    s_add_u32 m0, s28, 24576
    s_add_u32 s19, s16, 896
    s_add_u32 s19, s19, s29
    buffer_load_dwordx4 v2, s[4:7], s19 offen lds
    s_waitcnt vmcnt(10) lgkmcnt(0)
    s_barrier
    v_mfma_f32_16x16x32_bf16 a[0:3], v[32:35], v[16:19], a[0:3]
    v_mfma_f32_16x16x32_bf16 a[4:7], v[32:35], v[20:23], a[4:7]
    ds_read_b128 v[60:63], v5 offset:0
    v_mfma_f32_16x16x32_bf16 a[8:11], v[32:35], v[24:27], a[8:11]
    ds_read_b128 v[64:67], v5 offset:2048
    v_mfma_f32_16x16x32_bf16 a[12:15], v[32:35], v[28:31], a[12:15]
    ds_read_b128 v[68:71], v5 offset:4096
    v_mfma_f32_16x16x32_bf16 a[16:19], v[36:39], v[16:19], a[16:19]
    v_mfma_f32_16x16x32_bf16 a[20:23], v[36:39], v[20:23], a[20:23]
    ds_read_b128 v[72:75], v5 offset:6144
    v_mfma_f32_16x16x32_bf16 a[24:27], v[36:39], v[24:27], a[24:27]
    ds_read_b64_tr_b16 v[76:77], v7 offset:0
    v_mfma_f32_16x16x32_bf16 a[28:31], v[36:39], v[28:31], a[28:31]
    ds_read_b64_tr_b16 v[78:79], v7 offset:512
    v_mfma_f32_16x16x32_bf16 a[32:35], v[40:43], v[16:19], a[32:35]
    ds_read_b64_tr_b16 v[80:81], v7 offset:4096
    v_mfma_f32_16x16x32_bf16 a[36:39], v[40:43], v[20:23], a[36:39]
    v_mfma_f32_16x16x32_bf16 a[40:43], v[40:43], v[24:27], a[40:43]
    ds_read_b64_tr_b16 v[82:83], v7 offset:4608
    v_mfma_f32_16x16x32_bf16 a[44:47], v[40:43], v[28:31], a[44:47]
    ds_read_b64_tr_b16 v[84:85], v7 offset:8192
    v_mfma_f32_16x16x32_bf16 a[48:51], v[44:47], v[16:19], a[48:51]
    ds_read_b64_tr_b16 v[86:87], v7 offset:8704
    v_mfma_f32_16x16x32_bf16 a[52:55], v[44:47], v[20:23], a[52:55]
    ds_read_b64_tr_b16 v[88:89], v7 offset:12288
    v_mfma_f32_16x16x32_bf16 a[56:59], v[44:47], v[24:27], a[56:59]
    v_mfma_f32_16x16x32_bf16 a[60:63], v[44:47], v[28:31], a[60:63]
    ds_read_b64_tr_b16 v[90:91], v7 offset:12800
    v_mfma_f32_16x16x32_bf16 a[64:67], v[48:51], v[16:19], a[64:67]
    ds_read_b64_tr_b16 v[92:93], v7 offset:16384
    v_mfma_f32_16x16x32_bf16 a[68:71], v[48:51], v[20:23], a[68:71]
    ds_read_b64_tr_b16 v[94:95], v7 offset:16896
    v_mfma_f32_16x16x32_bf16 a[72:75], v[48:51], v[24:27], a[72:75]
    v_mfma_f32_16x16x32_bf16 a[76:79], v[48:51], v[28:31], a[76:79]
    ds_read_b64_tr_b16 v[96:97], v7 offset:20480
    v_mfma_f32_16x16x32_bf16 a[80:83], v[52:55], v[16:19], a[80:83]
    ds_read_b64_tr_b16 v[98:99], v7 offset:20992
    v_mfma_f32_16x16x32_bf16 a[84:87], v[52:55], v[20:23], a[84:87]
    ds_read_b64_tr_b16 v[100:101], v7 offset:24576
    v_mfma_f32_16x16x32_bf16 a[88:91], v[52:55], v[24:27], a[88:91]
    ds_read_b64_tr_b16 v[102:103], v7 offset:25088
    v_mfma_f32_16x16x32_bf16 a[92:95], v[52:55], v[28:31], a[92:95]
    v_mfma_f32_16x16x32_bf16 a[96:99], v[56:59], v[16:19], a[96:99]
    s_add_u32 m0, s24, 32768
    s_add_u32 s19, s17, s20
    buffer_load_dwordx4 v3, s[8:11], s19 offen lds
    v_mfma_f32_16x16x32_bf16 a[100:103], v[56:59], v[20:23], a[100:103]
    s_add_u32 m0, s25, 32768
    s_add_u32 s19, s17, s21
    buffer_load_dwordx4 v3, s[8:11], s19 offen lds
    v_mfma_f32_16x16x32_bf16 a[104:107], v[56:59], v[24:27], a[104:107]
    s_add_u32 m0, s26, 32768
    s_add_u32 s19, s17, s22
    buffer_load_dwordx4 v3, s[8:11], s19 offen lds
    v_mfma_f32_16x16x32_bf16 a[108:111], v[56:59], v[28:31], a[108:111]
    s_add_u32 m0, s27, 32768
    s_add_u32 s19, s17, s23
    buffer_load_dwordx4 v3, s[8:11], s19 offen lds
    s_add_u32 s17, s17, s18
    s_waitcnt vmcnt(4) lgkmcnt(0)
    s_barrier
    v_mfma_f32_16x16x32_bf16 a[0:3], v[76:79], v[60:63], a[0:3]
    v_mfma_f32_16x16x32_bf16 a[4:7], v[76:79], v[64:67], a[4:7]
    ds_read_b128 v[16:19], v4 offset:16384
    v_mfma_f32_16x16x32_bf16 a[8:11], v[76:79], v[68:71], a[8:11]
    ds_read_b128 v[20:23], v4 offset:18432
    v_mfma_f32_16x16x32_bf16 a[12:15], v[76:79], v[72:75], a[12:15]
    ds_read_b128 v[24:27], v4 offset:20480
    v_mfma_f32_16x16x32_bf16 a[16:19], v[80:83], v[60:63], a[16:19]
    ds_read_b128 v[28:31], v4 offset:22528
    v_mfma_f32_16x16x32_bf16 a[20:23], v[80:83], v[64:67], a[20:23]
    ds_read_b64_tr_b16 v[32:33], v8 offset:0
    v_mfma_f32_16x16x32_bf16 a[24:27], v[80:83], v[68:71], a[24:27]
    ds_read_b64_tr_b16 v[34:35], v8 offset:512
    v_mfma_f32_16x16x32_bf16 a[28:31], v[80:83], v[72:75], a[28:31]
    v_mfma_f32_16x16x32_bf16 a[32:35], v[84:87], v[60:63], a[32:35]
    ds_read_b64_tr_b16 v[36:37], v8 offset:4096
    v_mfma_f32_16x16x32_bf16 a[36:39], v[84:87], v[64:67], a[36:39]
    ds_read_b64_tr_b16 v[38:39], v8 offset:4608
    v_mfma_f32_16x16x32_bf16 a[40:43], v[84:87], v[68:71], a[40:43]
    ds_read_b64_tr_b16 v[40:41], v8 offset:8192
    v_mfma_f32_16x16x32_bf16 a[44:47], v[84:87], v[72:75], a[44:47]
    ds_read_b64_tr_b16 v[42:43], v8 offset:8704
    v_mfma_f32_16x16x32_bf16 a[48:51], v[88:91], v[60:63], a[48:51]
    ds_read_b64_tr_b16 v[44:45], v8 offset:12288
    v_mfma_f32_16x16x32_bf16 a[52:55], v[88:91], v[64:67], a[52:55]
    ds_read_b64_tr_b16 v[46:47], v8 offset:12800
    v_mfma_f32_16x16x32_bf16 a[56:59], v[88:91], v[68:71], a[56:59]
    v_mfma_f32_16x16x32_bf16 a[60:63], v[88:91], v[72:75], a[60:63]
    ds_read_b64_tr_b16 v[48:49], v8 offset:16384
    v_mfma_f32_16x16x32_bf16 a[64:67], v[92:95], v[60:63], a[64:67]
    ds_read_b64_tr_b16 v[50:51], v8 offset:16896
    v_mfma_f32_16x16x32_bf16 a[68:71], v[92:95], v[64:67], a[68:71]
    ds_read_b64_tr_b16 v[52:53], v8 offset:20480
    v_mfma_f32_16x16x32_bf16 a[72:75], v[92:95], v[68:71], a[72:75]
    ds_read_b64_tr_b16 v[54:55], v8 offset:20992
    v_mfma_f32_16x16x32_bf16 a[76:79], v[92:95], v[72:75], a[76:79]
    ds_read_b64_tr_b16 v[56:57], v8 offset:24576
    v_mfma_f32_16x16x32_bf16 a[80:83], v[96:99], v[60:63], a[80:83]
    ds_read_b64_tr_b16 v[58:59], v8 offset:25088
    v_mfma_f32_16x16x32_bf16 a[84:87], v[96:99], v[64:67], a[84:87]
    v_mfma_f32_16x16x32_bf16 a[88:91], v[96:99], v[68:71], a[88:91]
    s_add_u32 m0, s24, 61440
    s_add_u32 s19, s17, s20
    buffer_load_dwordx4 v3, s[8:11], s19 offen lds
    v_mfma_f32_16x16x32_bf16 a[92:95], v[96:99], v[72:75], a[92:95]
    s_add_u32 m0, s25, 61440
    s_add_u32 s19, s17, s21
    buffer_load_dwordx4 v3, s[8:11], s19 offen lds
    v_mfma_f32_16x16x32_bf16 a[96:99], v[100:103], v[60:63], a[96:99]
    s_add_u32 m0, s26, 61440
    s_add_u32 s19, s17, s22
    buffer_load_dwordx4 v3, s[8:11], s19 offen lds
    v_mfma_f32_16x16x32_bf16 a[100:103], v[100:103], v[64:67], a[100:103]
    s_add_u32 m0, s27, 61440
    s_add_u32 s19, s17, s23
    buffer_load_dwordx4 v3, s[8:11], s19 offen lds
    s_add_u32 s17, s17, s18
    v_mfma_f32_16x16x32_bf16 a[104:107], v[100:103], v[68:71], a[104:107]
    s_add_u32 m0, s28, 0
    s_add_u32 s19, s16, 1024
    buffer_load_dwordx4 v2, s[4:7], s19 offen lds
    v_mfma_f32_16x16x32_bf16 a[108:111], v[100:103], v[72:75], a[108:111]
    s_add_u32 m0, s28, 8192
    s_add_u32 s19, s16, 1024
    s_add_u32 s19, s19, s29
    buffer_load_dwordx4 v2, s[4:7], s19 offen lds
    s_waitcnt vmcnt(10) lgkmcnt(0)
    s_barrier
    v_mfma_f32_16x16x32_bf16 a[0:3], v[32:35], v[16:19], a[0:3]
    v_mfma_f32_16x16x32_bf16 a[4:7], v[32:35], v[20:23], a[4:7]
    ds_read_b128 v[60:63], v5 offset:16384
    v_mfma_f32_16x16x32_bf16 a[8:11], v[32:35], v[24:27], a[8:11]
    v_mfma_f32_16x16x32_bf16 a[12:15], v[32:35], v[28:31], a[12:15]
    ds_read_b128 v[64:67], v5 offset:18432
    v_mfma_f32_16x16x32_bf16 a[16:19], v[36:39], v[16:19], a[16:19]
    ds_read_b128 v[68:71], v5 offset:20480
    v_mfma_f32_16x16x32_bf16 a[20:23], v[36:39], v[20:23], a[20:23]
    v_mfma_f32_16x16x32_bf16 a[24:27], v[36:39], v[24:27], a[24:27]
    ds_read_b128 v[72:75], v5 offset:22528
    v_mfma_f32_16x16x32_bf16 a[28:31], v[36:39], v[28:31], a[28:31]
    ds_read_b64_tr_b16 v[76:77], v9 offset:0
    v_mfma_f32_16x16x32_bf16 a[32:35], v[40:43], v[16:19], a[32:35]
    v_mfma_f32_16x16x32_bf16 a[36:39], v[40:43], v[20:23], a[36:39]
    ds_read_b64_tr_b16 v[78:79], v9 offset:512
    v_mfma_f32_16x16x32_bf16 a[40:43], v[40:43], v[24:27], a[40:43]
    ds_read_b64_tr_b16 v[80:81], v9 offset:4096
    v_mfma_f32_16x16x32_bf16 a[44:47], v[40:43], v[28:31], a[44:47]
    v_mfma_f32_16x16x32_bf16 a[48:51], v[44:47], v[16:19], a[48:51]
    ds_read_b64_tr_b16 v[82:83], v9 offset:4608
    v_mfma_f32_16x16x32_bf16 a[52:55], v[44:47], v[20:23], a[52:55]
    ds_read_b64_tr_b16 v[84:85], v9 offset:8192
    v_mfma_f32_16x16x32_bf16 a[56:59], v[44:47], v[24:27], a[56:59]
    v_mfma_f32_16x16x32_bf16 a[60:63], v[44:47], v[28:31], a[60:63]
    ds_read_b64_tr_b16 v[86:87], v9 offset:8704
    v_mfma_f32_16x16x32_bf16 a[64:67], v[48:51], v[16:19], a[64:67]
    v_mfma_f32_16x16x32_bf16 a[68:71], v[48:51], v[20:23], a[68:71]
    ds_read_b64_tr_b16 v[88:89], v9 offset:12288
    v_mfma_f32_16x16x32_bf16 a[72:75], v[48:51], v[24:27], a[72:75]
    ds_read_b64_tr_b16 v[90:91], v9 offset:12800
    v_mfma_f32_16x16x32_bf16 a[76:79], v[48:51], v[28:31], a[76:79]
    v_mfma_f32_16x16x32_bf16 a[80:83], v[52:55], v[16:19], a[80:83]
    ds_read_b64_tr_b16 v[92:93], v9 offset:16384
    v_mfma_f32_16x16x32_bf16 a[84:87], v[52:55], v[20:23], a[84:87]
    ds_read_b64_tr_b16 v[94:95], v9 offset:16896
    v_mfma_f32_16x16x32_bf16 a[88:91], v[52:55], v[24:27], a[88:91]
    v_mfma_f32_16x16x32_bf16 a[92:95], v[52:55], v[28:31], a[92:95]
    ds_read_b64_tr_b16 v[96:97], v9 offset:20480
    v_mfma_f32_16x16x32_bf16 a[96:99], v[56:59], v[16:19], a[96:99]
    ds_read_b64_tr_b16 v[98:99], v9 offset:20992
    v_mfma_f32_16x16x32_bf16 a[100:103], v[56:59], v[20:23], a[100:103]
    v_mfma_f32_16x16x32_bf16 a[104:107], v[56:59], v[24:27], a[104:107]
    ds_read_b64_tr_b16 v[100:101], v9 offset:24576
    v_mfma_f32_16x16x32_bf16 a[108:111], v[56:59], v[28:31], a[108:111]
    ds_read_b64_tr_b16 v[102:103], v9 offset:25088
    s_waitcnt vmcnt(0) lgkmcnt(0)
    s_barrier
    v_mfma_f32_16x16x32_bf16 a[0:3], v[76:79], v[60:63], a[0:3]
    v_mfma_f32_16x16x32_bf16 a[4:7], v[76:79], v[64:67], a[4:7]
    ds_read_b128 v[16:19], v4 offset:0
    v_mfma_f32_16x16x32_bf16 a[8:11], v[76:79], v[68:71], a[8:11]
    v_mfma_f32_16x16x32_bf16 a[12:15], v[76:79], v[72:75], a[12:15]
    ds_read_b128 v[20:23], v4 offset:2048
    v_mfma_f32_16x16x32_bf16 a[16:19], v[80:83], v[60:63], a[16:19]
    ds_read_b128 v[24:27], v4 offset:4096
    v_mfma_f32_16x16x32_bf16 a[20:23], v[80:83], v[64:67], a[20:23]
    v_mfma_f32_16x16x32_bf16 a[24:27], v[80:83], v[68:71], a[24:27]
    ds_read_b128 v[28:31], v4 offset:6144
    v_mfma_f32_16x16x32_bf16 a[28:31], v[80:83], v[72:75], a[28:31]
    ds_read_b64_tr_b16 v[32:33], v6 offset:0
    v_mfma_f32_16x16x32_bf16 a[32:35], v[84:87], v[60:63], a[32:35]
    v_mfma_f32_16x16x32_bf16 a[36:39], v[84:87], v[64:67], a[36:39]
    ds_read_b64_tr_b16 v[34:35], v6 offset:512
    v_mfma_f32_16x16x32_bf16 a[40:43], v[84:87], v[68:71], a[40:43]
    ds_read_b64_tr_b16 v[36:37], v6 offset:4096
    v_mfma_f32_16x16x32_bf16 a[44:47], v[84:87], v[72:75], a[44:47]
    v_mfma_f32_16x16x32_bf16 a[48:51], v[88:91], v[60:63], a[48:51]
    ds_read_b64_tr_b16 v[38:39], v6 offset:4608
    v_mfma_f32_16x16x32_bf16 a[52:55], v[88:91], v[64:67], a[52:55]
    ds_read_b64_tr_b16 v[40:41], v6 offset:8192
    v_mfma_f32_16x16x32_bf16 a[56:59], v[88:91], v[68:71], a[56:59]
    v_mfma_f32_16x16x32_bf16 a[60:63], v[88:91], v[72:75], a[60:63]
    ds_read_b64_tr_b16 v[42:43], v6 offset:8704
    v_mfma_f32_16x16x32_bf16 a[64:67], v[92:95], v[60:63], a[64:67]
    v_mfma_f32_16x16x32_bf16 a[68:71], v[92:95], v[64:67], a[68:71]
    ds_read_b64_tr_b16 v[44:45], v6 offset:12288
    v_mfma_f32_16x16x32_bf16 a[72:75], v[92:95], v[68:71], a[72:75]
    ds_read_b64_tr_b16 v[46:47], v6 offset:12800
    v_mfma_f32_16x16x32_bf16 a[76:79], v[92:95], v[72:75], a[76:79]
    v_mfma_f32_16x16x32_bf16 a[80:83], v[96:99], v[60:63], a[80:83]
    ds_read_b64_tr_b16 v[48:49], v6 offset:16384
    v_mfma_f32_16x16x32_bf16 a[84:87], v[96:99], v[64:67], a[84:87]
    ds_read_b64_tr_b16 v[50:51], v6 offset:16896
    v_mfma_f32_16x16x32_bf16 a[88:91], v[96:99], v[68:71], a[88:91]
    v_mfma_f32_16x16x32_bf16 a[92:95], v[96:99], v[72:75], a[92:95]
    ds_read_b64_tr_b16 v[52:53], v6 offset:20480
    v_mfma_f32_16x16x32_bf16 a[96:99], v[100:103], v[60:63], a[96:99]
    ds_read_b64_tr_b16 v[54:55], v6 offset:20992
    v_mfma_f32_16x16x32_bf16 a[100:103], v[100:103], v[64:67], a[100:103]
    v_mfma_f32_16x16x32_bf16 a[104:107], v[100:103], v[68:71], a[104:107]
    ds_read_b64_tr_b16 v[56:57], v6 offset:24576
    v_mfma_f32_16x16x32_bf16 a[108:111], v[100:103], v[72:75], a[108:111]
    ds_read_b64_tr_b16 v[58:59], v6 offset:25088
    s_waitcnt vmcnt(0) lgkmcnt(0)
    s_barrier
    v_mfma_f32_16x16x32_bf16 a[0:3], v[32:35], v[16:19], a[0:3]
    v_mfma_f32_16x16x32_bf16 a[4:7], v[32:35], v[20:23], a[4:7]
    ds_read_b128 v[60:63], v5 offset:0
    v_mfma_f32_16x16x32_bf16 a[8:11], v[32:35], v[24:27], a[8:11]
    v_mfma_f32_16x16x32_bf16 a[12:15], v[32:35], v[28:31], a[12:15]
    ds_read_b128 v[64:67], v5 offset:2048
    v_mfma_f32_16x16x32_bf16 a[16:19], v[36:39], v[16:19], a[16:19]
    ds_read_b128 v[68:71], v5 offset:4096
    v_mfma_f32_16x16x32_bf16 a[20:23], v[36:39], v[20:23], a[20:23]
    v_mfma_f32_16x16x32_bf16 a[24:27], v[36:39], v[24:27], a[24:27]
    ds_read_b128 v[72:75], v5 offset:6144
    v_mfma_f32_16x16x32_bf16 a[28:31], v[36:39], v[28:31], a[28:31]
    ds_read_b64_tr_b16 v[76:77], v7 offset:0
    v_mfma_f32_16x16x32_bf16 a[32:35], v[40:43], v[16:19], a[32:35]
    v_mfma_f32_16x16x32_bf16 a[36:39], v[40:43], v[20:23], a[36:39]
    ds_read_b64_tr_b16 v[78:79], v7 offset:512
    v_mfma_f32_16x16x32_bf16 a[40:43], v[40:43], v[24:27], a[40:43]
    ds_read_b64_tr_b16 v[80:81], v7 offset:4096
    v_mfma_f32_16x16x32_bf16 a[44:47], v[40:43], v[28:31], a[44:47]
    v_mfma_f32_16x16x32_bf16 a[48:51], v[44:47], v[16:19], a[48:51]
    ds_read_b64_tr_b16 v[82:83], v7 offset:4608
    v_mfma_f32_16x16x32_bf16 a[52:55], v[44:47], v[20:23], a[52:55]
    ds_read_b64_tr_b16 v[84:85], v7 offset:8192
    v_mfma_f32_16x16x32_bf16 a[56:59], v[44:47], v[24:27], a[56:59]
    v_mfma_f32_16x16x32_bf16 a[60:63], v[44:47], v[28:31], a[60:63]
    ds_read_b64_tr_b16 v[86:87], v7 offset:8704
    v_mfma_f32_16x16x32_bf16 a[64:67], v[48:51], v[16:19], a[64:67]
    v_mfma_f32_16x16x32_bf16 a[68:71], v[48:51], v[20:23], a[68:71]
    ds_read_b64_tr_b16 v[88:89], v7 offset:12288
    v_mfma_f32_16x16x32_bf16 a[72:75], v[48:51], v[24:27], a[72:75]
    ds_read_b64_tr_b16 v[90:91], v7 offset:12800
    v_mfma_f32_16x16x32_bf16 a[76:79], v[48:51], v[28:31], a[76:79]
    v_mfma_f32_16x16x32_bf16 a[80:83], v[52:55], v[16:19], a[80:83]
    ds_read_b64_tr_b16 v[92:93], v7 offset:16384
    v_mfma_f32_16x16x32_bf16 a[84:87], v[52:55], v[20:23], a[84:87]
    ds_read_b64_tr_b16 v[94:95], v7 offset:16896
    v_mfma_f32_16x16x32_bf16 a[88:91], v[52:55], v[24:27], a[88:91]
    v_mfma_f32_16x16x32_bf16 a[92:95], v[52:55], v[28:31], a[92:95]
    ds_read_b64_tr_b16 v[96:97], v7 offset:20480
    v_mfma_f32_16x16x32_bf16 a[96:99], v[56:59], v[16:19], a[96:99]
    ds_read_b64_tr_b16 v[98:99], v7 offset:20992
    v_mfma_f32_16x16x32_bf16 a[100:103], v[56:59], v[20:23], a[100:103]
    v_mfma_f32_16x16x32_bf16 a[104:107], v[56:59], v[24:27], a[104:107]
    ds_read_b64_tr_b16 v[100:101], v7 offset:24576
    v_mfma_f32_16x16x32_bf16 a[108:111], v[56:59], v[28:31], a[108:111]
    ds_read_b64_tr_b16 v[102:103], v7 offset:25088
    s_waitcnt vmcnt(0) lgkmcnt(0)
    s_barrier
    v_mfma_f32_16x16x32_bf16 a[0:3], v[76:79], v[60:63], a[0:3]
    v_mfma_f32_16x16x32_bf16 a[4:7], v[76:79], v[64:67], a[4:7]
    v_mfma_f32_16x16x32_bf16 a[8:11], v[76:79], v[68:71], a[8:11]
    v_mfma_f32_16x16x32_bf16 a[12:15], v[76:79], v[72:75], a[12:15]
    v_mfma_f32_16x16x32_bf16 a[16:19], v[80:83], v[60:63], a[16:19]
    v_mfma_f32_16x16x32_bf16 a[20:23], v[80:83], v[64:67], a[20:23]
    v_mfma_f32_16x16x32_bf16 a[24:27], v[80:83], v[68:71], a[24:27]
    v_mfma_f32_16x16x32_bf16 a[28:31], v[80:83], v[72:75], a[28:31]
    v_mfma_f32_16x16x32_bf16 a[32:35], v[84:87], v[60:63], a[32:35]
    v_mfma_f32_16x16x32_bf16 a[36:39], v[84:87], v[64:67], a[36:39]
    v_mfma_f32_16x16x32_bf16 a[40:43], v[84:87], v[68:71], a[40:43]
    v_mfma_f32_16x16x32_bf16 a[44:47], v[84:87], v[72:75], a[44:47]
    v_mfma_f32_16x16x32_bf16 a[48:51], v[88:91], v[60:63], a[48:51]
    v_mfma_f32_16x16x32_bf16 a[52:55], v[88:91], v[64:67], a[52:55]
    v_mfma_f32_16x16x32_bf16 a[56:59], v[88:91], v[68:71], a[56:59]
    v_mfma_f32_16x16x32_bf16 a[60:63], v[88:91], v[72:75], a[60:63]
    v_mfma_f32_16x16x32_bf16 a[64:67], v[92:95], v[60:63], a[64:67]
    v_mfma_f32_16x16x32_bf16 a[68:71], v[92:95], v[64:67], a[68:71]
    v_mfma_f32_16x16x32_bf16 a[72:75], v[92:95], v[68:71], a[72:75]
    v_mfma_f32_16x16x32_bf16 a[76:79], v[92:95], v[72:75], a[76:79]
    v_mfma_f32_16x16x32_bf16 a[80:83], v[96:99], v[60:63], a[80:83]
    v_mfma_f32_16x16x32_bf16 a[84:87], v[96:99], v[64:67], a[84:87]
    v_mfma_f32_16x16x32_bf16 a[88:91], v[96:99], v[68:71], a[88:91]
    v_mfma_f32_16x16x32_bf16 a[92:95], v[96:99], v[72:75], a[92:95]
    v_mfma_f32_16x16x32_bf16 a[96:99], v[100:103], v[60:63], a[96:99]
    v_mfma_f32_16x16x32_bf16 a[100:103], v[100:103], v[64:67], a[100:103]
    v_mfma_f32_16x16x32_bf16 a[104:107], v[100:103], v[68:71], a[104:107]
    v_mfma_f32_16x16x32_bf16 a[108:111], v[100:103], v[72:75], a[108:111]
    s_mov_b32 s52, 7
    s_branch L_g1_epi
L_g1_np6:
    s_add_u32 m0, s24, 32768
    s_add_u32 s19, s17, s20
    buffer_load_dwordx4 v3, s[8:11], s19 offen lds
    s_add_u32 m0, s25, 32768
    s_add_u32 s19, s17, s21
    buffer_load_dwordx4 v3, s[8:11], s19 offen lds
    s_add_u32 m0, s26, 32768
    s_add_u32 s19, s17, s22
    buffer_load_dwordx4 v3, s[8:11], s19 offen lds
    s_add_u32 s17, s17, s18
    s_add_u32 m0, s28, 0
    s_add_u32 s19, s16, 0
    buffer_load_dwordx4 v2, s[4:7], s19 offen lds
    s_add_u32 m0, s28, 8192
    s_add_u32 s19, s16, 0
    s_add_u32 s19, s19, s29
    buffer_load_dwordx4 v2, s[4:7], s19 offen lds
    s_add_u32 m0, s24, 61440
    s_add_u32 s19, s17, s20
    buffer_load_dwordx4 v3, s[8:11], s19 offen lds
    s_add_u32 m0, s25, 61440
    s_add_u32 s19, s17, s21
    buffer_load_dwordx4 v3, s[8:11], s19 offen lds
    s_add_u32 m0, s26, 61440
    s_add_u32 s19, s17, s22
    buffer_load_dwordx4 v3, s[8:11], s19 offen lds
    s_add_u32 s17, s17, s18
    s_add_u32 m0, s28, 16384
    s_add_u32 s19, s16, 128
    buffer_load_dwordx4 v2, s[4:7], s19 offen lds
    s_add_u32 m0, s28, 24576
    s_add_u32 s19, s16, 128
    s_add_u32 s19, s19, s29
    buffer_load_dwordx4 v2, s[4:7], s19 offen lds
    s_add_u32 m0, s24, 90112
    s_add_u32 s19, s17, s20
    buffer_load_dwordx4 v3, s[8:11], s19 offen lds
    s_add_u32 m0, s25, 90112
    s_add_u32 s19, s17, s21
    buffer_load_dwordx4 v3, s[8:11], s19 offen lds
    s_add_u32 m0, s26, 90112
    s_add_u32 s19, s17, s22
    buffer_load_dwordx4 v3, s[8:11], s19 offen lds
    s_add_u32 s17, s17, s18
    s_add_u32 m0, s24, 118784
    s_add_u32 s19, s17, s20
    buffer_load_dwordx4 v3, s[8:11], s19 offen lds
    s_add_u32 m0, s25, 118784
    s_add_u32 s19, s17, s21
    buffer_load_dwordx4 v3, s[8:11], s19 offen lds
    s_add_u32 m0, s26, 118784
    s_add_u32 s19, s17, s22
    buffer_load_dwordx4 v3, s[8:11], s19 offen lds
    s_add_u32 s17, s17, s18
    s_waitcnt vmcnt(8)
    s_barrier
    ds_read_b128 v[16:19], v4 offset:0
    ds_read_b128 v[20:23], v4 offset:2048
    ds_read_b128 v[24:27], v4 offset:4096
    ds_read_b128 v[28:31], v4 offset:6144
    ds_read_b64_tr_b16 v[32:33], v6 offset:0
    ds_read_b64_tr_b16 v[34:35], v6 offset:512
    ds_read_b64_tr_b16 v[36:37], v6 offset:4096
    ds_read_b64_tr_b16 v[38:39], v6 offset:4608
    ds_read_b64_tr_b16 v[40:41], v6 offset:8192
    ds_read_b64_tr_b16 v[42:43], v6 offset:8704
    ds_read_b64_tr_b16 v[44:45], v6 offset:12288
    ds_read_b64_tr_b16 v[46:47], v6 offset:12800
    ds_read_b64_tr_b16 v[48:49], v6 offset:16384
    ds_read_b64_tr_b16 v[50:51], v6 offset:16896
    ds_read_b64_tr_b16 v[52:53], v6 offset:20480
    ds_read_b64_tr_b16 v[54:55], v6 offset:20992
    s_waitcnt lgkmcnt(0)
    s_barrier
    v_mfma_f32_16x16x32_bf16 a[0:3], v[32:35], v[16:19], a[0:3]
    v_mfma_f32_16x16x32_bf16 a[4:7], v[32:35], v[20:23], a[4:7]
    ds_read_b128 v[56:59], v5 offset:0
    v_mfma_f32_16x16x32_bf16 a[8:11], v[32:35], v[24:27], a[8:11]
    ds_read_b128 v[60:63], v5 offset:2048
    v_mfma_f32_16x16x32_bf16 a[12:15], v[32:35], v[28:31], a[12:15]
    ds_read_b128 v[64:67], v5 offset:4096
    v_mfma_f32_16x16x32_bf16 a[16:19], v[36:39], v[16:19], a[16:19]
    v_mfma_f32_16x16x32_bf16 a[20:23], v[36:39], v[20:23], a[20:23]
    ds_read_b128 v[68:71], v5 offset:6144
    v_mfma_f32_16x16x32_bf16 a[24:27], v[36:39], v[24:27], a[24:27]
    ds_read_b64_tr_b16 v[72:73], v7 offset:0
    v_mfma_f32_16x16x32_bf16 a[28:31], v[36:39], v[28:31], a[28:31]
    ds_read_b64_tr_b16 v[74:75], v7 offset:512
    v_mfma_f32_16x16x32_bf16 a[32:35], v[40:43], v[16:19], a[32:35]
    ds_read_b64_tr_b16 v[76:77], v7 offset:4096
    v_mfma_f32_16x16x32_bf16 a[36:39], v[40:43], v[20:23], a[36:39]
    v_mfma_f32_16x16x32_bf16 a[40:43], v[40:43], v[24:27], a[40:43]
    ds_read_b64_tr_b16 v[78:79], v7 offset:4608
    v_mfma_f32_16x16x32_bf16 a[44:47], v[40:43], v[28:31], a[44:47]
    ds_read_b64_tr_b16 v[80:81], v7 offset:8192
    v_mfma_f32_16x16x32_bf16 a[48:51], v[44:47], v[16:19], a[48:51]
    ds_read_b64_tr_b16 v[82:83], v7 offset:8704
    v_mfma_f32_16x16x32_bf16 a[52:55], v[44:47], v[20:23], a[52:55]
    ds_read_b64_tr_b16 v[84:85], v7 offset:12288
    v_mfma_f32_16x16x32_bf16 a[56:59], v[44:47], v[24:27], a[56:59]
    v_mfma_f32_16x16x32_bf16 a[60:63], v[44:47], v[28:31], a[60:63]
    ds_read_b64_tr_b16 v[86:87], v7 offset:12800
    v_mfma_f32_16x16x32_bf16 a[64:67], v[48:51], v[16:19], a[64:67]
    ds_read_b64_tr_b16 v[88:89], v7 offset:16384
    v_mfma_f32_16x16x32_bf16 a[68:71], v[48:51], v[20:23], a[68:71]
    ds_read_b64_tr_b16 v[90:91], v7 offset:16896
    v_mfma_f32_16x16x32_bf16 a[72:75], v[48:51], v[24:27], a[72:75]
    ds_read_b64_tr_b16 v[92:93], v7 offset:20480
    v_mfma_f32_16x16x32_bf16 a[76:79], v[48:51], v[28:31], a[76:79]
    v_mfma_f32_16x16x32_bf16 a[80:83], v[52:55], v[16:19], a[80:83]
    ds_read_b64_tr_b16 v[94:95], v7 offset:20992
    v_mfma_f32_16x16x32_bf16 a[84:87], v[52:55], v[20:23], a[84:87]
    s_add_u32 m0, s24, 32768
    s_add_u32 s19, s17, s20
    buffer_load_dwordx4 v3, s[8:11], s19 offen lds
    v_mfma_f32_16x16x32_bf16 a[88:91], v[52:55], v[24:27], a[88:91]
    s_add_u32 m0, s25, 32768
    s_add_u32 s19, s17, s21
    buffer_load_dwordx4 v3, s[8:11], s19 offen lds
    v_mfma_f32_16x16x32_bf16 a[92:95], v[52:55], v[28:31], a[92:95]
    s_add_u32 m0, s26, 32768
    s_add_u32 s19, s17, s22
    buffer_load_dwordx4 v3, s[8:11], s19 offen lds
    s_add_u32 s17, s17, s18
    s_waitcnt vmcnt(6) lgkmcnt(0)
    s_barrier
    v_mfma_f32_16x16x32_bf16 a[0:3], v[72:75], v[56:59], a[0:3]
    v_mfma_f32_16x16x32_bf16 a[4:7], v[72:75], v[60:63], a[4:7]
    ds_read_b128 v[16:19], v4 offset:16384
    v_mfma_f32_16x16x32_bf16 a[8:11], v[72:75], v[64:67], a[8:11]
    ds_read_b128 v[20:23], v4 offset:18432
    v_mfma_f32_16x16x32_bf16 a[12:15], v[72:75], v[68:71], a[12:15]
    ds_read_b128 v[24:27], v4 offset:20480
    v_mfma_f32_16x16x32_bf16 a[16:19], v[76:79], v[56:59], a[16:19]
    ds_read_b128 v[28:31], v4 offset:22528
    v_mfma_f32_16x16x32_bf16 a[20:23], v[76:79], v[60:63], a[20:23]
    ds_read_b64_tr_b16 v[32:33], v8 offset:0
    v_mfma_f32_16x16x32_bf16 a[24:27], v[76:79], v[64:67], a[24:27]
    ds_read_b64_tr_b16 v[34:35], v8 offset:512
    v_mfma_f32_16x16x32_bf16 a[28:31], v[76:79], v[68:71], a[28:31]
    ds_read_b64_tr_b16 v[36:37], v8 offset:4096
    v_mfma_f32_16x16x32_bf16 a[32:35], v[80:83], v[56:59], a[32:35]
    v_mfma_f32_16x16x32_bf16 a[36:39], v[80:83], v[60:63], a[36:39]
    ds_read_b64_tr_b16 v[38:39], v8 offset:4608
    v_mfma_f32_16x16x32_bf16 a[40:43], v[80:83], v[64:67], a[40:43]
    ds_read_b64_tr_b16 v[40:41], v8 offset:8192
    v_mfma_f32_16x16x32_bf16 a[44:47], v[80:83], v[68:71], a[44:47]
    ds_read_b64_tr_b16 v[42:43], v8 offset:8704
    v_mfma_f32_16x16x32_bf16 a[48:51], v[84:87], v[56:59], a[48:51]
    ds_read_b64_tr_b16 v[44:45], v8 offset:12288
    v_mfma_f32_16x16x32_bf16 a[52:55], v[84:87], v[60:63], a[52:55]
    ds_read_b64_tr_b16 v[46:47], v8 offset:12800
    v_mfma_f32_16x16x32_bf16 a[56:59], v[84:87], v[64:67], a[56:59]
    ds_read_b64_tr_b16 v[48:49], v8 offset:16384
    v_mfma_f32_16x16x32_bf16 a[60:63], v[84:87], v[68:71], a[60:63]
    ds_read_b64_tr_b16 v[50:51], v8 offset:16896
    v_mfma_f32_16x16x32_bf16 a[64:67], v[88:91], v[56:59], a[64:67]
    v_mfma_f32_16x16x32_bf16 a[68:71], v[88:91], v[60:63], a[68:71]
    ds_read_b64_tr_b16 v[52:53], v8 offset:20480
    v_mfma_f32_16x16x32_bf16 a[72:75], v[88:91], v[64:67], a[72:75]
    ds_read_b64_tr_b16 v[54:55], v8 offset:20992
    v_mfma_f32_16x16x32_bf16 a[76:79], v[88:91], v[68:71], a[76:79]
    s_add_u32 m0, s24, 61440
    s_add_u32 s19, s17, s20
    buffer_load_dwordx4 v3, s[8:11], s19 offen lds
    v_mfma_f32_16x16x32_bf16 a[80:83], v[92:95], v[56:59], a[80:83]
    s_add_u32 m0, s25, 61440
    s_add_u32 s19, s17, s21
    buffer_load_dwordx4 v3, s[8:11], s19 offen lds
    v_mfma_f32_16x16x32_bf16 a[84:87], v[92:95], v[60:63], a[84:87]
    s_add_u32 m0, s26, 61440
    s_add_u32 s19, s17, s22
    buffer_load_dwordx4 v3, s[8:11], s19 offen lds
    s_add_u32 s17, s17, s18
    v_mfma_f32_16x16x32_bf16 a[88:91], v[92:95], v[64:67], a[88:91]
    s_add_u32 m0, s28, 0
    s_add_u32 s19, s16, 256
    buffer_load_dwordx4 v2, s[4:7], s19 offen lds
    v_mfma_f32_16x16x32_bf16 a[92:95], v[92:95], v[68:71], a[92:95]
    s_add_u32 m0, s28, 8192
    s_add_u32 s19, s16, 256
    s_add_u32 s19, s19, s29
    buffer_load_dwordx4 v2, s[4:7], s19 offen lds
    s_waitcnt vmcnt(8) lgkmcnt(0)
    s_barrier
    v_mfma_f32_16x16x32_bf16 a[0:3], v[32:35], v[16:19], a[0:3]
    v_mfma_f32_16x16x32_bf16 a[4:7], v[32:35], v[20:23], a[4:7]
    ds_read_b128 v[56:59], v5 offset:16384
    v_mfma_f32_16x16x32_bf16 a[8:11], v[32:35], v[24:27], a[8:11]
    ds_read_b128 v[60:63], v5 offset:18432
    v_mfma_f32_16x16x32_bf16 a[12:15], v[32:35], v[28:31], a[12:15]
    ds_read_b128 v[64:67], v5 offset:20480
    v_mfma_f32_16x16x32_bf16 a[16:19], v[36:39], v[16:19], a[16:19]
    v_mfma_f32_16x16x32_bf16 a[20:23], v[36:39], v[20:23], a[20:23]
    ds_read_b128 v[68:71], v5 offset:22528
    v_mfma_f32_16x16x32_bf16 a[24:27], v[36:39], v[24:27], a[24:27]
    ds_read_b64_tr_b16 v[72:73], v9 offset:0
    v_mfma_f32_16x16x32_bf16 a[28:31], v[36:39], v[28:31], a[28:31]
    ds_read_b64_tr_b16 v[74:75], v9 offset:512
    v_mfma_f32_16x16x32_bf16 a[32:35], v[40:43], v[16:19], a[32:35]
    ds_read_b64_tr_b16 v[76:77], v9 offset:4096
    v_mfma_f32_16x16x32_bf16 a[36:39], v[40:43], v[20:23], a[36:39]
    v_mfma_f32_16x16x32_bf16 a[40:43], v[40:43], v[24:27], a[40:43]
    ds_read_b64_tr_b16 v[78:79], v9 offset:4608
    v_mfma_f32_16x16x32_bf16 a[44:47], v[40:43], v[28:31], a[44:47]
    ds_read_b64_tr_b16 v[80:81], v9 offset:8192
    v_mfma_f32_16x16x32_bf16 a[48:51], v[44:47], v[16:19], a[48:51]
    ds_read_b64_tr_b16 v[82:83], v9 offset:8704
    v_mfma_f32_16x16x32_bf16 a[52:55], v[44:47], v[20:23], a[52:55]
    ds_read_b64_tr_b16 v[84:85], v9 offset:12288
    v_mfma_f32_16x16x32_bf16 a[56:59], v[44:47], v[24:27], a[56:59]
    v_mfma_f32_16x16x32_bf16 a[60:63], v[44:47], v[28:31], a[60:63]
    ds_read_b64_tr_b16 v[86:87], v9 offset:12800
    v_mfma_f32_16x16x32_bf16 a[64:67], v[48:51], v[16:19], a[64:67]
    ds_read_b64_tr_b16 v[88:89], v9 offset:16384
    v_mfma_f32_16x16x32_bf16 a[68:71], v[48:51], v[20:23], a[68:71]
    ds_read_b64_tr_b16 v[90:91], v9 offset:16896
    v_mfma_f32_16x16x32_bf16 a[72:75], v[48:51], v[24:27], a[72:75]
    ds_read_b64_tr_b16 v[92:93], v9 offset:20480
    v_mfma_f32_16x16x32_bf16 a[76:79], v[48:51], v[28:31], a[76:79]
    v_mfma_f32_16x16x32_bf16 a[80:83], v[52:55], v[16:19], a[80:83]
    ds_read_b64_tr_b16 v[94:95], v9 offset:20992
    v_mfma_f32_16x16x32_bf16 a[84:87], v[52:55], v[20:23], a[84:87]
    s_add_u32 m0, s24, 90112
    s_add_u32 s19, s17, s20
    buffer_load_dwordx4 v3, s[8:11], s19 offen lds
    v_mfma_f32_16x16x32_bf16 a[88:91], v[52:55], v[24:27], a[88:91]
    s_add_u32 m0, s25, 90112
    s_add_u32 s19, s17, s21
    buffer_load_dwordx4 v3, s[8:11], s19 offen lds
    v_mfma_f32_16x16x32_bf16 a[92:95], v[52:55], v[28:31], a[92:95]
    s_add_u32 m0, s26, 90112
    s_add_u32 s19, s17, s22
    buffer_load_dwordx4 v3, s[8:11], s19 offen lds
    s_add_u32 s17, s17, s18
    s_waitcnt vmcnt(3) lgkmcnt(0)
    s_barrier
    v_mfma_f32_16x16x32_bf16 a[0:3], v[72:75], v[56:59], a[0:3]
    v_mfma_f32_16x16x32_bf16 a[4:7], v[72:75], v[60:63], a[4:7]
    ds_read_b128 v[16:19], v4 offset:0
    v_mfma_f32_16x16x32_bf16 a[8:11], v[72:75], v[64:67], a[8:11]
    ds_read_b128 v[20:23], v4 offset:2048
    v_mfma_f32_16x16x32_bf16 a[12:15], v[72:75], v[68:71], a[12:15]
    ds_read_b128 v[24:27], v4 offset:4096
    v_mfma_f32_16x16x32_bf16 a[16:19], v[76:79], v[56:59], a[16:19]
    ds_read_b128 v[28:31], v4 offset:6144
    v_mfma_f32_16x16x32_bf16 a[20:23], v[76:79], v[60:63], a[20:23]
    ds_read_b64_tr_b16 v[32:33], v6 offset:0
    v_mfma_f32_16x16x32_bf16 a[24:27], v[76:79], v[64:67], a[24:27]
    ds_read_b64_tr_b16 v[34:35], v6 offset:512
    v_mfma_f32_16x16x32_bf16 a[28:31], v[76:79], v[68:71], a[28:31]
    ds_read_b64_tr_b16 v[36:37], v6 offset:4096
    v_mfma_f32_16x16x32_bf16 a[32:35], v[80:83], v[56:59], a[32:35]
    v_mfma_f32_16x16x32_bf16 a[36:39], v[80:83], v[60:63], a[36:39]
    ds_read_b64_tr_b16 v[38:39], v6 offset:4608
    v_mfma_f32_16x16x32_bf16 a[40:43], v[80:83], v[64:67], a[40:43]
    ds_read_b64_tr_b16 v[40:41], v6 offset:8192
    v_mfma_f32_16x16x32_bf16 a[44:47], v[80:83], v[68:71], a[44:47]
    ds_read_b64_tr_b16 v[42:43], v6 offset:8704
    v_mfma_f32_16x16x32_bf16 a[48:51], v[84:87], v[56:59], a[48:51]
    ds_read_b64_tr_b16 v[44:45], v6 offset:12288
    v_mfma_f32_16x16x32_bf16 a[52:55], v[84:87], v[60:63], a[52:55]
    ds_read_b64_tr_b16 v[46:47], v6 offset:12800
    v_mfma_f32_16x16x32_bf16 a[56:59], v[84:87], v[64:67], a[56:59]
    ds_read_b64_tr_b16 v[48:49], v6 offset:16384
    v_mfma_f32_16x16x32_bf16 a[60:63], v[84:87], v[68:71], a[60:63]
    ds_read_b64_tr_b16 v[50:51], v6 offset:16896
    v_mfma_f32_16x16x32_bf16 a[64:67], v[88:91], v[56:59], a[64:67]
    v_mfma_f32_16x16x32_bf16 a[68:71], v[88:91], v[60:63], a[68:71]
    ds_read_b64_tr_b16 v[52:53], v6 offset:20480
    v_mfma_f32_16x16x32_bf16 a[72:75], v[88:91], v[64:67], a[72:75]
    ds_read_b64_tr_b16 v[54:55], v6 offset:20992
    v_mfma_f32_16x16x32_bf16 a[76:79], v[88:91], v[68:71], a[76:79]
    s_add_u32 m0, s24, 118784
    s_add_u32 s19, s17, s20
    buffer_load_dwordx4 v3, s[8:11], s19 offen lds
    v_mfma_f32_16x16x32_bf16 a[80:83], v[92:95], v[56:59], a[80:83]
    s_add_u32 m0, s25, 118784
    s_add_u32 s19, s17, s21
    buffer_load_dwordx4 v3, s[8:11], s19 offen lds
    v_mfma_f32_16x16x32_bf16 a[84:87], v[92:95], v[60:63], a[84:87]
    s_add_u32 m0, s26, 118784
    s_add_u32 s19, s17, s22
    buffer_load_dwordx4 v3, s[8:11], s19 offen lds
    s_add_u32 s17, s17, s18
    v_mfma_f32_16x16x32_bf16 a[88:91], v[92:95], v[64:67], a[88:91]
    s_add_u32 m0, s28, 16384
    s_add_u32 s19, s16, 384
    buffer_load_dwordx4 v2, s[4:7], s19 offen lds
    v_mfma_f32_16x16x32_bf16 a[92:95], v[92:95], v[68:71], a[92:95]
    s_add_u32 m0, s28, 24576
    s_add_u32 s19, s16, 384
    s_add_u32 s19, s19, s29
    buffer_load_dwordx4 v2, s[4:7], s19 offen lds
    s_waitcnt vmcnt(8) lgkmcnt(0)
    s_barrier
    v_mfma_f32_16x16x32_bf16 a[0:3], v[32:35], v[16:19], a[0:3]
    v_mfma_f32_16x16x32_bf16 a[4:7], v[32:35], v[20:23], a[4:7]
    ds_read_b128 v[56:59], v5 offset:0
    v_mfma_f32_16x16x32_bf16 a[8:11], v[32:35], v[24:27], a[8:11]
    ds_read_b128 v[60:63], v5 offset:2048
    v_mfma_f32_16x16x32_bf16 a[12:15], v[32:35], v[28:31], a[12:15]
    ds_read_b128 v[64:67], v5 offset:4096
    v_mfma_f32_16x16x32_bf16 a[16:19], v[36:39], v[16:19], a[16:19]
    v_mfma_f32_16x16x32_bf16 a[20:23], v[36:39], v[20:23], a[20:23]
    ds_read_b128 v[68:71], v5 offset:6144
    v_mfma_f32_16x16x32_bf16 a[24:27], v[36:39], v[24:27], a[24:27]
    ds_read_b64_tr_b16 v[72:73], v7 offset:0
    v_mfma_f32_16x16x32_bf16 a[28:31], v[36:39], v[28:31], a[28:31]
    ds_read_b64_tr_b16 v[74:75], v7 offset:512
    v_mfma_f32_16x16x32_bf16 a[32:35], v[40:43], v[16:19], a[32:35]
    ds_read_b64_tr_b16 v[76:77], v7 offset:4096
    v_mfma_f32_16x16x32_bf16 a[36:39], v[40:43], v[20:23], a[36:39]
    v_mfma_f32_16x16x32_bf16 a[40:43], v[40:43], v[24:27], a[40:43]
    ds_read_b64_tr_b16 v[78:79], v7 offset:4608
    v_mfma_f32_16x16x32_bf16 a[44:47], v[40:43], v[28:31], a[44:47]
    ds_read_b64_tr_b16 v[80:81], v7 offset:8192
    v_mfma_f32_16x16x32_bf16 a[48:51], v[44:47], v[16:19], a[48:51]
    ds_read_b64_tr_b16 v[82:83], v7 offset:8704
    v_mfma_f32_16x16x32_bf16 a[52:55], v[44:47], v[20:23], a[52:55]
    ds_read_b64_tr_b16 v[84:85], v7 offset:12288
    v_mfma_f32_16x16x32_bf16 a[56:59], v[44:47], v[24:27], a[56:59]
    v_mfma_f32_16x16x32_bf16 a[60:63], v[44:47], v[28:31], a[60:63]
    ds_read_b64_tr_b16 v[86:87], v7 offset:12800
    v_mfma_f32_16x16x32_bf16 a[64:67], v[48:51], v[16:19], a[64:67]
    ds_read_b64_tr_b16 v[88:89], v7 offset:16384
    v_mfma_f32_16x16x32_bf16 a[68:71], v[48:51], v[20:23], a[68:71]
    ds_read_b64_tr_b16 v[90:91], v7 offset:16896
    v_mfma_f32_16x16x32_bf16 a[72:75], v[48:51], v[24:27], a[72:75]
    ds_read_b64_tr_b16 v[92:93], v7 offset:20480
    v_mfma_f32_16x16x32_bf16 a[76:79], v[48:51], v[28:31], a[76:79]
    v_mfma_f32_16x16x32_bf16 a[80:83], v[52:55], v[16:19], a[80:83]
    ds_read_b64_tr_b16 v[94:95], v7 offset:20992
    v_mfma_f32_16x16x32_bf16 a[84:87], v[52:55], v[20:23], a[84:87]
    s_add_u32 m0, s24, 32768
    s_add_u32 s19, s17, s20
    buffer_load_dwordx4 v3, s[8:11], s19 offen lds
    v_mfma_f32_16x16x32_bf16 a[88:91], v[52:55], v[24:27], a[88:91]
    s_add_u32 m0, s25, 32768
    s_add_u32 s19, s17, s21
    buffer_load_dwordx4 v3, s[8:11], s19 offen lds
    v_mfma_f32_16x16x32_bf16 a[92:95], v[52:55], v[28:31], a[92:95]
    s_add_u32 m0, s26, 32768
    s_add_u32 s19, s17, s22
    buffer_load_dwordx4 v3, s[8:11], s19 offen lds
    s_add_u32 s17, s17, s18
    s_waitcnt vmcnt(3) lgkmcnt(0)
    s_barrier
    v_mfma_f32_16x16x32_bf16 a[0:3], v[72:75], v[56:59], a[0:3]
    v_mfma_f32_16x16x32_bf16 a[4:7], v[72:75], v[60:63], a[4:7]
    ds_read_b128 v[16:19], v4 offset:16384
    v_mfma_f32_16x16x32_bf16 a[8:11], v[72:75], v[64:67], a[8:11]
    ds_read_b128 v[20:23], v4 offset:18432
    v_mfma_f32_16x16x32_bf16 a[12:15], v[72:75], v[68:71], a[12:15]
    ds_read_b128 v[24:27], v4 offset:20480
    v_mfma_f32_16x16x32_bf16 a[16:19], v[76:79], v[56:59], a[16:19]
    ds_read_b128 v[28:31], v4 offset:22528
    v_mfma_f32_16x16x32_bf16 a[20:23], v[76:79], v[60:63], a[20:23]
    ds_read_b64_tr_b16 v[32:33], v8 offset:0
    v_mfma_f32_16x16x32_bf16 a[24:27], v[76:79], v[64:67], a[24:27]
    ds_read_b64_tr_b16 v[34:35], v8 offset:512
    v_mfma_f32_16x16x32_bf16 a[28:31], v[76:79], v[68:71], a[28:31]
    ds_read_b64_tr_b16 v[36:37], v8 offset:4096
    v_mfma_f32_16x16x32_bf16 a[32:35], v[80:83], v[56:59], a[32:35]
    v_mfma_f32_16x16x32_bf16 a[36:39], v[80:83], v[60:63], a[36:39]
    ds_read_b64_tr_b16 v[38:39], v8 offset:4608
    v_mfma_f32_16x16x32_bf16 a[40:43], v[80:83], v[64:67], a[40:43]
    ds_read_b64_tr_b16 v[40:41], v8 offset:8192
    v_mfma_f32_16x16x32_bf16 a[44:47], v[80:83], v[68:71], a[44:47]
    ds_read_b64_tr_b16 v[42:43], v8 offset:8704
    v_mfma_f32_16x16x32_bf16 a[48:51], v[84:87], v[56:59], a[48:51]
    ds_read_b64_tr_b16 v[44:45], v8 offset:12288
    v_mfma_f32_16x16x32_bf16 a[52:55], v[84:87], v[60:63], a[52:55]
    ds_read_b64_tr_b16 v[46:47], v8 offset:12800
    v_mfma_f32_16x16x32_bf16 a[56:59], v[84:87], v[64:67], a[56:59]
    ds_read_b64_tr_b16 v[48:49], v8 offset:16384
    v_mfma_f32_16x16x32_bf16 a[60:63], v[84:87], v[68:71], a[60:63]
    ds_read_b64_tr_b16 v[50:51], v8 offset:16896
    v_mfma_f32_16x16x32_bf16 a[64:67], v[88:91], v[56:59], a[64:67]
    v_mfma_f32_16x16x32_bf16 a[68:71], v[88:91], v[60:63], a[68:71]
    ds_read_b64_tr_b16 v[52:53], v8 offset:20480
    v_mfma_f32_16x16x32_bf16 a[72:75], v[88:91], v[64:67], a[72:75]
    ds_read_b64_tr_b16 v[54:55], v8 offset:20992
    v_mfma_f32_16x16x32_bf16 a[76:79], v[88:91], v[68:71], a[76:79]
    s_add_u32 m0, s24, 61440
    s_add_u32 s19, s17, s20
    buffer_load_dwordx4 v3, s[8:11], s19 offen lds
    v_mfma_f32_16x16x32_bf16 a[80:83], v[92:95], v[56:59], a[80:83]
    s_add_u32 m0, s25, 61440
    s_add_u32 s19, s17, s21
    buffer_load_dwordx4 v3, s[8:11], s19 offen lds
    v_mfma_f32_16x16x32_bf16 a[84:87], v[92:95], v[60:63], a[84:87]
    s_add_u32 m0, s26, 61440
    s_add_u32 s19, s17, s22
    buffer_load_dwordx4 v3, s[8:11], s19 offen lds
    s_add_u32 s17, s17, s18
    v_mfma_f32_16x16x32_bf16 a[88:91], v[92:95], v[64:67], a[88:91]
    s_add_u32 m0, s28, 0
    s_add_u32 s19, s16, 512
    buffer_load_dwordx4 v2, s[4:7], s19 offen lds
    v_mfma_f32_16x16x32_bf16 a[92:95], v[92:95], v[68:71], a[92:95]
    s_add_u32 m0, s28, 8192
    s_add_u32 s19, s16, 512
    s_add_u32 s19, s19, s29
    buffer_load_dwordx4 v2, s[4:7], s19 offen lds
    s_waitcnt vmcnt(8) lgkmcnt(0)
    s_barrier
    v_mfma_f32_16x16x32_bf16 a[0:3], v[32:35], v[16:19], a[0:3]
    v_mfma_f32_16x16x32_bf16 a[4:7], v[32:35], v[20:23], a[4:7]
    ds_read_b128 v[56:59], v5 offset:16384
    v_mfma_f32_16x16x32_bf16 a[8:11], v[32:35], v[24:27], a[8:11]
    ds_read_b128 v[60:63], v5 offset:18432
    v_mfma_f32_16x16x32_bf16 a[12:15], v[32:35], v[28:31], a[12:15]
    ds_read_b128 v[64:67], v5 offset:20480
    v_mfma_f32_16x16x32_bf16 a[16:19], v[36:39], v[16:19], a[16:19]
    v_mfma_f32_16x16x32_bf16 a[20:23], v[36:39], v[20:23], a[20:23]
    ds_read_b128 v[68:71], v5 offset:22528
    v_mfma_f32_16x16x32_bf16 a[24:27], v[36:39], v[24:27], a[24:27]
    ds_read_b64_tr_b16 v[72:73], v9 offset:0
    v_mfma_f32_16x16x32_bf16 a[28:31], v[36:39], v[28:31], a[28:31]
    ds_read_b64_tr_b16 v[74:75], v9 offset:512
    v_mfma_f32_16x16x32_bf16 a[32:35], v[40:43], v[16:19], a[32:35]
    ds_read_b64_tr_b16 v[76:77], v9 offset:4096
    v_mfma_f32_16x16x32_bf16 a[36:39], v[40:43], v[20:23], a[36:39]
    v_mfma_f32_16x16x32_bf16 a[40:43], v[40:43], v[24:27], a[40:43]
    ds_read_b64_tr_b16 v[78:79], v9 offset:4608
    v_mfma_f32_16x16x32_bf16 a[44:47], v[40:43], v[28:31], a[44:47]
    ds_read_b64_tr_b16 v[80:81], v9 offset:8192
    v_mfma_f32_16x16x32_bf16 a[48:51], v[44:47], v[16:19], a[48:51]
    ds_read_b64_tr_b16 v[82:83], v9 offset:8704
    v_mfma_f32_16x16x32_bf16 a[52:55], v[44:47], v[20:23], a[52:55]
    ds_read_b64_tr_b16 v[84:85], v9 offset:12288
    v_mfma_f32_16x16x32_bf16 a[56:59], v[44:47], v[24:27], a[56:59]
    v_mfma_f32_16x16x32_bf16 a[60:63], v[44:47], v[28:31], a[60:63]
    ds_read_b64_tr_b16 v[86:87], v9 offset:12800
    v_mfma_f32_16x16x32_bf16 a[64:67], v[48:51], v[16:19], a[64:67]
    ds_read_b64_tr_b16 v[88:89], v9 offset:16384
    v_mfma_f32_16x16x32_bf16 a[68:71], v[48:51], v[20:23], a[68:71]
    ds_read_b64_tr_b16 v[90:91], v9 offset:16896
    v_mfma_f32_16x16x32_bf16 a[72:75], v[48:51], v[24:27], a[72:75]
    ds_read_b64_tr_b16 v[92:93], v9 offset:20480
    v_mfma_f32_16x16x32_bf16 a[76:79], v[48:51], v[28:31], a[76:79]
    v_mfma_f32_16x16x32_bf16 a[80:83], v[52:55], v[16:19], a[80:83]
    ds_read_b64_tr_b16 v[94:95], v9 offset:20992
    v_mfma_f32_16x16x32_bf16 a[84:87], v[52:55], v[20:23], a[84:87]
    s_add_u32 m0, s24, 90112
    s_add_u32 s19, s17, s20
    buffer_load_dwordx4 v3, s[8:11], s19 offen lds
    v_mfma_f32_16x16x32_bf16 a[88:91], v[52:55], v[24:27], a[88:91]
    s_add_u32 m0, s25, 90112
    s_add_u32 s19, s17, s21
    buffer_load_dwordx4 v3, s[8:11], s19 offen lds
    v_mfma_f32_16x16x32_bf16 a[92:95], v[52:55], v[28:31], a[92:95]
    s_add_u32 m0, s26, 90112
    s_add_u32 s19, s17, s22
    buffer_load_dwordx4 v3, s[8:11], s19 offen lds
    s_add_u32 s17, s17, s18
    s_waitcnt vmcnt(3) lgkmcnt(0)
    s_barrier
    v_mfma_f32_16x16x32_bf16 a[0:3], v[72:75], v[56:59], a[0:3]
    v_mfma_f32_16x16x32_bf16 a[4:7], v[72:75], v[60:63], a[4:7]
    ds_read_b128 v[16:19], v4 offset:0
    v_mfma_f32_16x16x32_bf16 a[8:11], v[72:75], v[64:67], a[8:11]
    ds_read_b128 v[20:23], v4 offset:2048
    v_mfma_f32_16x16x32_bf16 a[12:15], v[72:75], v[68:71], a[12:15]
    ds_read_b128 v[24:27], v4 offset:4096
    v_mfma_f32_16x16x32_bf16 a[16:19], v[76:79], v[56:59], a[16:19]
    ds_read_b128 v[28:31], v4 offset:6144
    v_mfma_f32_16x16x32_bf16 a[20:23], v[76:79], v[60:63], a[20:23]
    ds_read_b64_tr_b16 v[32:33], v6 offset:0
    v_mfma_f32_16x16x32_bf16 a[24:27], v[76:79], v[64:67], a[24:27]
    ds_read_b64_tr_b16 v[34:35], v6 offset:512
    v_mfma_f32_16x16x32_bf16 a[28:31], v[76:79], v[68:71], a[28:31]
    ds_read_b64_tr_b16 v[36:37], v6 offset:4096
    v_mfma_f32_16x16x32_bf16 a[32:35], v[80:83], v[56:59], a[32:35]
    v_mfma_f32_16x16x32_bf16 a[36:39], v[80:83], v[60:63], a[36:39]
    ds_read_b64_tr_b16 v[38:39], v6 offset:4608
    v_mfma_f32_16x16x32_bf16 a[40:43], v[80:83], v[64:67], a[40:43]
    ds_read_b64_tr_b16 v[40:41], v6 offset:8192
    v_mfma_f32_16x16x32_bf16 a[44:47], v[80:83], v[68:71], a[44:47]
    ds_read_b64_tr_b16 v[42:43], v6 offset:8704
    v_mfma_f32_16x16x32_bf16 a[48:51], v[84:87], v[56:59], a[48:51]
    ds_read_b64_tr_b16 v[44:45], v6 offset:12288
    v_mfma_f32_16x16x32_bf16 a[52:55], v[84:87], v[60:63], a[52:55]
    ds_read_b64_tr_b16 v[46:47], v6 offset:12800
    v_mfma_f32_16x16x32_bf16 a[56:59], v[84:87], v[64:67], a[56:59]
    ds_read_b64_tr_b16 v[48:49], v6 offset:16384
    v_mfma_f32_16x16x32_bf16 a[60:63], v[84:87], v[68:71], a[60:63]
    ds_read_b64_tr_b16 v[50:51], v6 offset:16896
    v_mfma_f32_16x16x32_bf16 a[64:67], v[88:91], v[56:59], a[64:67]
    v_mfma_f32_16x16x32_bf16 a[68:71], v[88:91], v[60:63], a[68:71]
    ds_read_b64_tr_b16 v[52:53], v6 offset:20480
    v_mfma_f32_16x16x32_bf16 a[72:75], v[88:91], v[64:67], a[72:75]
    ds_read_b64_tr_b16 v[54:55], v6 offset:20992
    v_mfma_f32_16x16x32_bf16 a[76:79], v[88:91], v[68:71], a[76:79]
    s_add_u32 m0, s24, 118784
    s_add_u32 s19, s17, s20
    buffer_load_dwordx4 v3, s[8:11], s19 offen lds
    v_mfma_f32_16x16x32_bf16 a[80:83], v[92:95], v[56:59], a[80:83]
    s_add_u32 m0, s25, 118784
    s_add_u32 s19, s17, s21
    buffer_load_dwordx4 v3, s[8:11], s19 offen lds
    v_mfma_f32_16x16x32_bf16 a[84:87], v[92:95], v[60:63], a[84:87]
    s_add_u32 m0, s26, 118784
    s_add_u32 s19, s17, s22
    buffer_load_dwordx4 v3, s[8:11], s19 offen lds
    s_add_u32 s17, s17, s18
    v_mfma_f32_16x16x32_bf16 a[88:91], v[92:95], v[64:67], a[88:91]
    s_add_u32 m0, s28, 16384
    s_add_u32 s19, s16, 640
    buffer_load_dwordx4 v2, s[4:7], s19 offen lds
    v_mfma_f32_16x16x32_bf16 a[92:95], v[92:95], v[68:71], a[92:95]
    s_add_u32 m0, s28, 24576
    s_add_u32 s19, s16, 640
    s_add_u32 s19, s19, s29
    buffer_load_dwordx4 v2, s[4:7], s19 offen lds
    s_waitcnt vmcnt(8) lgkmcnt(0)
    s_barrier
    v_mfma_f32_16x16x32_bf16 a[0:3], v[32:35], v[16:19], a[0:3]
    v_mfma_f32_16x16x32_bf16 a[4:7], v[32:35], v[20:23], a[4:7]
    ds_read_b128 v[56:59], v5 offset:0
    v_mfma_f32_16x16x32_bf16 a[8:11], v[32:35], v[24:27], a[8:11]
    ds_read_b128 v[60:63], v5 offset:2048
    v_mfma_f32_16x16x32_bf16 a[12:15], v[32:35], v[28:31], a[12:15]
    ds_read_b128 v[64:67], v5 offset:4096
    v_mfma_f32_16x16x32_bf16 a[16:19], v[36:39], v[16:19], a[16:19]
    v_mfma_f32_16x16x32_bf16 a[20:23], v[36:39], v[20:23], a[20:23]
    ds_read_b128 v[68:71], v5 offset:6144
    v_mfma_f32_16x16x32_bf16 a[24:27], v[36:39], v[24:27], a[24:27]
    ds_read_b64_tr_b16 v[72:73], v7 offset:0
    v_mfma_f32_16x16x32_bf16 a[28:31], v[36:39], v[28:31], a[28:31]
    ds_read_b64_tr_b16 v[74:75], v7 offset:512
    v_mfma_f32_16x16x32_bf16 a[32:35], v[40:43], v[16:19], a[32:35]
    ds_read_b64_tr_b16 v[76:77], v7 offset:4096
    v_mfma_f32_16x16x32_bf16 a[36:39], v[40:43], v[20:23], a[36:39]
    v_mfma_f32_16x16x32_bf16 a[40:43], v[40:43], v[24:27], a[40:43]
    ds_read_b64_tr_b16 v[78:79], v7 offset:4608
    v_mfma_f32_16x16x32_bf16 a[44:47], v[40:43], v[28:31], a[44:47]
    ds_read_b64_tr_b16 v[80:81], v7 offset:8192
    v_mfma_f32_16x16x32_bf16 a[48:51], v[44:47], v[16:19], a[48:51]
    ds_read_b64_tr_b16 v[82:83], v7 offset:8704
    v_mfma_f32_16x16x32_bf16 a[52:55], v[44:47], v[20:23], a[52:55]
    ds_read_b64_tr_b16 v[84:85], v7 offset:12288
    v_mfma_f32_16x16x32_bf16 a[56:59], v[44:47], v[24:27], a[56:59]
    v_mfma_f32_16x16x32_bf16 a[60:63], v[44:47], v[28:31], a[60:63]
    ds_read_b64_tr_b16 v[86:87], v7 offset:12800
    v_mfma_f32_16x16x32_bf16 a[64:67], v[48:51], v[16:19], a[64:67]
    ds_read_b64_tr_b16 v[88:89], v7 offset:16384
    v_mfma_f32_16x16x32_bf16 a[68:71], v[48:51], v[20:23], a[68:71]
    ds_read_b64_tr_b16 v[90:91], v7 offset:16896
    v_mfma_f32_16x16x32_bf16 a[72:75], v[48:51], v[24:27], a[72:75]
    ds_read_b64_tr_b16 v[92:93], v7 offset:20480
    v_mfma_f32_16x16x32_bf16 a[76:79], v[48:51], v[28:31], a[76:79]
    v_mfma_f32_16x16x32_bf16 a[80:83], v[52:55], v[16:19], a[80:83]
    ds_read_b64_tr_b16 v[94:95], v7 offset:20992
    v_mfma_f32_16x16x32_bf16 a[84:87], v[52:55], v[20:23], a[84:87]
    s_add_u32 m0, s24, 32768
    s_add_u32 s19, s17, s20
    buffer_load_dwordx4 v3, s[8:11], s19 offen lds
    v_mfma_f32_16x16x32_bf16 a[88:91], v[52:55], v[24:27], a[88:91]
    s_add_u32 m0, s25, 32768
    s_add_u32 s19, s17, s21
    buffer_load_dwordx4 v3, s[8:11], s19 offen lds
    v_mfma_f32_16x16x32_bf16 a[92:95], v[52:55], v[28:31], a[92:95]
    s_add_u32 m0, s26, 32768
    s_add_u32 s19, s17, s22
    buffer_load_dwordx4 v3, s[8:11], s19 offen lds
    s_add_u32 s17, s17, s18
    s_waitcnt vmcnt(3) lgkmcnt(0)
    s_barrier
    v_mfma_f32_16x16x32_bf16 a[0:3], v[72:75], v[56:59], a[0:3]
    v_mfma_f32_16x16x32_bf16 a[4:7], v[72:75], v[60:63], a[4:7]
    ds_read_b128 v[16:19], v4 offset:16384
    v_mfma_f32_16x16x32_bf16 a[8:11], v[72:75], v[64:67], a[8:11]
    ds_read_b128 v[20:23], v4 offset:18432
    v_mfma_f32_16x16x32_bf16 a[12:15], v[72:75], v[68:71], a[12:15]
    ds_read_b128 v[24:27], v4 offset:20480
    v_mfma_f32_16x16x32_bf16 a[16:19], v[76:79], v[56:59], a[16:19]
    ds_read_b128 v[28:31], v4 offset:22528
    v_mfma_f32_16x16x32_bf16 a[20:23], v[76:79], v[60:63], a[20:23]
    ds_read_b64_tr_b16 v[32:33], v8 offset:0
    v_mfma_f32_16x16x32_bf16 a[24:27], v[76:79], v[64:67], a[24:27]
    ds_read_b64_tr_b16 v[34:35], v8 offset:512
    v_mfma_f32_16x16x32_bf16 a[28:31], v[76:79], v[68:71], a[28:31]
    ds_read_b64_tr_b16 v[36:37], v8 offset:4096
    v_mfma_f32_16x16x32_bf16 a[32:35], v[80:83], v[56:59], a[32:35]
    v_mfma_f32_16x16x32_bf16 a[36:39], v[80:83], v[60:63], a[36:39]
    ds_read_b64_tr_b16 v[38:39], v8 offset:4608
    v_mfma_f32_16x16x32_bf16 a[40:43], v[80:83], v[64:67], a[40:43]
    ds_read_b64_tr_b16 v[40:41], v8 offset:8192
    v_mfma_f32_16x16x32_bf16 a[44:47], v[80:83], v[68:71], a[44:47]
    ds_read_b64_tr_b16 v[42:43], v8 offset:8704
    v_mfma_f32_16x16x32_bf16 a[48:51], v[84:87], v[56:59], a[48:51]
    ds_read_b64_tr_b16 v[44:45], v8 offset:12288
    v_mfma_f32_16x16x32_bf16 a[52:55], v[84:87], v[60:63], a[52:55]
    ds_read_b64_tr_b16 v[46:47], v8 offset:12800
    v_mfma_f32_16x16x32_bf16 a[56:59], v[84:87], v[64:67], a[56:59]
    ds_read_b64_tr_b16 v[48:49], v8 offset:16384
    v_mfma_f32_16x16x32_bf16 a[60:63], v[84:87], v[68:71], a[60:63]
    ds_read_b64_tr_b16 v[50:51], v8 offset:16896
    v_mfma_f32_16x16x32_bf16 a[64:67], v[88:91], v[56:59], a[64:67]
    v_mfma_f32_16x16x32_bf16 a[68:71], v[88:91], v[60:63], a[68:71]
    ds_read_b64_tr_b16 v[52:53], v8 offset:20480
    v_mfma_f32_16x16x32_bf16 a[72:75], v[88:91], v[64:67], a[72:75]
    ds_read_b64_tr_b16 v[54:55], v8 offset:20992
    v_mfma_f32_16x16x32_bf16 a[76:79], v[88:91], v[68:71], a[76:79]
    s_add_u32 m0, s24, 61440
    s_add_u32 s19, s17, s20
    buffer_load_dwordx4 v3, s[8:11], s19 offen lds
    v_mfma_f32_16x16x32_bf16 a[80:83], v[92:95], v[56:59], a[80:83]
    s_add_u32 m0, s25, 61440
    s_add_u32 s19, s17, s21
    buffer_load_dwordx4 v3, s[8:11], s19 offen lds
    v_mfma_f32_16x16x32_bf16 a[84:87], v[92:95], v[60:63], a[84:87]
    s_add_u32 m0, s26, 61440
    s_add_u32 s19, s17, s22
    buffer_load_dwordx4 v3, s[8:11], s19 offen lds
    s_add_u32 s17, s17, s18
    v_mfma_f32_16x16x32_bf16 a[88:91], v[92:95], v[64:67], a[88:91]
    s_add_u32 m0, s28, 0
    s_add_u32 s19, s16, 768
    buffer_load_dwordx4 v2, s[4:7], s19 offen lds
    v_mfma_f32_16x16x32_bf16 a[92:95], v[92:95], v[68:71], a[92:95]
    s_add_u32 m0, s28, 8192
    s_add_u32 s19, s16, 768
    s_add_u32 s19, s19, s29
    buffer_load_dwordx4 v2, s[4:7], s19 offen lds
    s_waitcnt vmcnt(8) lgkmcnt(0)
    s_barrier
    v_mfma_f32_16x16x32_bf16 a[0:3], v[32:35], v[16:19], a[0:3]
    v_mfma_f32_16x16x32_bf16 a[4:7], v[32:35], v[20:23], a[4:7]
    ds_read_b128 v[56:59], v5 offset:16384
    v_mfma_f32_16x16x32_bf16 a[8:11], v[32:35], v[24:27], a[8:11]
    ds_read_b128 v[60:63], v5 offset:18432
    v_mfma_f32_16x16x32_bf16 a[12:15], v[32:35], v[28:31], a[12:15]
    ds_read_b128 v[64:67], v5 offset:20480
    v_mfma_f32_16x16x32_bf16 a[16:19], v[36:39], v[16:19], a[16:19]
    v_mfma_f32_16x16x32_bf16 a[20:23], v[36:39], v[20:23], a[20:23]
    ds_read_b128 v[68:71], v5 offset:22528
    v_mfma_f32_16x16x32_bf16 a[24:27], v[36:39], v[24:27], a[24:27]
    ds_read_b64_tr_b16 v[72:73], v9 offset:0
    v_mfma_f32_16x16x32_bf16 a[28:31], v[36:39], v[28:31], a[28:31]
    ds_read_b64_tr_b16 v[74:75], v9 offset:512
    v_mfma_f32_16x16x32_bf16 a[32:35], v[40:43], v[16:19], a[32:35]
    ds_read_b64_tr_b16 v[76:77], v9 offset:4096
    v_mfma_f32_16x16x32_bf16 a[36:39], v[40:43], v[20:23], a[36:39]
    v_mfma_f32_16x16x32_bf16 a[40:43], v[40:43], v[24:27], a[40:43]
    ds_read_b64_tr_b16 v[78:79], v9 offset:4608
    v_mfma_f32_16x16x32_bf16 a[44:47], v[40:43], v[28:31], a[44:47]
    ds_read_b64_tr_b16 v[80:81], v9 offset:8192
    v_mfma_f32_16x16x32_bf16 a[48:51], v[44:47], v[16:19], a[48:51]
    ds_read_b64_tr_b16 v[82:83], v9 offset:8704
    v_mfma_f32_16x16x32_bf16 a[52:55], v[44:47], v[20:23], a[52:55]
    ds_read_b64_tr_b16 v[84:85], v9 offset:12288
    v_mfma_f32_16x16x32_bf16 a[56:59], v[44:47], v[24:27], a[56:59]
    v_mfma_f32_16x16x32_bf16 a[60:63], v[44:47], v[28:31], a[60:63]
    ds_read_b64_tr_b16 v[86:87], v9 offset:12800
    v_mfma_f32_16x16x32_bf16 a[64:67], v[48:51], v[16:19], a[64:67]
    ds_read_b64_tr_b16 v[88:89], v9 offset:16384
    v_mfma_f32_16x16x32_bf16 a[68:71], v[48:51], v[20:23], a[68:71]
    ds_read_b64_tr_b16 v[90:91], v9 offset:16896
    v_mfma_f32_16x16x32_bf16 a[72:75], v[48:51], v[24:27], a[72:75]
    ds_read_b64_tr_b16 v[92:93], v9 offset:20480
    v_mfma_f32_16x16x32_bf16 a[76:79], v[48:51], v[28:31], a[76:79]
    v_mfma_f32_16x16x32_bf16 a[80:83], v[52:55], v[16:19], a[80:83]
    ds_read_b64_tr_b16 v[94:95], v9 offset:20992
    v_mfma_f32_16x16x32_bf16 a[84:87], v[52:55], v[20:23], a[84:87]
    s_add_u32 m0, s24, 90112
    s_add_u32 s19, s17, s20
    buffer_load_dwordx4 v3, s[8:11], s19 offen lds
    v_mfma_f32_16x16x32_bf16 a[88:91], v[52:55], v[24:27], a[88:91]
    s_add_u32 m0, s25, 90112
    s_add_u32 s19, s17, s21
    buffer_load_dwordx4 v3, s[8:11], s19 offen lds
    v_mfma_f32_16x16x32_bf16 a[92:95], v[52:55], v[28:31], a[92:95]
    s_add_u32 m0, s26, 90112
    s_add_u32 s19, s17, s22
    buffer_load_dwordx4 v3, s[8:11], s19 offen lds
    s_add_u32 s17, s17, s18
    s_waitcnt vmcnt(3) lgkmcnt(0)
    s_barrier
    v_mfma_f32_16x16x32_bf16 a[0:3], v[72:75], v[56:59], a[0:3]
    v_mfma_f32_16x16x32_bf16 a[4:7], v[72:75], v[60:63], a[4:7]
    ds_read_b128 v[16:19], v4 offset:0
    v_mfma_f32_16x16x32_bf16 a[8:11], v[72:75], v[64:67], a[8:11]
    ds_read_b128 v[20:23], v4 offset:2048
    v_mfma_f32_16x16x32_bf16 a[12:15], v[72:75], v[68:71], a[12:15]
    ds_read_b128 v[24:27], v4 offset:4096
    v_mfma_f32_16x16x32_bf16 a[16:19], v[76:79], v[56:59], a[16:19]
    ds_read_b128 v[28:31], v4 offset:6144
    v_mfma_f32_16x16x32_bf16 a[20:23], v[76:79], v[60:63], a[20:23]
    ds_read_b64_tr_b16 v[32:33], v6 offset:0
    v_mfma_f32_16x16x32_bf16 a[24:27], v[76:79], v[64:67], a[24:27]
    ds_read_b64_tr_b16 v[34:35], v6 offset:512
    v_mfma_f32_16x16x32_bf16 a[28:31], v[76:79], v[68:71], a[28:31]
    ds_read_b64_tr_b16 v[36:37], v6 offset:4096
    v_mfma_f32_16x16x32_bf16 a[32:35], v[80:83], v[56:59], a[32:35]
    v_mfma_f32_16x16x32_bf16 a[36:39], v[80:83], v[60:63], a[36:39]
    ds_read_b64_tr_b16 v[38:39], v6 offset:4608
    v_mfma_f32_16x16x32_bf16 a[40:43], v[80:83], v[64:67], a[40:43]
    ds_read_b64_tr_b16 v[40:41], v6 offset:8192
    v_mfma_f32_16x16x32_bf16 a[44:47], v[80:83], v[68:71], a[44:47]
    ds_read_b64_tr_b16 v[42:43], v6 offset:8704
    v_mfma_f32_16x16x32_bf16 a[48:51], v[84:87], v[56:59], a[48:51]
    ds_read_b64_tr_b16 v[44:45], v6 offset:12288
    v_mfma_f32_16x16x32_bf16 a[52:55], v[84:87], v[60:63], a[52:55]
    ds_read_b64_tr_b16 v[46:47], v6 offset:12800
    v_mfma_f32_16x16x32_bf16 a[56:59], v[84:87], v[64:67], a[56:59]
    ds_read_b64_tr_b16 v[48:49], v6 offset:16384
    v_mfma_f32_16x16x32_bf16 a[60:63], v[84:87], v[68:71], a[60:63]
    ds_read_b64_tr_b16 v[50:51], v6 offset:16896
    v_mfma_f32_16x16x32_bf16 a[64:67], v[88:91], v[56:59], a[64:67]
    v_mfma_f32_16x16x32_bf16 a[68:71], v[88:91], v[60:63], a[68:71]
    ds_read_b64_tr_b16 v[52:53], v6 offset:20480
    v_mfma_f32_16x16x32_bf16 a[72:75], v[88:91], v[64:67], a[72:75]
    ds_read_b64_tr_b16 v[54:55], v6 offset:20992
    v_mfma_f32_16x16x32_bf16 a[76:79], v[88:91], v[68:71], a[76:79]
    s_add_u32 m0, s24, 118784
    s_add_u32 s19, s17, s20
    buffer_load_dwordx4 v3, s[8:11], s19 offen lds
    v_mfma_f32_16x16x32_bf16 a[80:83], v[92:95], v[56:59], a[80:83]
    s_add_u32 m0, s25, 118784
    s_add_u32 s19, s17, s21
    buffer_load_dwordx4 v3, s[8:11], s19 offen lds
    v_mfma_f32_16x16x32_bf16 a[84:87], v[92:95], v[60:63], a[84:87]
    s_add_u32 m0, s26, 118784
    s_add_u32 s19, s17, s22
    buffer_load_dwordx4 v3, s[8:11], s19 offen lds
    s_add_u32 s17, s17, s18
    v_mfma_f32_16x16x32_bf16 a[88:91], v[92:95], v[64:67], a[88:91]
    s_add_u32 m0, s28, 16384
    s_add_u32 s19, s16, 896
    buffer_load_dwordx4 v2, s[4:7], s19 offen lds
    v_mfma_f32_16x16x32_bf16 a[92:95], v[92:95], v[68:71], a[92:95]
    s_add_u32 m0, s28, 24576
    s_add_u32 s19, s16, 896
    s_add_u32 s19, s19, s29
    buffer_load_dwordx4 v2, s[4:7], s19 offen lds
    s_waitcnt vmcnt(8) lgkmcnt(0)
    s_barrier
    v_mfma_f32_16x16x32_bf16 a[0:3], v[32:35], v[16:19], a[0:3]
    v_mfma_f32_16x16x32_bf16 a[4:7], v[32:35], v[20:23], a[4:7]
    ds_read_b128 v[56:59], v5 offset:0
    v_mfma_f32_16x16x32_bf16 a[8:11], v[32:35], v[24:27], a[8:11]
    ds_read_b128 v[60:63], v5 offset:2048
    v_mfma_f32_16x16x32_bf16 a[12:15], v[32:35], v[28:31], a[12:15]
    ds_read_b128 v[64:67], v5 offset:4096
    v_mfma_f32_16x16x32_bf16 a[16:19], v[36:39], v[16:19], a[16:19]
    v_mfma_f32_16x16x32_bf16 a[20:23], v[36:39], v[20:23], a[20:23]
    ds_read_b128 v[68:71], v5 offset:6144
    v_mfma_f32_16x16x32_bf16 a[24:27], v[36:39], v[24:27], a[24:27]
    ds_read_b64_tr_b16 v[72:73], v7 offset:0
    v_mfma_f32_16x16x32_bf16 a[28:31], v[36:39], v[28:31], a[28:31]
    ds_read_b64_tr_b16 v[74:75], v7 offset:512
    v_mfma_f32_16x16x32_bf16 a[32:35], v[40:43], v[16:19], a[32:35]
    ds_read_b64_tr_b16 v[76:77], v7 offset:4096
    v_mfma_f32_16x16x32_bf16 a[36:39], v[40:43], v[20:23], a[36:39]
    v_mfma_f32_16x16x32_bf16 a[40:43], v[40:43], v[24:27], a[40:43]
    ds_read_b64_tr_b16 v[78:79], v7 offset:4608
    v_mfma_f32_16x16x32_bf16 a[44:47], v[40:43], v[28:31], a[44:47]
    ds_read_b64_tr_b16 v[80:81], v7 offset:8192
    v_mfma_f32_16x16x32_bf16 a[48:51], v[44:47], v[16:19], a[48:51]
    ds_read_b64_tr_b16 v[82:83], v7 offset:8704
    v_mfma_f32_16x16x32_bf16 a[52:55], v[44:47], v[20:23], a[52:55]
    ds_read_b64_tr_b16 v[84:85], v7 offset:12288
    v_mfma_f32_16x16x32_bf16 a[56:59], v[44:47], v[24:27], a[56:59]
    v_mfma_f32_16x16x32_bf16 a[60:63], v[44:47], v[28:31], a[60:63]
    ds_read_b64_tr_b16 v[86:87], v7 offset:12800
    v_mfma_f32_16x16x32_bf16 a[64:67], v[48:51], v[16:19], a[64:67]
    ds_read_b64_tr_b16 v[88:89], v7 offset:16384
    v_mfma_f32_16x16x32_bf16 a[68:71], v[48:51], v[20:23], a[68:71]
    ds_read_b64_tr_b16 v[90:91], v7 offset:16896
    v_mfma_f32_16x16x32_bf16 a[72:75], v[48:51], v[24:27], a[72:75]
    ds_read_b64_tr_b16 v[92:93], v7 offset:20480
    v_mfma_f32_16x16x32_bf16 a[76:79], v[48:51], v[28:31], a[76:79]
    v_mfma_f32_16x16x32_bf16 a[80:83], v[52:55], v[16:19], a[80:83]
    ds_read_b64_tr_b16 v[94:95], v7 offset:20992
    v_mfma_f32_16x16x32_bf16 a[84:87], v[52:55], v[20:23], a[84:87]
    s_add_u32 m0, s24, 32768
    s_add_u32 s19, s17, s20
    buffer_load_dwordx4 v3, s[8:11], s19 offen lds
    v_mfma_f32_16x16x32_bf16 a[88:91], v[52:55], v[24:27], a[88:91]
    s_add_u32 m0, s25, 32768
    s_add_u32 s19, s17, s21
    buffer_load_dwordx4 v3, s[8:11], s19 offen lds
    v_mfma_f32_16x16x32_bf16 a[92:95], v[52:55], v[28:31], a[92:95]
    s_add_u32 m0, s26, 32768
    s_add_u32 s19, s17, s22
    buffer_load_dwordx4 v3, s[8:11], s19 offen lds
    s_add_u32 s17, s17, s18
    s_waitcnt vmcnt(3) lgkmcnt(0)
    s_barrier
    v_mfma_f32_16x16x32_bf16 a[0:3], v[72:75], v[56:59], a[0:3]
    v_mfma_f32_16x16x32_bf16 a[4:7], v[72:75], v[60:63], a[4:7]
    ds_read_b128 v[16:19], v4 offset:16384
    v_mfma_f32_16x16x32_bf16 a[8:11], v[72:75], v[64:67], a[8:11]
    ds_read_b128 v[20:23], v4 offset:18432
    v_mfma_f32_16x16x32_bf16 a[12:15], v[72:75], v[68:71], a[12:15]
    ds_read_b128 v[24:27], v4 offset:20480
    v_mfma_f32_16x16x32_bf16 a[16:19], v[76:79], v[56:59], a[16:19]
    ds_read_b128 v[28:31], v4 offset:22528
    v_mfma_f32_16x16x32_bf16 a[20:23], v[76:79], v[60:63], a[20:23]
    ds_read_b64_tr_b16 v[32:33], v8 offset:0
    v_mfma_f32_16x16x32_bf16 a[24:27], v[76:79], v[64:67], a[24:27]
    ds_read_b64_tr_b16 v[34:35], v8 offset:512
    v_mfma_f32_16x16x32_bf16 a[28:31], v[76:79], v[68:71], a[28:31]
    ds_read_b64_tr_b16 v[36:37], v8 offset:4096
    v_mfma_f32_16x16x32_bf16 a[32:35], v[80:83], v[56:59], a[32:35]
    v_mfma_f32_16x16x32_bf16 a[36:39], v[80:83], v[60:63], a[36:39]
    ds_read_b64_tr_b16 v[38:39], v8 offset:4608
    v_mfma_f32_16x16x32_bf16 a[40:43], v[80:83], v[64:67], a[40:43]
    ds_read_b64_tr_b16 v[40:41], v8 offset:8192
    v_mfma_f32_16x16x32_bf16 a[44:47], v[80:83], v[68:71], a[44:47]
    ds_read_b64_tr_b16 v[42:43], v8 offset:8704
    v_mfma_f32_16x16x32_bf16 a[48:51], v[84:87], v[56:59], a[48:51]
    ds_read_b64_tr_b16 v[44:45], v8 offset:12288
    v_mfma_f32_16x16x32_bf16 a[52:55], v[84:87], v[60:63], a[52:55]
    ds_read_b64_tr_b16 v[46:47], v8 offset:12800
    v_mfma_f32_16x16x32_bf16 a[56:59], v[84:87], v[64:67], a[56:59]
    ds_read_b64_tr_b16 v[48:49], v8 offset:16384
    v_mfma_f32_16x16x32_bf16 a[60:63], v[84:87], v[68:71], a[60:63]
    ds_read_b64_tr_b16 v[50:51], v8 offset:16896
    v_mfma_f32_16x16x32_bf16 a[64:67], v[88:91], v[56:59], a[64:67]
    v_mfma_f32_16x16x32_bf16 a[68:71], v[88:91], v[60:63], a[68:71]
    ds_read_b64_tr_b16 v[52:53], v8 offset:20480
    v_mfma_f32_16x16x32_bf16 a[72:75], v[88:91], v[64:67], a[72:75]
    ds_read_b64_tr_b16 v[54:55], v8 offset:20992
    v_mfma_f32_16x16x32_bf16 a[76:79], v[88:91], v[68:71], a[76:79]
    s_add_u32 m0, s24, 61440
    s_add_u32 s19, s17, s20
    buffer_load_dwordx4 v3, s[8:11], s19 offen lds
    v_mfma_f32_16x16x32_bf16 a[80:83], v[92:95], v[56:59], a[80:83]
    s_add_u32 m0, s25, 61440
    s_add_u32 s19, s17, s21
    buffer_load_dwordx4 v3, s[8:11], s19 offen lds
    v_mfma_f32_16x16x32_bf16 a[84:87], v[92:95], v[60:63], a[84:87]
    s_add_u32 m0, s26, 61440
    s_add_u32 s19, s17, s22
    buffer_load_dwordx4 v3, s[8:11], s19 offen lds
    s_add_u32 s17, s17, s18
    v_mfma_f32_16x16x32_bf16 a[88:91], v[92:95], v[64:67], a[88:91]
    s_add_u32 m0, s28, 0
    s_add_u32 s19, s16, 1024
    buffer_load_dwordx4 v2, s[4:7], s19 offen lds
    v_mfma_f32_16x16x32_bf16 a[92:95], v[92:95], v[68:71], a[92:95]
    s_add_u32 m0, s28, 8192
    s_add_u32 s19, s16, 1024
    s_add_u32 s19, s19, s29
    buffer_load_dwordx4 v2, s[4:7], s19 offen lds
    s_waitcnt vmcnt(8) lgkmcnt(0)
    s_barrier
    v_mfma_f32_16x16x32_bf16 a[0:3], v[32:35], v[16:19], a[0:3]
    v_mfma_f32_16x16x32_bf16 a[4:7], v[32:35], v[20:23], a[4:7]
    ds_read_b128 v[56:59], v5 offset:16384
    v_mfma_f32_16x16x32_bf16 a[8:11], v[32:35], v[24:27], a[8:11]
    ds_read_b128 v[60:63], v5 offset:18432
    v_mfma_f32_16x16x32_bf16 a[12:15], v[32:35], v[28:31], a[12:15]
    v_mfma_f32_16x16x32_bf16 a[16:19], v[36:39], v[16:19], a[16:19]
    ds_read_b128 v[64:67], v5 offset:20480
    v_mfma_f32_16x16x32_bf16 a[20:23], v[36:39], v[20:23], a[20:23]
    ds_read_b128 v[68:71], v5 offset:22528
    v_mfma_f32_16x16x32_bf16 a[24:27], v[36:39], v[24:27], a[24:27]
    v_mfma_f32_16x16x32_bf16 a[28:31], v[36:39], v[28:31], a[28:31]
    ds_read_b64_tr_b16 v[72:73], v9 offset:0
    v_mfma_f32_16x16x32_bf16 a[32:35], v[40:43], v[16:19], a[32:35]
    ds_read_b64_tr_b16 v[74:75], v9 offset:512
    v_mfma_f32_16x16x32_bf16 a[36:39], v[40:43], v[20:23], a[36:39]
    v_mfma_f32_16x16x32_bf16 a[40:43], v[40:43], v[24:27], a[40:43]
    ds_read_b64_tr_b16 v[76:77], v9 offset:4096
    v_mfma_f32_16x16x32_bf16 a[44:47], v[40:43], v[28:31], a[44:47]
    ds_read_b64_tr_b16 v[78:79], v9 offset:4608
    v_mfma_f32_16x16x32_bf16 a[48:51], v[44:47], v[16:19], a[48:51]
    v_mfma_f32_16x16x32_bf16 a[52:55], v[44:47], v[20:23], a[52:55]
    ds_read_b64_tr_b16 v[80:81], v9 offset:8192
    v_mfma_f32_16x16x32_bf16 a[56:59], v[44:47], v[24:27], a[56:59]
    ds_read_b64_tr_b16 v[82:83], v9 offset:8704
    v_mfma_f32_16x16x32_bf16 a[60:63], v[44:47], v[28:31], a[60:63]
    v_mfma_f32_16x16x32_bf16 a[64:67], v[48:51], v[16:19], a[64:67]
    ds_read_b64_tr_b16 v[84:85], v9 offset:12288
    v_mfma_f32_16x16x32_bf16 a[68:71], v[48:51], v[20:23], a[68:71]
    ds_read_b64_tr_b16 v[86:87], v9 offset:12800
    v_mfma_f32_16x16x32_bf16 a[72:75], v[48:51], v[24:27], a[72:75]
    v_mfma_f32_16x16x32_bf16 a[76:79], v[48:51], v[28:31], a[76:79]
    ds_read_b64_tr_b16 v[88:89], v9 offset:16384
    v_mfma_f32_16x16x32_bf16 a[80:83], v[52:55], v[16:19], a[80:83]
    ds_read_b64_tr_b16 v[90:91], v9 offset:16896
    v_mfma_f32_16x16x32_bf16 a[84:87], v[52:55], v[20:23], a[84:87]
    v_mfma_f32_16x16x32_bf16 a[88:91], v[52:55], v[24:27], a[88:91]
    ds_read_b64_tr_b16 v[92:93], v9 offset:20480
    v_mfma_f32_16x16x32_bf16 a[92:95], v[52:55], v[28:31], a[92:95]
    ds_read_b64_tr_b16 v[94:95], v9 offset:20992
    s_waitcnt vmcnt(0) lgkmcnt(0)
    s_barrier
    v_mfma_f32_16x16x32_bf16 a[0:3], v[72:75], v[56:59], a[0:3]
    v_mfma_f32_16x16x32_bf16 a[4:7], v[72:75], v[60:63], a[4:7]
    ds_read_b128 v[16:19], v4 offset:0
    v_mfma_f32_16x16x32_bf16 a[8:11], v[72:75], v[64:67], a[8:11]
    ds_read_b128 v[20:23], v4 offset:2048
    v_mfma_f32_16x16x32_bf16 a[12:15], v[72:75], v[68:71], a[12:15]
    v_mfma_f32_16x16x32_bf16 a[16:19], v[76:79], v[56:59], a[16:19]
    ds_read_b128 v[24:27], v4 offset:4096
    v_mfma_f32_16x16x32_bf16 a[20:23], v[76:79], v[60:63], a[20:23]
    ds_read_b128 v[28:31], v4 offset:6144
    v_mfma_f32_16x16x32_bf16 a[24:27], v[76:79], v[64:67], a[24:27]
    v_mfma_f32_16x16x32_bf16 a[28:31], v[76:79], v[68:71], a[28:31]
    ds_read_b64_tr_b16 v[32:33], v6 offset:0
    v_mfma_f32_16x16x32_bf16 a[32:35], v[80:83], v[56:59], a[32:35]
    ds_read_b64_tr_b16 v[34:35], v6 offset:512
    v_mfma_f32_16x16x32_bf16 a[36:39], v[80:83], v[60:63], a[36:39]
    v_mfma_f32_16x16x32_bf16 a[40:43], v[80:83], v[64:67], a[40:43]
    ds_read_b64_tr_b16 v[36:37], v6 offset:4096
    v_mfma_f32_16x16x32_bf16 a[44:47], v[80:83], v[68:71], a[44:47]
    ds_read_b64_tr_b16 v[38:39], v6 offset:4608
    v_mfma_f32_16x16x32_bf16 a[48:51], v[84:87], v[56:59], a[48:51]
    v_mfma_f32_16x16x32_bf16 a[52:55], v[84:87], v[60:63], a[52:55]
    ds_read_b64_tr_b16 v[40:41], v6 offset:8192
    v_mfma_f32_16x16x32_bf16 a[56:59], v[84:87], v[64:67], a[56:59]
    ds_read_b64_tr_b16 v[42:43], v6 offset:8704
    v_mfma_f32_16x16x32_bf16 a[60:63], v[84:87], v[68:71], a[60:63]
    v_mfma_f32_16x16x32_bf16 a[64:67], v[88:91], v[56:59], a[64:67]
    ds_read_b64_tr_b16 v[44:45], v6 offset:12288
    v_mfma_f32_16x16x32_bf16 a[68:71], v[88:91], v[60:63], a[68:71]
    ds_read_b64_tr_b16 v[46:47], v6 offset:12800
    v_mfma_f32_16x16x32_bf16 a[72:75], v[88:91], v[64:67], a[72:75]
    v_mfma_f32_16x16x32_bf16 a[76:79], v[88:91], v[68:71], a[76:79]
    ds_read_b64_tr_b16 v[48:49], v6 offset:16384
    v_mfma_f32_16x16x32_bf16 a[80:83], v[92:95], v[56:59], a[80:83]
    ds_read_b64_tr_b16 v[50:51], v6 offset:16896
    v_mfma_f32_16x16x32_bf16 a[84:87], v[92:95], v[60:63], a[84:87]
    v_mfma_f32_16x16x32_bf16 a[88:91], v[92:95], v[64:67], a[88:91]
    ds_read_b64_tr_b16 v[52:53], v6 offset:20480
    v_mfma_f32_16x16x32_bf16 a[92:95], v[92:95], v[68:71], a[92:95]
    ds_read_b64_tr_b16 v[54:55], v6 offset:20992
    s_waitcnt vmcnt(0) lgkmcnt(0)
    s_barrier
    v_mfma_f32_16x16x32_bf16 a[0:3], v[32:35], v[16:19], a[0:3]
    v_mfma_f32_16x16x32_bf16 a[4:7], v[32:35], v[20:23], a[4:7]
    ds_read_b128 v[56:59], v5 offset:0
    v_mfma_f32_16x16x32_bf16 a[8:11], v[32:35], v[24:27], a[8:11]
    ds_read_b128 v[60:63], v5 offset:2048
    v_mfma_f32_16x16x32_bf16 a[12:15], v[32:35], v[28:31], a[12:15]
    v_mfma_f32_16x16x32_bf16 a[16:19], v[36:39], v[16:19], a[16:19]
    ds_read_b128 v[64:67], v5 offset:4096
    v_mfma_f32_16x16x32_bf16 a[20:23], v[36:39], v[20:23], a[20:23]
    ds_read_b128 v[68:71], v5 offset:6144
    v_mfma_f32_16x16x32_bf16 a[24:27], v[36:39], v[24:27], a[24:27]
    v_mfma_f32_16x16x32_bf16 a[28:31], v[36:39], v[28:31], a[28:31]
    ds_read_b64_tr_b16 v[72:73], v7 offset:0
    v_mfma_f32_16x16x32_bf16 a[32:35], v[40:43], v[16:19], a[32:35]
    ds_read_b64_tr_b16 v[74:75], v7 offset:512
    v_mfma_f32_16x16x32_bf16 a[36:39], v[40:43], v[20:23], a[36:39]
    v_mfma_f32_16x16x32_bf16 a[40:43], v[40:43], v[24:27], a[40:43]
    ds_read_b64_tr_b16 v[76:77], v7 offset:4096
    v_mfma_f32_16x16x32_bf16 a[44:47], v[40:43], v[28:31], a[44:47]
    ds_read_b64_tr_b16 v[78:79], v7 offset:4608
    v_mfma_f32_16x16x32_bf16 a[48:51], v[44:47], v[16:19], a[48:51]
    v_mfma_f32_16x16x32_bf16 a[52:55], v[44:47], v[20:23], a[52:55]
    ds_read_b64_tr_b16 v[80:81], v7 offset:8192
    v_mfma_f32_16x16x32_bf16 a[56:59], v[44:47], v[24:27], a[56:59]
    ds_read_b64_tr_b16 v[82:83], v7 offset:8704
    v_mfma_f32_16x16x32_bf16 a[60:63], v[44:47], v[28:31], a[60:63]
    v_mfma_f32_16x16x32_bf16 a[64:67], v[48:51], v[16:19], a[64:67]
    ds_read_b64_tr_b16 v[84:85], v7 offset:12288
    v_mfma_f32_16x16x32_bf16 a[68:71], v[48:51], v[20:23], a[68:71]
    ds_read_b64_tr_b16 v[86:87], v7 offset:12800
    v_mfma_f32_16x16x32_bf16 a[72:75], v[48:51], v[24:27], a[72:75]
    v_mfma_f32_16x16x32_bf16 a[76:79], v[48:51], v[28:31], a[76:79]
    ds_read_b64_tr_b16 v[88:89], v7 offset:16384
    v_mfma_f32_16x16x32_bf16 a[80:83], v[52:55], v[16:19], a[80:83]
    ds_read_b64_tr_b16 v[90:91], v7 offset:16896
    v_mfma_f32_16x16x32_bf16 a[84:87], v[52:55], v[20:23], a[84:87]
    v_mfma_f32_16x16x32_bf16 a[88:91], v[52:55], v[24:27], a[88:91]
    ds_read_b64_tr_b16 v[92:93], v7 offset:20480
    v_mfma_f32_16x16x32_bf16 a[92:95], v[52:55], v[28:31], a[92:95]
    ds_read_b64_tr_b16 v[94:95], v7 offset:20992
    s_waitcnt vmcnt(0) lgkmcnt(0)
    s_barrier
    v_mfma_f32_16x16x32_bf16 a[0:3], v[72:75], v[56:59], a[0:3]
    v_mfma_f32_16x16x32_bf16 a[4:7], v[72:75], v[60:63], a[4:7]
    v_mfma_f32_16x16x32_bf16 a[8:11], v[72:75], v[64:67], a[8:11]
    v_mfma_f32_16x16x32_bf16 a[12:15], v[72:75], v[68:71], a[12:15]
    v_mfma_f32_16x16x32_bf16 a[16:19], v[76:79], v[56:59], a[16:19]
    v_mfma_f32_16x16x32_bf16 a[20:23], v[76:79], v[60:63], a[20:23]
    v_mfma_f32_16x16x32_bf16 a[24:27], v[76:79], v[64:67], a[24:27]
    v_mfma_f32_16x16x32_bf16 a[28:31], v[76:79], v[68:71], a[28:31]
    v_mfma_f32_16x16x32_bf16 a[32:35], v[80:83], v[56:59], a[32:35]
    v_mfma_f32_16x16x32_bf16 a[36:39], v[80:83], v[60:63], a[36:39]
    v_mfma_f32_16x16x32_bf16 a[40:43], v[80:83], v[64:67], a[40:43]
    v_mfma_f32_16x16x32_bf16 a[44:47], v[80:83], v[68:71], a[44:47]
    v_mfma_f32_16x16x32_bf16 a[48:51], v[84:87], v[56:59], a[48:51]
    v_mfma_f32_16x16x32_bf16 a[52:55], v[84:87], v[60:63], a[52:55]
    v_mfma_f32_16x16x32_bf16 a[56:59], v[84:87], v[64:67], a[56:59]
    v_mfma_f32_16x16x32_bf16 a[60:63], v[84:87], v[68:71], a[60:63]
    v_mfma_f32_16x16x32_bf16 a[64:67], v[88:91], v[56:59], a[64:67]
    v_mfma_f32_16x16x32_bf16 a[68:71], v[88:91], v[60:63], a[68:71]
    v_mfma_f32_16x16x32_bf16 a[72:75], v[88:91], v[64:67], a[72:75]
    v_mfma_f32_16x16x32_bf16 a[76:79], v[88:91], v[68:71], a[76:79]
    v_mfma_f32_16x16x32_bf16 a[80:83], v[92:95], v[56:59], a[80:83]
    v_mfma_f32_16x16x32_bf16 a[84:87], v[92:95], v[60:63], a[84:87]
    v_mfma_f32_16x16x32_bf16 a[88:91], v[92:95], v[64:67], a[88:91]
    v_mfma_f32_16x16x32_bf16 a[92:95], v[92:95], v[68:71], a[92:95]
    s_mov_b32 s52, 6
L_g1_epi:
    s_waitcnt lgkmcnt(0)
    s_barrier
    v_and_b32 v10, 15, v1
    s_lshr_b32 s31, s30, 2
    s_lshl_b32 s31, s31, 6
    v_add_u32 v10, s31, v10
    v_mul_u32_u24 v10, 912, v10
    v_lshrrev_b32 v11, 4, v1
    v_lshl_add_u32 v10, v11, 3, v10
    s_and_b32 s31, s30, 3
    s_lshl_b32 s31, s31, 5
    v_add_u32 v10, s31, v10
    s_mov_b32 s56, 0xbfb8aa3b
    s_mov_b32 s57, 0xbfb8aa3b
    s_cmp_eq_u32 s51, 0
    s_cbranch_scc0 L_g1_silu
    v_accvgpr_read_b32 v16, a0
    v_accvgpr_read_b32 v17, a1
    v_accvgpr_read_b32 v18, a2
    v_accvgpr_read_b32 v19, a3
    v_cvt_pk_bf16_f32 v20, v16, v17
    v_cvt_pk_bf16_f32 v21, v18, v19
    ds_write_b64 v10, v[20:21] offset:0
    v_accvgpr_read_b32 v24, a16
    v_accvgpr_read_b32 v25, a17
    v_accvgpr_read_b32 v26, a18
    v_accvgpr_read_b32 v27, a19
    v_cvt_pk_bf16_f32 v28, v24, v25
    v_cvt_pk_bf16_f32 v29, v26, v27
    ds_write_b64 v10, v[28:29] offset:128
    v_accvgpr_read_b32 v16, a32
    v_accvgpr_read_b32 v17, a33
    v_accvgpr_read_b32 v18, a34
    v_accvgpr_read_b32 v19, a35
    v_cvt_pk_bf16_f32 v20, v16, v17
    v_cvt_pk_bf16_f32 v21, v18, v19
    ds_write_b64 v10, v[20:21] offset:256
    v_accvgpr_read_b32 v24, a48
    v_accvgpr_read_b32 v25, a49
    v_accvgpr_read_b32 v26, a50
    v_accvgpr_read_b32 v27, a51
    v_cvt_pk_bf16_f32 v28, v24, v25
    v_cvt_pk_bf16_f32 v29, v26, v27
    ds_write_b64 v10, v[28:29] offset:384
    v_accvgpr_read_b32 v16, a64
    v_accvgpr_read_b32 v17, a65
    v_accvgpr_read_b32 v18, a66
    v_accvgpr_read_b32 v19, a67
    v_cvt_pk_bf16_f32 v20, v16, v17
    v_cvt_pk_bf16_f32 v21, v18, v19
    ds_write_b64 v10, v[20:21] offset:512
    v_accvgpr_read_b32 v24, a80
    v_accvgpr_read_b32 v25, a81
    v_accvgpr_read_b32 v26, a82
    v_accvgpr_read_b32 v27, a83
    v_cvt_pk_bf16_f32 v28, v24, v25
    v_cvt_pk_bf16_f32 v29, v26, v27
    ds_write_b64 v10, v[28:29] offset:640
    s_cmp_lt_u32 s52, 7
    s_cbranch_scc1 L_g1_skip0_0
    v_accvgpr_read_b32 v16, a96
    v_accvgpr_read_b32 v17, a97
    v_accvgpr_read_b32 v18, a98
    v_accvgpr_read_b32 v19, a99
    v_cvt_pk_bf16_f32 v20, v16, v17
    v_cvt_pk_bf16_f32 v21, v18, v19
    ds_write_b64 v10, v[20:21] offset:768
L_g1_skip0_0:
    v_accvgpr_read_b32 v16, a4
    v_accvgpr_read_b32 v17, a5
    v_accvgpr_read_b32 v18, a6
    v_accvgpr_read_b32 v19, a7
    v_cvt_pk_bf16_f32 v20, v16, v17
    v_cvt_pk_bf16_f32 v21, v18, v19
    ds_write_b64 v10, v[20:21] offset:14592
    v_accvgpr_read_b32 v24, a20
    v_accvgpr_read_b32 v25, a21
    v_accvgpr_read_b32 v26, a22
    v_accvgpr_read_b32 v27, a23
    v_cvt_pk_bf16_f32 v28, v24, v25
    v_cvt_pk_bf16_f32 v29, v26, v27
    ds_write_b64 v10, v[28:29] offset:14720
    v_accvgpr_read_b32 v16, a36
    v_accvgpr_read_b32 v17, a37
    v_accvgpr_read_b32 v18, a38
    v_accvgpr_read_b32 v19, a39
    v_cvt_pk_bf16_f32 v20, v16, v17
    v_cvt_pk_bf16_f32 v21, v18, v19
    ds_write_b64 v10, v[20:21] offset:14848
    v_accvgpr_read_b32 v24, a52
    v_accvgpr_read_b32 v25, a53
    v_accvgpr_read_b32 v26, a54
    v_accvgpr_read_b32 v27, a55
    v_cvt_pk_bf16_f32 v28, v24, v25
    v_cvt_pk_bf16_f32 v29, v26, v27
    ds_write_b64 v10, v[28:29] offset:14976
    v_accvgpr_read_b32 v16, a68
    v_accvgpr_read_b32 v17, a69
    v_accvgpr_read_b32 v18, a70
    v_accvgpr_read_b32 v19, a71
    v_cvt_pk_bf16_f32 v20, v16, v17
    v_cvt_pk_bf16_f32 v21, v18, v19
    ds_write_b64 v10, v[20:21] offset:15104
    v_accvgpr_read_b32 v24, a84
    v_accvgpr_read_b32 v25, a85
    v_accvgpr_read_b32 v26, a86
    v_accvgpr_read_b32 v27, a87
    v_cvt_pk_bf16_f32 v28, v24, v25
    v_cvt_pk_bf16_f32 v29, v26, v27
    ds_write_b64 v10, v[28:29] offset:15232
    s_cmp_lt_u32 s52, 7
    s_cbranch_scc1 L_g1_skip0_1
    v_accvgpr_read_b32 v16, a100
    v_accvgpr_read_b32 v17, a101
    v_accvgpr_read_b32 v18, a102
    v_accvgpr_read_b32 v19, a103
    v_cvt_pk_bf16_f32 v20, v16, v17
    v_cvt_pk_bf16_f32 v21, v18, v19
    ds_write_b64 v10, v[20:21] offset:15360
L_g1_skip0_1:
    v_accvgpr_read_b32 v16, a8
    v_accvgpr_read_b32 v17, a9
    v_accvgpr_read_b32 v18, a10
    v_accvgpr_read_b32 v19, a11
    v_cvt_pk_bf16_f32 v20, v16, v17
    v_cvt_pk_bf16_f32 v21, v18, v19
    ds_write_b64 v10, v[20:21] offset:29184
    v_accvgpr_read_b32 v24, a24
    v_accvgpr_read_b32 v25, a25
    v_accvgpr_read_b32 v26, a26
    v_accvgpr_read_b32 v27, a27
    v_cvt_pk_bf16_f32 v28, v24, v25
    v_cvt_pk_bf16_f32 v29, v26, v27
    ds_write_b64 v10, v[28:29] offset:29312
    v_accvgpr_read_b32 v16, a40
    v_accvgpr_read_b32 v17, a41
    v_accvgpr_read_b32 v18, a42
    v_accvgpr_read_b32 v19, a43
    v_cvt_pk_bf16_f32 v20, v16, v17
    v_cvt_pk_bf16_f32 v21, v18, v19
    ds_write_b64 v10, v[20:21] offset:29440
    v_accvgpr_read_b32 v24, a56
    v_accvgpr_read_b32 v25, a57
    v_accvgpr_read_b32 v26, a58
    v_accvgpr_read_b32 v27, a59
    v_cvt_pk_bf16_f32 v28, v24, v25
    v_cvt_pk_bf16_f32 v29, v26, v27
    ds_write_b64 v10, v[28:29] offset:29568
    v_accvgpr_read_b32 v16, a72
    v_accvgpr_read_b32 v17, a73
    v_accvgpr_read_b32 v18, a74
    v_accvgpr_read_b32 v19, a75
    v_cvt_pk_bf16_f32 v20, v16, v17
    v_cvt_pk_bf16_f32 v21, v18, v19
    ds_write_b64 v10, v[20:21] offset:29696
    v_accvgpr_read_b32 v24, a88
    v_accvgpr_read_b32 v25, a89
    v_accvgpr_read_b32 v26, a90
    v_accvgpr_read_b32 v27, a91
    v_cvt_pk_bf16_f32 v28, v24, v25
    v_cvt_pk_bf16_f32 v29, v26, v27
    ds_write_b64 v10, v[28:29] offset:29824
    s_cmp_lt_u32 s52, 7
    s_cbranch_scc1 L_g1_skip0_2
    v_accvgpr_read_b32 v16, a104
    v_accvgpr_read_b32 v17, a105
    v_accvgpr_read_b32 v18, a106
    v_accvgpr_read_b32 v19, a107
    v_cvt_pk_bf16_f32 v20, v16, v17
    v_cvt_pk_bf16_f32 v21, v18, v19
    ds_write_b64 v10, v[20:21] offset:29952
L_g1_skip0_2:
    v_accvgpr_read_b32 v16, a12
    v_accvgpr_read_b32 v17, a13
    v_accvgpr_read_b32 v18, a14
    v_accvgpr_read_b32 v19, a15
    v_cvt_pk_bf16_f32 v20, v16, v17
    v_cvt_pk_bf16_f32 v21, v18, v19
    ds_write_b64 v10, v[20:21] offset:43776
    v_accvgpr_read_b32 v24, a28
    v_accvgpr_read_b32 v25, a29
    v_accvgpr_read_b32 v26, a30
    v_accvgpr_read_b32 v27, a31
    v_cvt_pk_bf16_f32 v28, v24, v25
    v_cvt_pk_bf16_f32 v29, v26, v27
    ds_write_b64 v10, v[28:29] offset:43904
    v_accvgpr_read_b32 v16, a44
    v_accvgpr_read_b32 v17, a45
    v_accvgpr_read_b32 v18, a46
    v_accvgpr_read_b32 v19, a47
    v_cvt_pk_bf16_f32 v20, v16, v17
    v_cvt_pk_bf16_f32 v21, v18, v19
    ds_write_b64 v10, v[20:21] offset:44032
    v_accvgpr_read_b32 v24, a60
    v_accvgpr_read_b32 v25, a61
    v_accvgpr_read_b32 v26, a62
    v_accvgpr_read_b32 v27, a63
    v_cvt_pk_bf16_f32 v28, v24, v25
    v_cvt_pk_bf16_f32 v29, v26, v27
    ds_write_b64 v10, v[28:29] offset:44160
    v_accvgpr_read_b32 v16, a76
    v_accvgpr_read_b32 v17, a77
    v_accvgpr_read_b32 v18, a78
    v_accvgpr_read_b32 v19, a79
    v_cvt_pk_bf16_f32 v20, v16, v17
    v_cvt_pk_bf16_f32 v21, v18, v19
    ds_write_b64 v10, v[20:21] offset:44288
    v_accvgpr_read_b32 v24, a92
    v_accvgpr_read_b32 v25, a93
    v_accvgpr_read_b32 v26, a94
    v_accvgpr_read_b32 v27, a95
    v_cvt_pk_bf16_f32 v28, v24, v25
    v_cvt_pk_bf16_f32 v29, v26, v27
    ds_write_b64 v10, v[28:29] offset:44416
    s_cmp_lt_u32 s52, 7
    s_cbranch_scc1 L_g1_skip0_3
    v_accvgpr_read_b32 v16, a108
    v_accvgpr_read_b32 v17, a109
    v_accvgpr_read_b32 v18, a110
    v_accvgpr_read_b32 v19, a111
    v_cvt_pk_bf16_f32 v20, v16, v17
    v_cvt_pk_bf16_f32 v21, v18, v19
    ds_write_b64 v10, v[20:21] offset:44544
L_g1_skip0_3:
    s_branch L_g1_st
L_g1_silu:
    v_accvgpr_read_b32 v16, a0
    v_accvgpr_read_b32 v17, a1
    v_accvgpr_read_b32 v18, a2
    v_accvgpr_read_b32 v19, a3
    v_cvt_pk_bf16_f32 v20, v16, v17
    v_cvt_pk_bf16_f32 v21, v18, v19
    v_lshlrev_b32 v16, 16, v20
    v_and_b32 v17, 0xffff0000, v20
    v_lshlrev_b32 v18, 16, v21
    v_and_b32 v19, 0xffff0000, v21
    v_pk_mul_f32 v[20:21], v[16:17], s[56:57]
    v_pk_mul_f32 v[22:23], v[18:19], s[56:57]
    v_exp_f32 v20, v20
    v_exp_f32 v21, v21
    v_exp_f32 v22, v22
    v_exp_f32 v23, v23
    v_pk_add_f32 v[20:21], v[20:21], 1.0
    v_pk_add_f32 v[22:23], v[22:23], 1.0
    v_rcp_f32 v20, v20
    v_rcp_f32 v21, v21
    v_rcp_f32 v22, v22
    v_rcp_f32 v23, v23
    v_pk_mul_f32 v[16:17], v[16:17], v[20:21]
    v_pk_mul_f32 v[18:19], v[18:19], v[22:23]
    v_cvt_pk_bf16_f32 v20, v16, v17
    v_cvt_pk_bf16_f32 v21, v18, v19
    ds_write_b64 v10, v[20:21] offset:0
    v_accvgpr_read_b32 v24, a16
    v_accvgpr_read_b32 v25, a17
    v_accvgpr_read_b32 v26, a18
    v_accvgpr_read_b32 v27, a19
    v_cvt_pk_bf16_f32 v28, v24, v25
    v_cvt_pk_bf16_f32 v29, v26, v27
    v_lshlrev_b32 v24, 16, v28
    v_and_b32 v25, 0xffff0000, v28
    v_lshlrev_b32 v26, 16, v29
    v_and_b32 v27, 0xffff0000, v29
    v_pk_mul_f32 v[28:29], v[24:25], s[56:57]
    v_pk_mul_f32 v[30:31], v[26:27], s[56:57]
    v_exp_f32 v28, v28
    v_exp_f32 v29, v29
    v_exp_f32 v30, v30
    v_exp_f32 v31, v31
    v_pk_add_f32 v[28:29], v[28:29], 1.0
    v_pk_add_f32 v[30:31], v[30:31], 1.0
    v_rcp_f32 v28, v28
    v_rcp_f32 v29, v29
    v_rcp_f32 v30, v30
    v_rcp_f32 v31, v31
    v_pk_mul_f32 v[24:25], v[24:25], v[28:29]
    v_pk_mul_f32 v[26:27], v[26:27], v[30:31]
    v_cvt_pk_bf16_f32 v28, v24, v25
    v_cvt_pk_bf16_f32 v29, v26, v27
    ds_write_b64 v10, v[28:29] offset:128
    v_accvgpr_read_b32 v16, a32
    v_accvgpr_read_b32 v17, a33
    v_accvgpr_read_b32 v18, a34
    v_accvgpr_read_b32 v19, a35
    v_cvt_pk_bf16_f32 v20, v16, v17
    v_cvt_pk_bf16_f32 v21, v18, v19
    v_lshlrev_b32 v16, 16, v20
    v_and_b32 v17, 0xffff0000, v20
    v_lshlrev_b32 v18, 16, v21
    v_and_b32 v19, 0xffff0000, v21
    v_pk_mul_f32 v[20:21], v[16:17], s[56:57]
    v_pk_mul_f32 v[22:23], v[18:19], s[56:57]
    v_exp_f32 v20, v20
    v_exp_f32 v21, v21
    v_exp_f32 v22, v22
    v_exp_f32 v23, v23
    v_pk_add_f32 v[20:21], v[20:21], 1.0
    v_pk_add_f32 v[22:23], v[22:23], 1.0
    v_rcp_f32 v20, v20
    v_rcp_f32 v21, v21
    v_rcp_f32 v22, v22
    v_rcp_f32 v23, v23
    v_pk_mul_f32 v[16:17], v[16:17], v[20:21]
    v_pk_mul_f32 v[18:19], v[18:19], v[22:23]
    v_cvt_pk_bf16_f32 v20, v16, v17
    v_cvt_pk_bf16_f32 v21, v18, v19
    ds_write_b64 v10, v[20:21] offset:256
    v_accvgpr_read_b32 v24, a48
    v_accvgpr_read_b32 v25, a49
    v_accvgpr_read_b32 v26, a50
    v_accvgpr_read_b32 v27, a51
    v_cvt_pk_bf16_f32 v28, v24, v25
    v_cvt_pk_bf16_f32 v29, v26, v27
    v_lshlrev_b32 v24, 16, v28
    v_and_b32 v25, 0xffff0000, v28
    v_lshlrev_b32 v26, 16, v29
    v_and_b32 v27, 0xffff0000, v29
    v_pk_mul_f32 v[28:29], v[24:25], s[56:57]
    v_pk_mul_f32 v[30:31], v[26:27], s[56:57]
    v_exp_f32 v28, v28
    v_exp_f32 v29, v29
    v_exp_f32 v30, v30
    v_exp_f32 v31, v31
    v_pk_add_f32 v[28:29], v[28:29], 1.0
    v_pk_add_f32 v[30:31], v[30:31], 1.0
    v_rcp_f32 v28, v28
    v_rcp_f32 v29, v29
    v_rcp_f32 v30, v30
    v_rcp_f32 v31, v31
    v_pk_mul_f32 v[24:25], v[24:25], v[28:29]
    v_pk_mul_f32 v[26:27], v[26:27], v[30:31]
    v_cvt_pk_bf16_f32 v28, v24, v25
    v_cvt_pk_bf16_f32 v29, v26, v27
    ds_write_b64 v10, v[28:29] offset:384
    v_accvgpr_read_b32 v16, a64
    v_accvgpr_read_b32 v17, a65
    v_accvgpr_read_b32 v18, a66
    v_accvgpr_read_b32 v19, a67
    v_cvt_pk_bf16_f32 v20, v16, v17
    v_cvt_pk_bf16_f32 v21, v18, v19
    v_lshlrev_b32 v16, 16, v20
    v_and_b32 v17, 0xffff0000, v20
    v_lshlrev_b32 v18, 16, v21
    v_and_b32 v19, 0xffff0000, v21
    v_pk_mul_f32 v[20:21], v[16:17], s[56:57]
    v_pk_mul_f32 v[22:23], v[18:19], s[56:57]
    v_exp_f32 v20, v20
    v_exp_f32 v21, v21
    v_exp_f32 v22, v22
    v_exp_f32 v23, v23
    v_pk_add_f32 v[20:21], v[20:21], 1.0
    v_pk_add_f32 v[22:23], v[22:23], 1.0
    v_rcp_f32 v20, v20
    v_rcp_f32 v21, v21
    v_rcp_f32 v22, v22
    v_rcp_f32 v23, v23
    v_pk_mul_f32 v[16:17], v[16:17], v[20:21]
    v_pk_mul_f32 v[18:19], v[18:19], v[22:23]
    v_cvt_pk_bf16_f32 v20, v16, v17
    v_cvt_pk_bf16_f32 v21, v18, v19
    ds_write_b64 v10, v[20:21] offset:512
    v_accvgpr_read_b32 v24, a80
    v_accvgpr_read_b32 v25, a81
    v_accvgpr_read_b32 v26, a82
    v_accvgpr_read_b32 v27, a83
    v_cvt_pk_bf16_f32 v28, v24, v25
    v_cvt_pk_bf16_f32 v29, v26, v27
    v_lshlrev_b32 v24, 16, v28
    v_and_b32 v25, 0xffff0000, v28
    v_lshlrev_b32 v26, 16, v29
    v_and_b32 v27, 0xffff0000, v29
    v_pk_mul_f32 v[28:29], v[24:25], s[56:57]
    v_pk_mul_f32 v[30:31], v[26:27], s[56:57]
    v_exp_f32 v28, v28
    v_exp_f32 v29, v29
    v_exp_f32 v30, v30
    v_exp_f32 v31, v31
    v_pk_add_f32 v[28:29], v[28:29], 1.0
    v_pk_add_f32 v[30:31], v[30:31], 1.0
    v_rcp_f32 v28, v28
    v_rcp_f32 v29, v29
    v_rcp_f32 v30, v30
    v_rcp_f32 v31, v31
    v_pk_mul_f32 v[24:25], v[24:25], v[28:29]
    v_pk_mul_f32 v[26:27], v[26:27], v[30:31]
    v_cvt_pk_bf16_f32 v28, v24, v25
    v_cvt_pk_bf16_f32 v29, v26, v27
    ds_write_b64 v10, v[28:29] offset:640
    s_cmp_lt_u32 s52, 7
    s_cbranch_scc1 L_g1_skip1_0
    v_accvgpr_read_b32 v16, a96
    v_accvgpr_read_b32 v17, a97
    v_accvgpr_read_b32 v18, a98
    v_accvgpr_read_b32 v19, a99
    v_cvt_pk_bf16_f32 v20, v16, v17
    v_cvt_pk_bf16_f32 v21, v18, v19
    v_lshlrev_b32 v16, 16, v20
    v_and_b32 v17, 0xffff0000, v20
    v_lshlrev_b32 v18, 16, v21
    v_and_b32 v19, 0xffff0000, v21
    v_pk_mul_f32 v[20:21], v[16:17], s[56:57]
    v_pk_mul_f32 v[22:23], v[18:19], s[56:57]
    v_exp_f32 v20, v20
    v_exp_f32 v21, v21
    v_exp_f32 v22, v22
    v_exp_f32 v23, v23
    v_pk_add_f32 v[20:21], v[20:21], 1.0
    v_pk_add_f32 v[22:23], v[22:23], 1.0
    v_rcp_f32 v20, v20
    v_rcp_f32 v21, v21
    v_rcp_f32 v22, v22
    v_rcp_f32 v23, v23
    v_pk_mul_f32 v[16:17], v[16:17], v[20:21]
    v_pk_mul_f32 v[18:19], v[18:19], v[22:23]
    v_cvt_pk_bf16_f32 v20, v16, v17
    v_cvt_pk_bf16_f32 v21, v18, v19
    ds_write_b64 v10, v[20:21] offset:768
L_g1_skip1_0:
    v_accvgpr_read_b32 v16, a4
    v_accvgpr_read_b32 v17, a5
    v_accvgpr_read_b32 v18, a6
    v_accvgpr_read_b32 v19, a7
    v_cvt_pk_bf16_f32 v20, v16, v17
    v_cvt_pk_bf16_f32 v21, v18, v19
    v_lshlrev_b32 v16, 16, v20
    v_and_b32 v17, 0xffff0000, v20
    v_lshlrev_b32 v18, 16, v21
    v_and_b32 v19, 0xffff0000, v21
    v_pk_mul_f32 v[20:21], v[16:17], s[56:57]
    v_pk_mul_f32 v[22:23], v[18:19], s[56:57]
    v_exp_f32 v20, v20
    v_exp_f32 v21, v21
    v_exp_f32 v22, v22
    v_exp_f32 v23, v23
    v_pk_add_f32 v[20:21], v[20:21], 1.0
    v_pk_add_f32 v[22:23], v[22:23], 1.0
    v_rcp_f32 v20, v20
    v_rcp_f32 v21, v21
    v_rcp_f32 v22, v22
    v_rcp_f32 v23, v23
    v_pk_mul_f32 v[16:17], v[16:17], v[20:21]
    v_pk_mul_f32 v[18:19], v[18:19], v[22:23]
    v_cvt_pk_bf16_f32 v20, v16, v17
    v_cvt_pk_bf16_f32 v21, v18, v19
    ds_write_b64 v10, v[20:21] offset:14592
    v_accvgpr_read_b32 v24, a20
    v_accvgpr_read_b32 v25, a21
    v_accvgpr_read_b32 v26, a22
    v_accvgpr_read_b32 v27, a23
    v_cvt_pk_bf16_f32 v28, v24, v25
    v_cvt_pk_bf16_f32 v29, v26, v27
    v_lshlrev_b32 v24, 16, v28
    v_and_b32 v25, 0xffff0000, v28
    v_lshlrev_b32 v26, 16, v29
    v_and_b32 v27, 0xffff0000, v29
    v_pk_mul_f32 v[28:29], v[24:25], s[56:57]
    v_pk_mul_f32 v[30:31], v[26:27], s[56:57]
    v_exp_f32 v28, v28
    v_exp_f32 v29, v29
    v_exp_f32 v30, v30
    v_exp_f32 v31, v31
    v_pk_add_f32 v[28:29], v[28:29], 1.0
    v_pk_add_f32 v[30:31], v[30:31], 1.0
    v_rcp_f32 v28, v28
    v_rcp_f32 v29, v29
    v_rcp_f32 v30, v30
    v_rcp_f32 v31, v31
    v_pk_mul_f32 v[24:25], v[24:25], v[28:29]
    v_pk_mul_f32 v[26:27], v[26:27], v[30:31]
    v_cvt_pk_bf16_f32 v28, v24, v25
    v_cvt_pk_bf16_f32 v29, v26, v27
    ds_write_b64 v10, v[28:29] offset:14720
    v_accvgpr_read_b32 v16, a36
    v_accvgpr_read_b32 v17, a37
    v_accvgpr_read_b32 v18, a38
    v_accvgpr_read_b32 v19, a39
    v_cvt_pk_bf16_f32 v20, v16, v17
    v_cvt_pk_bf16_f32 v21, v18, v19
    v_lshlrev_b32 v16, 16, v20
    v_and_b32 v17, 0xffff0000, v20
    v_lshlrev_b32 v18, 16, v21
    v_and_b32 v19, 0xffff0000, v21
    v_pk_mul_f32 v[20:21], v[16:17], s[56:57]
    v_pk_mul_f32 v[22:23], v[18:19], s[56:57]
    v_exp_f32 v20, v20
    v_exp_f32 v21, v21
    v_exp_f32 v22, v22
    v_exp_f32 v23, v23
    v_pk_add_f32 v[20:21], v[20:21], 1.0
    v_pk_add_f32 v[22:23], v[22:23], 1.0
    v_rcp_f32 v20, v20
    v_rcp_f32 v21, v21
    v_rcp_f32 v22, v22
    v_rcp_f32 v23, v23
    v_pk_mul_f32 v[16:17], v[16:17], v[20:21]
    v_pk_mul_f32 v[18:19], v[18:19], v[22:23]
    v_cvt_pk_bf16_f32 v20, v16, v17
    v_cvt_pk_bf16_f32 v21, v18, v19
    ds_write_b64 v10, v[20:21] offset:14848
    v_accvgpr_read_b32 v24, a52
    v_accvgpr_read_b32 v25, a53
    v_accvgpr_read_b32 v26, a54
    v_accvgpr_read_b32 v27, a55
    v_cvt_pk_bf16_f32 v28, v24, v25
    v_cvt_pk_bf16_f32 v29, v26, v27
    v_lshlrev_b32 v24, 16, v28
    v_and_b32 v25, 0xffff0000, v28
    v_lshlrev_b32 v26, 16, v29
    v_and_b32 v27, 0xffff0000, v29
    v_pk_mul_f32 v[28:29], v[24:25], s[56:57]
    v_pk_mul_f32 v[30:31], v[26:27], s[56:57]
    v_exp_f32 v28, v28
    v_exp_f32 v29, v29
    v_exp_f32 v30, v30
    v_exp_f32 v31, v31
    v_pk_add_f32 v[28:29], v[28:29], 1.0
    v_pk_add_f32 v[30:31], v[30:31], 1.0
    v_rcp_f32 v28, v28
    v_rcp_f32 v29, v29
    v_rcp_f32 v30, v30
    v_rcp_f32 v31, v31
    v_pk_mul_f32 v[24:25], v[24:25], v[28:29]
    v_pk_mul_f32 v[26:27], v[26:27], v[30:31]
    v_cvt_pk_bf16_f32 v28, v24, v25
    v_cvt_pk_bf16_f32 v29, v26, v27
    ds_write_b64 v10, v[28:29] offset:14976
    v_accvgpr_read_b32 v16, a68
    v_accvgpr_read_b32 v17, a69
    v_accvgpr_read_b32 v18, a70
    v_accvgpr_read_b32 v19, a71
    v_cvt_pk_bf16_f32 v20, v16, v17
    v_cvt_pk_bf16_f32 v21, v18, v19
    v_lshlrev_b32 v16, 16, v20
    v_and_b32 v17, 0xffff0000, v20
    v_lshlrev_b32 v18, 16, v21
    v_and_b32 v19, 0xffff0000, v21
    v_pk_mul_f32 v[20:21], v[16:17], s[56:57]
    v_pk_mul_f32 v[22:23], v[18:19], s[56:57]
    v_exp_f32 v20, v20
    v_exp_f32 v21, v21
    v_exp_f32 v22, v22
    v_exp_f32 v23, v23
    v_pk_add_f32 v[20:21], v[20:21], 1.0
    v_pk_add_f32 v[22:23], v[22:23], 1.0
    v_rcp_f32 v20, v20
    v_rcp_f32 v21, v21
    v_rcp_f32 v22, v22
    v_rcp_f32 v23, v23
    v_pk_mul_f32 v[16:17], v[16:17], v[20:21]
    v_pk_mul_f32 v[18:19], v[18:19], v[22:23]
    v_cvt_pk_bf16_f32 v20, v16, v17
    v_cvt_pk_bf16_f32 v21, v18, v19
    ds_write_b64 v10, v[20:21] offset:15104
    v_accvgpr_read_b32 v24, a84
    v_accvgpr_read_b32 v25, a85
    v_accvgpr_read_b32 v26, a86
    v_accvgpr_read_b32 v27, a87
    v_cvt_pk_bf16_f32 v28, v24, v25
    v_cvt_pk_bf16_f32 v29, v26, v27
    v_lshlrev_b32 v24, 16, v28
    v_and_b32 v25, 0xffff0000, v28
    v_lshlrev_b32 v26, 16, v29
    v_and_b32 v27, 0xffff0000, v29
    v_pk_mul_f32 v[28:29], v[24:25], s[56:57]
    v_pk_mul_f32 v[30:31], v[26:27], s[56:57]
    v_exp_f32 v28, v28
    v_exp_f32 v29, v29
    v_exp_f32 v30, v30
    v_exp_f32 v31, v31
    v_pk_add_f32 v[28:29], v[28:29], 1.0
    v_pk_add_f32 v[30:31], v[30:31], 1.0
    v_rcp_f32 v28, v28
    v_rcp_f32 v29, v29
    v_rcp_f32 v30, v30
    v_rcp_f32 v31, v31
    v_pk_mul_f32 v[24:25], v[24:25], v[28:29]
    v_pk_mul_f32 v[26:27], v[26:27], v[30:31]
    v_cvt_pk_bf16_f32 v28, v24, v25
    v_cvt_pk_bf16_f32 v29, v26, v27
    ds_write_b64 v10, v[28:29] offset:15232
    s_cmp_lt_u32 s52, 7
    s_cbranch_scc1 L_g1_skip1_1
    v_accvgpr_read_b32 v16, a100
    v_accvgpr_read_b32 v17, a101
    v_accvgpr_read_b32 v18, a102
    v_accvgpr_read_b32 v19, a103
    v_cvt_pk_bf16_f32 v20, v16, v17
    v_cvt_pk_bf16_f32 v21, v18, v19
    v_lshlrev_b32 v16, 16, v20
    v_and_b32 v17, 0xffff0000, v20
    v_lshlrev_b32 v18, 16, v21
    v_and_b32 v19, 0xffff0000, v21
    v_pk_mul_f32 v[20:21], v[16:17], s[56:57]
    v_pk_mul_f32 v[22:23], v[18:19], s[56:57]
    v_exp_f32 v20, v20
    v_exp_f32 v21, v21
    v_exp_f32 v22, v22
    v_exp_f32 v23, v23
    v_pk_add_f32 v[20:21], v[20:21], 1.0
    v_pk_add_f32 v[22:23], v[22:23], 1.0
    v_rcp_f32 v20, v20
    v_rcp_f32 v21, v21
    v_rcp_f32 v22, v22
    v_rcp_f32 v23, v23
    v_pk_mul_f32 v[16:17], v[16:17], v[20:21]
    v_pk_mul_f32 v[18:19], v[18:19], v[22:23]
    v_cvt_pk_bf16_f32 v20, v16, v17
    v_cvt_pk_bf16_f32 v21, v18, v19
    ds_write_b64 v10, v[20:21] offset:15360
L_g1_skip1_1:
    v_accvgpr_read_b32 v16, a8
    v_accvgpr_read_b32 v17, a9
    v_accvgpr_read_b32 v18, a10
    v_accvgpr_read_b32 v19, a11
    v_cvt_pk_bf16_f32 v20, v16, v17
    v_cvt_pk_bf16_f32 v21, v18, v19
    v_lshlrev_b32 v16, 16, v20
    v_and_b32 v17, 0xffff0000, v20
    v_lshlrev_b32 v18, 16, v21
    v_and_b32 v19, 0xffff0000, v21
    v_pk_mul_f32 v[20:21], v[16:17], s[56:57]
    v_pk_mul_f32 v[22:23], v[18:19], s[56:57]
    v_exp_f32 v20, v20
    v_exp_f32 v21, v21
    v_exp_f32 v22, v22
    v_exp_f32 v23, v23
    v_pk_add_f32 v[20:21], v[20:21], 1.0
    v_pk_add_f32 v[22:23], v[22:23], 1.0
    v_rcp_f32 v20, v20
    v_rcp_f32 v21, v21
    v_rcp_f32 v22, v22
    v_rcp_f32 v23, v23
    v_pk_mul_f32 v[16:17], v[16:17], v[20:21]
    v_pk_mul_f32 v[18:19], v[18:19], v[22:23]
    v_cvt_pk_bf16_f32 v20, v16, v17
    v_cvt_pk_bf16_f32 v21, v18, v19
    ds_write_b64 v10, v[20:21] offset:29184
    v_accvgpr_read_b32 v24, a24
    v_accvgpr_read_b32 v25, a25
    v_accvgpr_read_b32 v26, a26
    v_accvgpr_read_b32 v27, a27
    v_cvt_pk_bf16_f32 v28, v24, v25
    v_cvt_pk_bf16_f32 v29, v26, v27
    v_lshlrev_b32 v24, 16, v28
    v_and_b32 v25, 0xffff0000, v28
    v_lshlrev_b32 v26, 16, v29
    v_and_b32 v27, 0xffff0000, v29
    v_pk_mul_f32 v[28:29], v[24:25], s[56:57]
    v_pk_mul_f32 v[30:31], v[26:27], s[56:57]
    v_exp_f32 v28, v28
    v_exp_f32 v29, v29
    v_exp_f32 v30, v30
    v_exp_f32 v31, v31
    v_pk_add_f32 v[28:29], v[28:29], 1.0
    v_pk_add_f32 v[30:31], v[30:31], 1.0
    v_rcp_f32 v28, v28
    v_rcp_f32 v29, v29
    v_rcp_f32 v30, v30
    v_rcp_f32 v31, v31
    v_pk_mul_f32 v[24:25], v[24:25], v[28:29]
    v_pk_mul_f32 v[26:27], v[26:27], v[30:31]
    v_cvt_pk_bf16_f32 v28, v24, v25
    v_cvt_pk_bf16_f32 v29, v26, v27
    ds_write_b64 v10, v[28:29] offset:29312
    v_accvgpr_read_b32 v16, a40
    v_accvgpr_read_b32 v17, a41
    v_accvgpr_read_b32 v18, a42
    v_accvgpr_read_b32 v19, a43
    v_cvt_pk_bf16_f32 v20, v16, v17
    v_cvt_pk_bf16_f32 v21, v18, v19
    v_lshlrev_b32 v16, 16, v20
    v_and_b32 v17, 0xffff0000, v20
    v_lshlrev_b32 v18, 16, v21
    v_and_b32 v19, 0xffff0000, v21
    v_pk_mul_f32 v[20:21], v[16:17], s[56:57]
    v_pk_mul_f32 v[22:23], v[18:19], s[56:57]
    v_exp_f32 v20, v20
    v_exp_f32 v21, v21
    v_exp_f32 v22, v22
    v_exp_f32 v23, v23
    v_pk_add_f32 v[20:21], v[20:21], 1.0
    v_pk_add_f32 v[22:23], v[22:23], 1.0
    v_rcp_f32 v20, v20
    v_rcp_f32 v21, v21
    v_rcp_f32 v22, v22
    v_rcp_f32 v23, v23
    v_pk_mul_f32 v[16:17], v[16:17], v[20:21]
    v_pk_mul_f32 v[18:19], v[18:19], v[22:23]
    v_cvt_pk_bf16_f32 v20, v16, v17
    v_cvt_pk_bf16_f32 v21, v18, v19
    ds_write_b64 v10, v[20:21] offset:29440
    v_accvgpr_read_b32 v24, a56
    v_accvgpr_read_b32 v25, a57
    v_accvgpr_read_b32 v26, a58
    v_accvgpr_read_b32 v27, a59
    v_cvt_pk_bf16_f32 v28, v24, v25
    v_cvt_pk_bf16_f32 v29, v26, v27
    v_lshlrev_b32 v24, 16, v28
    v_and_b32 v25, 0xffff0000, v28
    v_lshlrev_b32 v26, 16, v29
    v_and_b32 v27, 0xffff0000, v29
    v_pk_mul_f32 v[28:29], v[24:25], s[56:57]
    v_pk_mul_f32 v[30:31], v[26:27], s[56:57]
    v_exp_f32 v28, v28
    v_exp_f32 v29, v29
    v_exp_f32 v30, v30
    v_exp_f32 v31, v31
    v_pk_add_f32 v[28:29], v[28:29], 1.0
    v_pk_add_f32 v[30:31], v[30:31], 1.0
    v_rcp_f32 v28, v28
    v_rcp_f32 v29, v29
    v_rcp_f32 v30, v30
    v_rcp_f32 v31, v31
    v_pk_mul_f32 v[24:25], v[24:25], v[28:29]
    v_pk_mul_f32 v[26:27], v[26:27], v[30:31]
    v_cvt_pk_bf16_f32 v28, v24, v25
    v_cvt_pk_bf16_f32 v29, v26, v27
    ds_write_b64 v10, v[28:29] offset:29568
    v_accvgpr_read_b32 v16, a72
    v_accvgpr_read_b32 v17, a73
    v_accvgpr_read_b32 v18, a74
    v_accvgpr_read_b32 v19, a75
    v_cvt_pk_bf16_f32 v20, v16, v17
    v_cvt_pk_bf16_f32 v21, v18, v19
    v_lshlrev_b32 v16, 16, v20
    v_and_b32 v17, 0xffff0000, v20
    v_lshlrev_b32 v18, 16, v21
    v_and_b32 v19, 0xffff0000, v21
    v_pk_mul_f32 v[20:21], v[16:17], s[56:57]
    v_pk_mul_f32 v[22:23], v[18:19], s[56:57]
    v_exp_f32 v20, v20
    v_exp_f32 v21, v21
    v_exp_f32 v22, v22
    v_exp_f32 v23, v23
    v_pk_add_f32 v[20:21], v[20:21], 1.0
    v_pk_add_f32 v[22:23], v[22:23], 1.0
    v_rcp_f32 v20, v20
    v_rcp_f32 v21, v21
    v_rcp_f32 v22, v22
    v_rcp_f32 v23, v23
    v_pk_mul_f32 v[16:17], v[16:17], v[20:21]
    v_pk_mul_f32 v[18:19], v[18:19], v[22:23]
    v_cvt_pk_bf16_f32 v20, v16, v17
    v_cvt_pk_bf16_f32 v21, v18, v19
    ds_write_b64 v10, v[20:21] offset:29696
    v_accvgpr_read_b32 v24, a88
    v_accvgpr_read_b32 v25, a89
    v_accvgpr_read_b32 v26, a90
    v_accvgpr_read_b32 v27, a91
    v_cvt_pk_bf16_f32 v28, v24, v25
    v_cvt_pk_bf16_f32 v29, v26, v27
    v_lshlrev_b32 v24, 16, v28
    v_and_b32 v25, 0xffff0000, v28
    v_lshlrev_b32 v26, 16, v29
    v_and_b32 v27, 0xffff0000, v29
    v_pk_mul_f32 v[28:29], v[24:25], s[56:57]
    v_pk_mul_f32 v[30:31], v[26:27], s[56:57]
    v_exp_f32 v28, v28
    v_exp_f32 v29, v29
    v_exp_f32 v30, v30
    v_exp_f32 v31, v31
    v_pk_add_f32 v[28:29], v[28:29], 1.0
    v_pk_add_f32 v[30:31], v[30:31], 1.0
    v_rcp_f32 v28, v28
    v_rcp_f32 v29, v29
    v_rcp_f32 v30, v30
    v_rcp_f32 v31, v31
    v_pk_mul_f32 v[24:25], v[24:25], v[28:29]
    v_pk_mul_f32 v[26:27], v[26:27], v[30:31]
    v_cvt_pk_bf16_f32 v28, v24, v25
    v_cvt_pk_bf16_f32 v29, v26, v27
    ds_write_b64 v10, v[28:29] offset:29824
    s_cmp_lt_u32 s52, 7
    s_cbranch_scc1 L_g1_skip1_2
    v_accvgpr_read_b32 v16, a104
    v_accvgpr_read_b32 v17, a105
    v_accvgpr_read_b32 v18, a106
    v_accvgpr_read_b32 v19, a107
    v_cvt_pk_bf16_f32 v20, v16, v17
    v_cvt_pk_bf16_f32 v21, v18, v19
    v_lshlrev_b32 v16, 16, v20
    v_and_b32 v17, 0xffff0000, v20
    v_lshlrev_b32 v18, 16, v21
    v_and_b32 v19, 0xffff0000, v21
    v_pk_mul_f32 v[20:21], v[16:17], s[56:57]
    v_pk_mul_f32 v[22:23], v[18:19], s[56:57]
    v_exp_f32 v20, v20
    v_exp_f32 v21, v21
    v_exp_f32 v22, v22
    v_exp_f32 v23, v23
    v_pk_add_f32 v[20:21], v[20:21], 1.0
    v_pk_add_f32 v[22:23], v[22:23], 1.0
    v_rcp_f32 v20, v20
    v_rcp_f32 v21, v21
    v_rcp_f32 v22, v22
    v_rcp_f32 v23, v23
    v_pk_mul_f32 v[16:17], v[16:17], v[20:21]
    v_pk_mul_f32 v[18:19], v[18:19], v[22:23]
    v_cvt_pk_bf16_f32 v20, v16, v17
    v_cvt_pk_bf16_f32 v21, v18, v19
    ds_write_b64 v10, v[20:21] offset:29952
L_g1_skip1_2:
    v_accvgpr_read_b32 v16, a12
    v_accvgpr_read_b32 v17, a13
    v_accvgpr_read_b32 v18, a14
    v_accvgpr_read_b32 v19, a15
    v_cvt_pk_bf16_f32 v20, v16, v17
    v_cvt_pk_bf16_f32 v21, v18, v19
    v_lshlrev_b32 v16, 16, v20
    v_and_b32 v17, 0xffff0000, v20
    v_lshlrev_b32 v18, 16, v21
    v_and_b32 v19, 0xffff0000, v21
    v_pk_mul_f32 v[20:21], v[16:17], s[56:57]
    v_pk_mul_f32 v[22:23], v[18:19], s[56:57]
    v_exp_f32 v20, v20
    v_exp_f32 v21, v21
    v_exp_f32 v22, v22
    v_exp_f32 v23, v23
    v_pk_add_f32 v[20:21], v[20:21], 1.0
    v_pk_add_f32 v[22:23], v[22:23], 1.0
    v_rcp_f32 v20, v20
    v_rcp_f32 v21, v21
    v_rcp_f32 v22, v22
    v_rcp_f32 v23, v23
    v_pk_mul_f32 v[16:17], v[16:17], v[20:21]
    v_pk_mul_f32 v[18:19], v[18:19], v[22:23]
    v_cvt_pk_bf16_f32 v20, v16, v17
    v_cvt_pk_bf16_f32 v21, v18, v19
    ds_write_b64 v10, v[20:21] offset:43776
    v_accvgpr_read_b32 v24, a28
    v_accvgpr_read_b32 v25, a29
    v_accvgpr_read_b32 v26, a30
    v_accvgpr_read_b32 v27, a31
    v_cvt_pk_bf16_f32 v28, v24, v25
    v_cvt_pk_bf16_f32 v29, v26, v27
    v_lshlrev_b32 v24, 16, v28
    v_and_b32 v25, 0xffff0000, v28
    v_lshlrev_b32 v26, 16, v29
    v_and_b32 v27, 0xffff0000, v29
    v_pk_mul_f32 v[28:29], v[24:25], s[56:57]
    v_pk_mul_f32 v[30:31], v[26:27], s[56:57]
    v_exp_f32 v28, v28
    v_exp_f32 v29, v29
    v_exp_f32 v30, v30
    v_exp_f32 v31, v31
    v_pk_add_f32 v[28:29], v[28:29], 1.0
    v_pk_add_f32 v[30:31], v[30:31], 1.0
    v_rcp_f32 v28, v28
    v_rcp_f32 v29, v29
    v_rcp_f32 v30, v30
    v_rcp_f32 v31, v31
    v_pk_mul_f32 v[24:25], v[24:25], v[28:29]
    v_pk_mul_f32 v[26:27], v[26:27], v[30:31]
    v_cvt_pk_bf16_f32 v28, v24, v25
    v_cvt_pk_bf16_f32 v29, v26, v27
    ds_write_b64 v10, v[28:29] offset:43904
    v_accvgpr_read_b32 v16, a44
    v_accvgpr_read_b32 v17, a45
    v_accvgpr_read_b32 v18, a46
    v_accvgpr_read_b32 v19, a47
    v_cvt_pk_bf16_f32 v20, v16, v17
    v_cvt_pk_bf16_f32 v21, v18, v19
    v_lshlrev_b32 v16, 16, v20
    v_and_b32 v17, 0xffff0000, v20
    v_lshlrev_b32 v18, 16, v21
    v_and_b32 v19, 0xffff0000, v21
    v_pk_mul_f32 v[20:21], v[16:17], s[56:57]
    v_pk_mul_f32 v[22:23], v[18:19], s[56:57]
    v_exp_f32 v20, v20
    v_exp_f32 v21, v21
    v_exp_f32 v22, v22
    v_exp_f32 v23, v23
    v_pk_add_f32 v[20:21], v[20:21], 1.0
    v_pk_add_f32 v[22:23], v[22:23], 1.0
    v_rcp_f32 v20, v20
    v_rcp_f32 v21, v21
    v_rcp_f32 v22, v22
    v_rcp_f32 v23, v23
    v_pk_mul_f32 v[16:17], v[16:17], v[20:21]
    v_pk_mul_f32 v[18:19], v[18:19], v[22:23]
    v_cvt_pk_bf16_f32 v20, v16, v17
    v_cvt_pk_bf16_f32 v21, v18, v19
    ds_write_b64 v10, v[20:21] offset:44032
    v_accvgpr_read_b32 v24, a60
    v_accvgpr_read_b32 v25, a61
    v_accvgpr_read_b32 v26, a62
    v_accvgpr_read_b32 v27, a63
    v_cvt_pk_bf16_f32 v28, v24, v25
    v_cvt_pk_bf16_f32 v29, v26, v27
    v_lshlrev_b32 v24, 16, v28
    v_and_b32 v25, 0xffff0000, v28
    v_lshlrev_b32 v26, 16, v29
    v_and_b32 v27, 0xffff0000, v29
    v_pk_mul_f32 v[28:29], v[24:25], s[56:57]
    v_pk_mul_f32 v[30:31], v[26:27], s[56:57]
    v_exp_f32 v28, v28
    v_exp_f32 v29, v29
    v_exp_f32 v30, v30
    v_exp_f32 v31, v31
    v_pk_add_f32 v[28:29], v[28:29], 1.0
    v_pk_add_f32 v[30:31], v[30:31], 1.0
    v_rcp_f32 v28, v28
    v_rcp_f32 v29, v29
    v_rcp_f32 v30, v30
    v_rcp_f32 v31, v31
    v_pk_mul_f32 v[24:25], v[24:25], v[28:29]
    v_pk_mul_f32 v[26:27], v[26:27], v[30:31]
    v_cvt_pk_bf16_f32 v28, v24, v25
    v_cvt_pk_bf16_f32 v29, v26, v27
    ds_write_b64 v10, v[28:29] offset:44160
    v_accvgpr_read_b32 v16, a76
    v_accvgpr_read_b32 v17, a77
    v_accvgpr_read_b32 v18, a78
    v_accvgpr_read_b32 v19, a79
    v_cvt_pk_bf16_f32 v20, v16, v17
    v_cvt_pk_bf16_f32 v21, v18, v19
    v_lshlrev_b32 v16, 16, v20
    v_and_b32 v17, 0xffff0000, v20
    v_lshlrev_b32 v18, 16, v21
    v_and_b32 v19, 0xffff0000, v21
    v_pk_mul_f32 v[20:21], v[16:17], s[56:57]
    v_pk_mul_f32 v[22:23], v[18:19], s[56:57]
    v_exp_f32 v20, v20
    v_exp_f32 v21, v21
    v_exp_f32 v22, v22
    v_exp_f32 v23, v23
    v_pk_add_f32 v[20:21], v[20:21], 1.0
    v_pk_add_f32 v[22:23], v[22:23], 1.0
    v_rcp_f32 v20, v20
    v_rcp_f32 v21, v21
    v_rcp_f32 v22, v22
    v_rcp_f32 v23, v23
    v_pk_mul_f32 v[16:17], v[16:17], v[20:21]
    v_pk_mul_f32 v[18:19], v[18:19], v[22:23]
    v_cvt_pk_bf16_f32 v20, v16, v17
    v_cvt_pk_bf16_f32 v21, v18, v19
    ds_write_b64 v10, v[20:21] offset:44288
    v_accvgpr_read_b32 v24, a92
    v_accvgpr_read_b32 v25, a93
    v_accvgpr_read_b32 v26, a94
    v_accvgpr_read_b32 v27, a95
    v_cvt_pk_bf16_f32 v28, v24, v25
    v_cvt_pk_bf16_f32 v29, v26, v27
    v_lshlrev_b32 v24, 16, v28
    v_and_b32 v25, 0xffff0000, v28
    v_lshlrev_b32 v26, 16, v29
    v_and_b32 v27, 0xffff0000, v29
    v_pk_mul_f32 v[28:29], v[24:25], s[56:57]
    v_pk_mul_f32 v[30:31], v[26:27], s[56:57]
    v_exp_f32 v28, v28
    v_exp_f32 v29, v29
    v_exp_f32 v30, v30
    v_exp_f32 v31, v31
    v_pk_add_f32 v[28:29], v[28:29], 1.0
    v_pk_add_f32 v[30:31], v[30:31], 1.0
    v_rcp_f32 v28, v28
    v_rcp_f32 v29, v29
    v_rcp_f32 v30, v30
    v_rcp_f32 v31, v31
    v_pk_mul_f32 v[24:25], v[24:25], v[28:29]
    v_pk_mul_f32 v[26:27], v[26:27], v[30:31]
    v_cvt_pk_bf16_f32 v28, v24, v25
    v_cvt_pk_bf16_f32 v29, v26, v27
    ds_write_b64 v10, v[28:29] offset:44416
    s_cmp_lt_u32 s52, 7
    s_cbranch_scc1 L_g1_skip1_3
    v_accvgpr_read_b32 v16, a108
    v_accvgpr_read_b32 v17, a109
    v_accvgpr_read_b32 v18, a110
    v_accvgpr_read_b32 v19, a111
    v_cvt_pk_bf16_f32 v20, v16, v17
    v_cvt_pk_bf16_f32 v21, v18, v19
    v_lshlrev_b32 v16, 16, v20
    v_and_b32 v17, 0xffff0000, v20
    v_lshlrev_b32 v18, 16, v21
    v_and_b32 v19, 0xffff0000, v21
    v_pk_mul_f32 v[20:21], v[16:17], s[56:57]
    v_pk_mul_f32 v[22:23], v[18:19], s[56:57]
    v_exp_f32 v20, v20
    v_exp_f32 v21, v21
    v_exp_f32 v22, v22
    v_exp_f32 v23, v23
    v_pk_add_f32 v[20:21], v[20:21], 1.0
    v_pk_add_f32 v[22:23], v[22:23], 1.0
    v_rcp_f32 v20, v20
    v_rcp_f32 v21, v21
    v_rcp_f32 v22, v22
    v_rcp_f32 v23, v23
    v_pk_mul_f32 v[16:17], v[16:17], v[20:21]
    v_pk_mul_f32 v[18:19], v[18:19], v[22:23]
    v_cvt_pk_bf16_f32 v20, v16, v17
    v_cvt_pk_bf16_f32 v21, v18, v19
    ds_write_b64 v10, v[20:21] offset:44544
L_g1_skip1_3:
L_g1_st:
    s_waitcnt lgkmcnt(0)
    s_barrier
    v_lshlrev_b32 v10, 4, v1
    s_mul_i32 s31, s30, 14592
    v_add_u32 v11, s31, v10
    s_lshl_b32 s31, s41, 7
    s_lshl_b32 s32, s30, 4
    s_add_u32 s31, s31, s32
    s_mul_i32 s31, s31, s50
    s_lshl_b32 s32, s47, 7
    s_add_u32 s53, s31, s32
    s_lshl_b32 s31, s52, 3
    s_lshl_b64 s[54:55], 1, s31
    s_sub_u32 s54, s54, 1
    s_subb_u32 s55, s55, 0
    s_mov_b64 exec, s[54:55]
    ds_read_b128 v[16:19], v11 offset:0
    ds_read_b128 v[20:23], v11 offset:912
    ds_read_b128 v[24:27], v11 offset:1824
    ds_read_b128 v[28:31], v11 offset:2736
    s_waitcnt lgkmcnt(3)
    buffer_store_dwordx4 v[16:19], v10, s[12:15], s53 offen
    s_add_u32 s53, s53, s50
    s_waitcnt lgkmcnt(2)
    buffer_store_dwordx4 v[20:23], v10, s[12:15], s53 offen
    s_add_u32 s53, s53, s50
    s_waitcnt lgkmcnt(1)
    buffer_store_dwordx4 v[24:27], v10, s[12:15], s53 offen
    s_add_u32 s53, s53, s50
    s_waitcnt lgkmcnt(0)
    buffer_store_dwordx4 v[28:31], v10, s[12:15], s53 offen
    s_add_u32 s53, s53, s50
    ds_read_b128 v[16:19], v11 offset:3648
    ds_read_b128 v[20:23], v11 offset:4560
    ds_read_b128 v[24:27], v11 offset:5472
    ds_read_b128 v[28:31], v11 offset:6384
    s_waitcnt lgkmcnt(3)
    buffer_store_dwordx4 v[16:19], v10, s[12:15], s53 offen
    s_add_u32 s53, s53, s50
    s_waitcnt lgkmcnt(2)
    buffer_store_dwordx4 v[20:23], v10, s[12:15], s53 offen
    s_add_u32 s53, s53, s50
    s_waitcnt lgkmcnt(1)
    buffer_store_dwordx4 v[24:27], v10, s[12:15], s53 offen
    s_add_u32 s53, s53, s50
    s_waitcnt lgkmcnt(0)
    buffer_store_dwordx4 v[28:31], v10, s[12:15], s53 offen
    s_add_u32 s53, s53, s50
    ds_read_b128 v[16:19], v11 offset:7296
    ds_read_b128 v[20:23], v11 offset:8208
    ds_read_b128 v[24:27], v11 offset:9120
    ds_read_b128 v[28:31], v11 offset:10032
    s_waitcnt lgkmcnt(3)
    buffer_store_dwordx4 v[16:19], v10, s[12:15], s53 offen
    s_add_u32 s53, s53, s50
    s_waitcnt lgkmcnt(2)
    buffer_store_dwordx4 v[20:23], v10, s[12:15], s53 offen
    s_add_u32 s53, s53, s50
    s_waitcnt lgkmcnt(1)
    buffer_store_dwordx4 v[24:27], v10, s[12:15], s53 offen
    s_add_u32 s53, s53, s50
    s_waitcnt lgkmcnt(0)
    buffer_store_dwordx4 v[28:31], v10, s[12:15], s53 offen
    s_add_u32 s53, s53, s50
    ds_read_b128 v[16:19], v11 offset:10944
    ds_read_b128 v[20:23], v11 offset:11856
    ds_read_b128 v[24:27], v11 offset:12768
    ds_read_b128 v[28:31], v11 offset:13680
    s_waitcnt lgkmcnt(3)
    buffer_store_dwordx4 v[16:19], v10, s[12:15], s53 offen
    s_add_u32 s53, s53, s50
    s_waitcnt lgkmcnt(2)
    buffer_store_dwordx4 v[20:23], v10, s[12:15], s53 offen
    s_add_u32 s53, s53, s50
    s_waitcnt lgkmcnt(1)
    buffer_store_dwordx4 v[24:27], v10, s[12:15], s53 offen
    s_add_u32 s53, s53, s50
    s_waitcnt lgkmcnt(0)
    buffer_store_dwordx4 v[28:31], v10, s[12:15], s53 offen
    s_add_u32 s53, s53, s50
    s_mov_b64 exec, -1
L_g1_fin:
    s_waitcnt vmcnt(0)
L_g1_end:
    s_endpgm
.globl attn_kv_kernel
.p2align 8
.type attn_kv_kernel,@function
attn_kv_kernel:
    s_load_dwordx2 s[4:5], s[0:1], 16
    s_load_dwordx2 s[6:7], s[0:1], 72
    s_cmp_ge_u32 s2, 256
    s_cbranch_scc1 L_kv_end
    s_and_b32 s20, s2, 31
    s_lshr_b32 s21, s2, 5
    s_mul_i32 s22, s20, 648
    s_waitcnt lgkmcnt(0)
    s_mov_b32 s8, s6
    s_mov_b32 s9, s7
    s_mov_b32 s10, 7077888
    s_mov_b32 s11, 0x00020000
    s_add_u32 s8, s8, 29360128
    s_addc_u32 s9, s9, 0
    s_mov_b32 s12, s4
    s_mov_b32 s13, s5
    s_mov_b32 s14, 20736
    s_mov_b32 s15, 0x00020000
    s_lshl_b32 s23, s21, 8
    v_add_u32 v7, s23, v0
    s_movk_i32 s23, 3456
    v_mul_lo_u32 v7, v7, s23
    s_mul_i32 s23, s20, 36
    v_add_u32 v7, s23, v7
    s_mov_b32 s16, s6
    s_mov_b32 s17, s7
    s_mov_b32 s18, 1572864
    s_mov_b32 s19, 0x00020000
    s_add_u32 s16, s16, 37748736
    s_addc_u32 s17, s17, 0
    buffer_load_dwordx4 v[30:33], v7, s[8:11], 0 offen offset:2304
    buffer_load_dwordx4 v[34:37], v7, s[8:11], 0 offen offset:2320
    buffer_load_dword v38, v7, s[8:11], 0 offen offset:2336
    v_mov_b32 v8, 0
    v_mov_b32 v9, 0
    v_lshlrev_b32 v2, 3, v0
    ds_write_b64 v2, v[8:9] offset:0
    v_lshlrev_b32 v2, 2, v0
    v_add_u32 v2, s22, v2
    v_cmp_gt_u32 vcc, 162, v0
    s_and_saveexec_b64 s[24:25], vcc
    buffer_load_dword v3, v2, s[12:15], 0 offen
    s_mov_b64 exec, s[24:25]
    v_mul_u32_u24 v4, 57, v0
    v_lshrrev_b32 v4, 9, v4
    v_mul_u32_u24 v5, 9, v4
    v_sub_u32 v5, v0, v5
    v_lshlrev_b32 v5, 7, v5
    v_lshl_add_u32 v4, v4, 1, v5
    s_waitcnt lgkmcnt(0)
    s_barrier
    s_and_saveexec_b64 s[24:25], vcc
    s_waitcnt vmcnt(0)
    ds_write_b16 v4, v3 offset:0
    ds_write_b16_d16_hi v4, v3 offset:64
    s_mov_b64 exec, s[24:25]
    s_waitcnt lgkmcnt(0)
    s_barrier
    v_and_b32 v1, 63, v0
    v_and_b32 v8, 15, v1
    v_lshrrev_b32 v9, 4, v1
    v_lshlrev_b32 v10, 6, v8
    v_lshl_add_u32 v10, v9, 4, v10
    ds_read_b128 v[12:15], v10 offset:0
    ds_read_b128 v[16:19], v10 offset:1024
    v_sub_u32 v11, v8, v1
    s_movk_i32 s23, 3456
    v_mul_lo_u32 v11, v11, s23
    v_add_u32 v11, v11, v7
    v_lshl_add_u32 v11, v9, 4, v11
    s_mov_b32 s23, 0
    buffer_load_dwordx4 v[100:103], v11, s[8:11], s23 offen offset:1152
    s_mov_b32 s23, 55296
    buffer_load_dwordx4 v[104:107], v11, s[8:11], s23 offen offset:1152
    s_mov_b32 s23, 110592
    buffer_load_dwordx4 v[108:111], v11, s[8:11], s23 offen offset:1152
    s_mov_b32 s23, 165888
    buffer_load_dwordx4 v[112:115], v11, s[8:11], s23 offen offset:1152
    v_and_b32 v10, 0xc0, v0
    v_add_u32 v10, v10, v8
    v_mul_u32_u24 v10, 48, v10
    v_lshl_add_u32 v10, v9, 3, v10
    v_cmp_eq_u32 vcc, 0, v9
    v_mov_b32 v40, 0
    v_mov_b32 v41, 0
    v_mov_b32 v42, 0
    v_mov_b32 v43, 0
    v_mov_b32 v44, 0
    v_mov_b32 v45, 0
    v_mov_b32 v46, 0
    v_mov_b32 v47, 0
    s_waitcnt vmcnt(3) lgkmcnt(0)
    v_mfma_f32_16x16x32_bf16 v[40:43], v[12:15], v[100:103], v[40:43]
    v_mfma_f32_16x16x32_bf16 v[44:47], v[16:19], v[100:103], v[44:47]
    s_nop 7
    s_nop 1
    v_cvt_pk_bf16_f32 v48, v40, v41
    v_cvt_pk_bf16_f32 v49, v42, v43
    v_cvt_pk_bf16_f32 v50, v44, v45
    ds_write_b64 v10, v[48:49] offset:2048
    s_and_saveexec_b64 s[24:25], vcc
    ds_write_b32 v10, v50 offset:2080
    s_mov_b64 exec, s[24:25]
    v_mov_b32 v40, 0
    v_mov_b32 v41, 0
    v_mov_b32 v42, 0
    v_mov_b32 v43, 0
    v_mov_b32 v44, 0
    v_mov_b32 v45, 0
    v_mov_b32 v46, 0
    v_mov_b32 v47, 0
    s_waitcnt vmcnt(2) lgkmcnt(0)
    v_mfma_f32_16x16x32_bf16 v[40:43], v[12:15], v[104:107], v[40:43]
    v_mfma_f32_16x16x32_bf16 v[44:47], v[16:19], v[104:107], v[44:47]
    s_nop 7
    s_nop 1
    v_cvt_pk_bf16_f32 v48, v40, v41
    v_cvt_pk_bf16_f32 v49, v42, v43
    v_cvt_pk_bf16_f32 v50, v44, v45
    ds_write_b64 v10, v[48:49] offset:2816
    s_and_saveexec_b64 s[24:25], vcc
    ds_write_b32 v10, v50 offset:2848
    s_mov_b64 exec, s[24:25]
    v_mov_b32 v40, 0
    v_mov_b32 v41, 0
    v_mov_b32 v42, 0
    v_mov_b32 v43, 0
    v_mov_b32 v44, 0
    v_mov_b32 v45, 0
    v_mov_b32 v46, 0
    v_mov_b32 v47, 0
    s_waitcnt vmcnt(1) lgkmcnt(0)
    v_mfma_f32_16x16x32_bf16 v[40:43], v[12:15], v[108:111], v[40:43]
    v_mfma_f32_16x16x32_bf16 v[44:47], v[16:19], v[108:111], v[44:47]
    s_nop 7
    s_nop 1
    v_cvt_pk_bf16_f32 v48, v40, v41
    v_cvt_pk_bf16_f32 v49, v42, v43
    v_cvt_pk_bf16_f32 v50, v44, v45
    ds_write_b64 v10, v[48:49] offset:3584
    s_and_saveexec_b64 s[24:25], vcc
    ds_write_b32 v10, v50 offset:3616
    s_mov_b64 exec, s[24:25]
    v_mov_b32 v40, 0
    v_mov_b32 v41, 0
    v_mov_b32 v42, 0
    v_mov_b32 v43, 0
    v_mov_b32 v44, 0
    v_mov_b32 v45, 0
    v_mov_b32 v46, 0
    v_mov_b32 v47, 0
    s_waitcnt vmcnt(0) lgkmcnt(0)
    v_mfma_f32_16x16x32_bf16 v[40:43], v[12:15], v[112:115], v[40:43]
    v_mfma_f32_16x16x32_bf16 v[44:47], v[16:19], v[112:115], v[44:47]
    s_nop 7
    s_nop 1
    v_cvt_pk_bf16_f32 v48, v40, v41
    v_cvt_pk_bf16_f32 v49, v42, v43
    v_cvt_pk_bf16_f32 v50, v44, v45
    ds_write_b64 v10, v[48:49] offset:4352
    s_and_saveexec_b64 s[24:25], vcc
    ds_write_b32 v10, v50 offset:4384
    s_mov_b64 exec, s[24:25]
    v_mul_u32_u24 v10, 48, v0
    s_waitcnt lgkmcnt(0)
    ds_read_b128 v[20:23], v10 offset:2048
    ds_read_b128 v[24:27], v10 offset:2064
    ds_read_b32 v28, v10 offset:2080
    s_waitcnt lgkmcnt(0)
    v_lshlrev_b32 v60, 16, v20
    v_and_b32 v61, 0xffff0000, v20
    v_lshlrev_b32 v62, 16, v21
    v_and_b32 v63, 0xffff0000, v21
    v_lshlrev_b32 v64, 16, v22
    v_and_b32 v65, 0xffff0000, v22
    v_lshlrev_b32 v66, 16, v23
    v_and_b32 v67, 0xffff0000, v23
    v_lshlrev_b32 v68, 16, v24
    v_and_b32 v69, 0xffff0000, v24
    v_lshlrev_b32 v70, 16, v25
    v_and_b32 v71, 0xffff0000, v25
    v_lshlrev_b32 v72, 16, v26
    v_and_b32 v73, 0xffff0000, v26
    v_lshlrev_b32 v74, 16, v27
    v_and_b32 v75, 0xffff0000, v27
    v_lshlrev_b32 v76, 16, v28
    v_and_b32 v77, 0xffff0000, v28
    v_max3_f32 v40, v60, v61, v62
    v_min3_f32 v41, v60, v61, v62
    v_max3_f32 v40, v40, v63, v64
    v_min3_f32 v41, v41, v63, v64
    v_max3_f32 v40, v40, v65, v66
    v_min3_f32 v41, v41, v65, v66
    v_max3_f32 v40, v40, v67, v68
    v_min3_f32 v41, v41, v67, v68
    v_max3_f32 v40, v40, v69, v70
    v_min3_f32 v41, v41, v69, v70
    v_max3_f32 v40, v40, v71, v72
    v_min3_f32 v41, v41, v71, v72
    v_max3_f32 v40, v40, v73, v74
    v_min3_f32 v41, v41, v73, v74
    v_max3_f32 v40, v40, v75, v76
    v_min3_f32 v41, v41, v75, v76
    v_max_f32 v40, v40, v77
    v_min_f32 v41, v41, v77
    s_mov_b32 s26, 0x3fb8aa3b
    v_mul_f32 v40, s26, v40
    v_mul_f32 v41, s26, v41
    v_fma_f32 v80, v60, s26, -v40
    v_fma_f32 v98, -v60, s26, v41
    v_fma_f32 v81, v61, s26, -v40
    v_fma_f32 v99, -v61, s26, v41
    v_fma_f32 v82, v62, s26, -v40
    v_fma_f32 v100, -v62, s26, v41
    v_fma_f32 v83, v63, s26, -v40
    v_fma_f32 v101, -v63, s26, v41
    v_fma_f32 v84, v64, s26, -v40
    v_fma_f32 v102, -v64, s26, v41
    v_fma_f32 v85, v65, s26, -v40
    v_fma_f32 v103, -v65, s26, v41
    v_fma_f32 v86, v66, s26, -v40
    v_fma_f32 v104, -v66, s26, v41
    v_fma_f32 v87, v67, s26, -v40
    v_fma_f32 v105, -v67, s26, v41
    v_fma_f32 v88, v68, s26, -v40
    v_fma_f32 v106, -v68, s26, v41
    v_fma_f32 v89, v69, s26, -v40
    v_fma_f32 v107, -v69, s26, v41
    v_fma_f32 v90, v70, s26, -v40
    v_fma_f32 v108, -v70, s26, v41
    v_fma_f32 v91, v71, s26, -v40
    v_fma_f32 v109, -v71, s26, v41
    v_fma_f32 v92, v72, s26, -v40
    v_fma_f32 v110, -v72, s26, v41
    v_fma_f32 v93, v73, s26, -v40
    v_fma_f32 v111, -v73, s26, v41
    v_fma_f32 v94, v74, s26, -v40
    v_fma_f32 v112, -v74, s26, v41
    v_fma_f32 v95, v75, s26, -v40
    v_fma_f32 v113, -v75, s26, v41
    v_fma_f32 v96, v76, s26, -v40
    v_fma_f32 v114, -v76, s26, v41
    v_fma_f32 v97, v77, s26, -v40
    v_fma_f32 v115, -v77, s26, v41
    v_exp_f32 v80, v80
    v_exp_f32 v81, v81
    v_exp_f32 v82, v82
    v_exp_f32 v83, v83
    v_exp_f32 v84, v84
    v_exp_f32 v85, v85
    v_exp_f32 v86, v86
    v_exp_f32 v87, v87
    v_exp_f32 v88, v88
    v_exp_f32 v89, v89
    v_exp_f32 v90, v90
    v_exp_f32 v91, v91
    v_exp_f32 v92, v92
    v_exp_f32 v93, v93
    v_exp_f32 v94, v94
    v_exp_f32 v95, v95
    v_exp_f32 v96, v96
    v_exp_f32 v97, v97
    v_exp_f32 v98, v98
    v_exp_f32 v99, v99
    v_exp_f32 v100, v100
    v_exp_f32 v101, v101
    v_exp_f32 v102, v102
    v_exp_f32 v103, v103
    v_exp_f32 v104, v104
    v_exp_f32 v105, v105
    v_exp_f32 v106, v106
    v_exp_f32 v107, v107
    v_exp_f32 v108, v108
    v_exp_f32 v109, v109
    v_exp_f32 v110, v110
    v_exp_f32 v111, v111
    v_exp_f32 v112, v112
    v_exp_f32 v113, v113
    v_exp_f32 v114, v114
    v_exp_f32 v115, v115
    v_add_f32 v42, v80, v81
    v_add_f32 v42, v42, v82
    v_add_f32 v42, v42, v83
    v_add_f32 v42, v42, v84
    v_add_f32 v42, v42, v85
    v_add_f32 v42, v42, v86
    v_add_f32 v42, v42, v87
    v_add_f32 v42, v42, v88
    v_add_f32 v42, v42, v89
    v_add_f32 v42, v42, v90
    v_add_f32 v42, v42, v91
    v_add_f32 v42, v42, v92
    v_add_f32 v42, v42, v93
    v_add_f32 v42, v42, v94
    v_add_f32 v42, v42, v95
    v_add_f32 v42, v42, v96
    v_add_f32 v42, v42, v97
    v_add_f32 v43, v98, v99
    v_add_f32 v43, v43, v100
    v_add_f32 v43, v43, v101
    v_add_f32 v43, v43, v102
    v_add_f32 v43, v43, v103
    v_add_f32 v43, v43, v104
    v_add_f32 v43, v43, v105
    v_add_f32 v43, v43, v106
    v_add_f32 v43, v43, v107
    v_add_f32 v43, v43, v108
    v_add_f32 v43, v43, v109
    v_add_f32 v43, v43, v110
    v_add_f32 v43, v43, v111
    v_add_f32 v43, v43, v112
    v_add_f32 v43, v43, v113
    v_add_f32 v43, v43, v114
    v_add_f32 v43, v43, v115
    v_rcp_f32 v42, v42
    v_rcp_f32 v43, v43
    s_nop 0
    v_mul_f32 v80, v80, v42
    v_mul_f32 v81, v81, v42
    v_mul_f32 v82, v82, v42
    v_mul_f32 v83, v83, v42
    v_mul_f32 v84, v84, v42
    v_mul_f32 v85, v85, v42
    v_mul_f32 v86, v86, v42
    v_mul_f32 v87, v87, v42
    v_mul_f32 v88, v88, v42
    v_mul_f32 v89, v89, v42
    v_mul_f32 v90, v90, v42
    v_mul_f32 v91, v91, v42
    v_mul_f32 v92, v92, v42
    v_mul_f32 v93, v93, v42
    v_mul_f32 v94, v94, v42
    v_mul_f32 v95, v95, v42
    v_mul_f32 v96, v96, v42
    v_mul_f32 v97, v97, v42
    v_mul_f32 v98, v98, v43
    v_mul_f32 v99, v99, v43
    v_mul_f32 v100, v100, v43
    v_mul_f32 v101, v101, v43
    v_mul_f32 v102, v102, v43
    v_mul_f32 v103, v103, v43
    v_mul_f32 v104, v104, v43
    v_mul_f32 v105, v105, v43
    v_mul_f32 v106, v106, v43
    v_mul_f32 v107, v107, v43
    v_mul_f32 v108, v108, v43
    v_mul_f32 v109, v109, v43
    v_mul_f32 v110, v110, v43
    v_mul_f32 v111, v111, v43
    v_mul_f32 v112, v112, v43
    v_mul_f32 v113, v113, v43
    v_mul_f32 v114, v114, v43
    v_mul_f32 v115, v115, v43
    v_cvt_pk_bf16_f32 v120, v80, v81
    v_cvt_pk_bf16_f32 v121, v82, v83
    v_cvt_pk_bf16_f32 v122, v84, v85
    v_cvt_pk_bf16_f32 v123, v86, v87
    v_cvt_pk_bf16_f32 v124, v88, v89
    v_cvt_pk_bf16_f32 v125, v90, v91
    v_cvt_pk_bf16_f32 v126, v92, v93
    v_cvt_pk_bf16_f32 v127, v94, v95
    v_cvt_pk_bf16_f32 v128, v96, v97
    v_cvt_pk_bf16_f32 v129, v98, v99
    v_cvt_pk_bf16_f32 v130, v100, v101
    v_cvt_pk_bf16_f32 v131, v102, v103
    v_cvt_pk_bf16_f32 v132, v104, v105
    v_cvt_pk_bf16_f32 v133, v106, v107
    v_cvt_pk_bf16_f32 v134, v108, v109
    v_cvt_pk_bf16_f32 v135, v110, v111
    v_cvt_pk_bf16_f32 v136, v112, v113
    v_cvt_pk_bf16_f32 v137, v114, v115
    v_mul_u32_u24 v2, 96, v0
    ds_write_b128 v2, v[120:123] offset:14336
    ds_write_b128 v2, v[124:127] offset:14352
    ds_write_b128 v2, v[128:131] offset:14368
    ds_write_b128 v2, v[132:135] offset:14384
    ds_write_b64 v2, v[136:137] offset:14400
    v_lshlrev_b32 v2, 6, v0
    v_mov_b32 v39, 0x3f80
    ds_write_b128 v2, v[30:33] offset:38912
    ds_write_b128 v2, v[34:37] offset:38928
    ds_write_b64 v2, v[38:39] offset:38944
    s_waitcnt lgkmcnt(0)
    s_barrier
    v_and_b32 v1, 63, v0
    v_lshrrev_b32 v2, 6, v0
    s_nop 0
    v_readfirstlane_b32 s30, v2
    v_lshrrev_b32 v3, 4, v1
    v_bfe_u32 v4, v1, 2, 2
    v_lshl_add_u32 v4, v3, 3, v4
    v_and_b32 v5, 3, v1
    v_lshlrev_b32 v5, 3, v5
    s_and_b32 s31, s30, 1
    s_lshl_b32 s32, s31, 5
    v_lshl_add_u32 v6, v4, 6, v5
    v_add_u32 v6, s32, v6
    v_mul_u32_u24 v8, 96, v4
    v_add_u32 v8, v8, v5
    s_lshr_b32 s33, s30, 1
    s_lshl_b32 s33, s33, 5
    v_add_u32 v9, s33, v8
    v_add_u32 v10, 64, v8
    v_mov_b32 v12, 0
    v_mov_b32 v13, 0
    v_mov_b32 v14, 0
    v_mov_b32 v15, 0
    v_mov_b32 v16, 0
    v_mov_b32 v17, 0
    v_mov_b32 v18, 0
    v_mov_b32 v19, 0
    ds_read_b64_tr_b16 v[24:25], v6 offset:38912
    ds_read_b64_tr_b16 v[26:27], v6 offset:39168
    ds_read_b64_tr_b16 v[28:29], v9 offset:14336
    ds_read_b64_tr_b16 v[30:31], v9 offset:14720
    ds_read_b64_tr_b16 v[32:33], v10 offset:14336
    ds_read_b64_tr_b16 v[34:35], v10 offset:14720
    s_waitcnt lgkmcnt(0)
    v_mfma_f32_16x16x32_bf16 v[12:15], v[24:27], v[28:31], v[12:15]
    v_mfma_f32_16x16x32_bf16 v[16:19], v[24:27], v[32:35], v[16:19]
    s_nop 1
    ds_read_b64_tr_b16 v[24:25], v6 offset:40960
    ds_read_b64_tr_b16 v[26:27], v6 offset:41216
    ds_read_b64_tr_b16 v[28:29], v9 offset:17408
    ds_read_b64_tr_b16 v[30:31], v9 offset:17792
    ds_read_b64_tr_b16 v[32:33], v10 offset:17408
    ds_read_b64_tr_b16 v[34:35], v10 offset:17792
    s_waitcnt lgkmcnt(0)
    v_mfma_f32_16x16x32_bf16 v[12:15], v[24:27], v[28:31], v[12:15]
    v_mfma_f32_16x16x32_bf16 v[16:19], v[24:27], v[32:35], v[16:19]
    s_nop 1
    ds_read_b64_tr_b16 v[24:25], v6 offset:43008
    ds_read_b64_tr_b16 v[26:27], v6 offset:43264
    ds_read_b64_tr_b16 v[28:29], v9 offset:20480
    ds_read_b64_tr_b16 v[30:31], v9 offset:20864
    ds_read_b64_tr_b16 v[32:33], v10 offset:20480
    ds_read_b64_tr_b16 v[34:35], v10 offset:20864
    s_waitcnt lgkmcnt(0)
    v_mfma_f32_16x16x32_bf16 v[12:15], v[24:27], v[28:31], v[12:15]
    v_mfma_f32_16x16x32_bf16 v[16:19], v[24:27], v[32:35], v[16:19]
    s_nop 1
    ds_read_b64_tr_b16 v[24:25], v6 offset:45056
    ds_read_b64_tr_b16 v[26:27], v6 offset:45312
    ds_read_b64_tr_b16 v[28:29], v9 offset:23552
    ds_read_b64_tr_b16 v[30:31], v9 offset:23936
    ds_read_b64_tr_b16 v[32:33], v10 offset:23552
    ds_read_b64_tr_b16 v[34:35], v10 offset:23936
    s_waitcnt lgkmcnt(0)
    v_mfma_f32_16x16x32_bf16 v[12:15], v[24:27], v[28:31], v[12:15]
    v_mfma_f32_16x16x32_bf16 v[16:19], v[24:27], v[32:35], v[16:19]
    s_nop 1
    ds_read_b64_tr_b16 v[24:25], v6 offset:47104
    ds_read_b64_tr_b16 v[26:27], v6 offset:47360
    ds_read_b64_tr_b16 v[28:29], v9 offset:26624
    ds_read_b64_tr_b16 v[30:31], v9 offset:27008
    ds_read_b64_tr_b16 v[32:33], v10 offset:26624
    ds_read_b64_tr_b16 v[34:35], v10 offset:27008
    s_waitcnt lgkmcnt(0)
    v_mfma_f32_16x16x32_bf16 v[12:15], v[24:27], v[28:31], v[12:15]
    v_mfma_f32_16x16x32_bf16 v[16:19], v[24:27], v[32:35], v[16:19]
    s_nop 1
    ds_read_b64_tr_b16 v[24:25], v6 offset:49152
    ds_read_b64_tr_b16 v[26:27], v6 offset:49408
    ds_read_b64_tr_b16 v[28:29], v9 offset:29696
    ds_read_b64_tr_b16 v[30:31], v9 offset:30080
    ds_read_b64_tr_b16 v[32:33], v10 offset:29696
    ds_read_b64_tr_b16 v[34:35], v10 offset:30080
    s_waitcnt lgkmcnt(0)
    v_mfma_f32_16x16x32_bf16 v[12:15], v[24:27], v[28:31], v[12:15]
    v_mfma_f32_16x16x32_bf16 v[16:19], v[24:27], v[32:35], v[16:19]
    s_nop 1
    ds_read_b64_tr_b16 v[24:25], v6 offset:51200
    ds_read_b64_tr_b16 v[26:27], v6 offset:51456
    ds_read_b64_tr_b16 v[28:29], v9 offset:32768
    ds_read_b64_tr_b16 v[30:31], v9 offset:33152
    ds_read_b64_tr_b16 v[32:33], v10 offset:32768
    ds_read_b64_tr_b16 v[34:35], v10 offset:33152
    s_waitcnt lgkmcnt(0)
    v_mfma_f32_16x16x32_bf16 v[12:15], v[24:27], v[28:31], v[12:15]
    v_mfma_f32_16x16x32_bf16 v[16:19], v[24:27], v[32:35], v[16:19]
    s_nop 1
    ds_read_b64_tr_b16 v[24:25], v6 offset:53248
    ds_read_b64_tr_b16 v[26:27], v6 offset:53504
    ds_read_b64_tr_b16 v[28:29], v9 offset:35840
    ds_read_b64_tr_b16 v[30:31], v9 offset:36224
    ds_read_b64_tr_b16 v[32:33], v10 offset:35840
    ds_read_b64_tr_b16 v[34:35], v10 offset:36224
    s_waitcnt lgkmcnt(0)
    v_mfma_f32_16x16x32_bf16 v[12:15], v[24:27], v[28:31], v[12:15]
    v_mfma_f32_16x16x32_bf16 v[16:19], v[24:27], v[32:35], v[16:19]
    s_nop 1
    s_nop 7
    v_and_b32 v2, 15, v1
    v_lshlrev_b32 v2, 7, v2
    v_lshl_add_u32 v2, v3, 4, v2
    s_lshl_b32 s34, s20, 3
    s_add_u32 s34, s34, s21
    s_mul_i32 s34, s34, 6144
    s_lshl_b32 s35, s31, 6
    s_add_u32 s34, s34, s35
    s_lshl_b32 s35, s33, 6
    s_add_u32 s35, s35, s34
    buffer_store_dwordx4 v[12:15], v2, s[16:19], s35 offen
    s_add_u32 s35, s34, 4096
    buffer_store_dwordx4 v[16:19], v2, s[16:19], s35 offen
L_kv_end:
    s_endpgm
.globl attn_o_kernel
.p2align 8
.type attn_o_kernel,@function
attn_o_kernel:
    s_load_dwordx2 s[4:5], s[0:1], 16
    s_load_dwordx2 s[6:7], s[0:1], 72
    s_cmp_ge_u32 s2, 256
    s_cbranch_scc1 L_o_end
    s_and_b32 s20, s2, 31
    s_lshr_b32 s21, s2, 5
    s_mul_i32 s22, s20, 648
    s_waitcnt lgkmcnt(0)
    s_mov_b32 s8, s6
    s_mov_b32 s9, s7
    s_mov_b32 s10, 7077888
    s_mov_b32 s11, 0x00020000
    s_add_u32 s8, s8, 29360128
    s_addc_u32 s9, s9, 0
    s_mov_b32 s12, s4
    s_mov_b32 s13, s5
    s_mov_b32 s14, 20736
    s_mov_b32 s15, 0x00020000
    s_lshl_b32 s23, s21, 8
    v_add_u32 v7, s23, v0
    s_movk_i32 s23, 3456
    v_mul_lo_u32 v7, v7, s23
    s_mul_i32 s23, s20, 36
    v_add_u32 v7, s23, v7
    s_mov_b32 s16, s6
    s_mov_b32 s17, s7
    s_mov_b32 s18, 1572864
    s_mov_b32 s19, 0x00020000
    s_add_u32 s16, s16, 37748736
    s_addc_u32 s17, s17, 0
    v_mov_b32 v8, 0
    v_mov_b32 v9, 0
    v_mov_b32 v10, 0
    v_mov_b32 v11, 0
    v_lshlrev_b32 v2, 4, v0
    ds_write_b128 v2, v[8:11] offset:14336
    s_mul_i32 s34, s20, 49152
    v_lshlrev_b32 v2, 2, v0
    s_add_u32 s35, s34, 0
    buffer_load_dword v140, v2, s[16:19], s35 offen
    s_add_u32 s35, s34, 6144
    buffer_load_dword v141, v2, s[16:19], s35 offen
    s_add_u32 s35, s34, 12288
    buffer_load_dword v142, v2, s[16:19], s35 offen
    s_add_u32 s35, s34, 18432
    buffer_load_dword v143, v2, s[16:19], s35 offen
    s_add_u32 s35, s34, 24576
    buffer_load_dword v144, v2, s[16:19], s35 offen
    s_add_u32 s35, s34, 30720
    buffer_load_dword v145, v2, s[16:19], s35 offen
    s_add_u32 s35, s34, 36864
    buffer_load_dword v146, v2, s[16:19], s35 offen
    s_add_u32 s35, s34, 43008
    buffer_load_dword v147, v2, s[16:19], s35 offen
    s_add_u32 s35, s34, 1024
    buffer_load_dword v148, v2, s[16:19], s35 offen
    s_add_u32 s35, s34, 7168
    buffer_load_dword v149, v2, s[16:19], s35 offen
    s_add_u32 s35, s34, 13312
    buffer_load_dword v150, v2, s[16:19], s35 offen
    s_add_u32 s35, s34, 19456
    buffer_load_dword v151, v2, s[16:19], s35 offen
    s_add_u32 s35, s34, 25600
    buffer_load_dword v152, v2, s[16:19], s35 offen
    s_add_u32 s35, s34, 31744
    buffer_load_dword v153, v2, s[16:19], s35 offen
    s_add_u32 s35, s34, 37888
    buffer_load_dword v154, v2, s[16:19], s35 offen
    s_add_u32 s35, s34, 44032
    buffer_load_dword v155, v2, s[16:19], s35 offen
    s_add_u32 s35, s34, 2048
    buffer_load_dword v156, v2, s[16:19], s35 offen
    s_add_u32 s35, s34, 8192
    buffer_load_dword v157, v2, s[16:19], s35 offen
    s_add_u32 s35, s34, 14336
    buffer_load_dword v158, v2, s[16:19], s35 offen
    s_add_u32 s35, s34, 20480
    buffer_load_dword v159, v2, s[16:19], s35 offen
    s_add_u32 s35, s34, 26624
    buffer_load_dword v160, v2, s[16:19], s35 offen
    s_add_u32 s35, s34, 32768
    buffer_load_dword v161, v2, s[16:19], s35 offen
    s_add_u32 s35, s34, 38912
    buffer_load_dword v162, v2, s[16:19], s35 offen
    s_add_u32 s35, s34, 45056
    buffer_load_dword v163, v2, s[16:19], s35 offen
    s_add_u32 s35, s34, 3072
    buffer_load_dword v164, v2, s[16:19], s35 offen
    s_add_u32 s35, s34, 9216
    buffer_load_dword v165, v2, s[16:19], s35 offen
    s_add_u32 s35, s34, 15360
    buffer_load_dword v166, v2, s[16:19], s35 offen
    s_add_u32 s35, s34, 21504
    buffer_load_dword v167, v2, s[16:19], s35 offen
    s_add_u32 s35, s34, 27648
    buffer_load_dword v168, v2, s[16:19], s35 offen
    s_add_u32 s35, s34, 33792
    buffer_load_dword v169, v2, s[16:19], s35 offen
    s_add_u32 s35, s34, 39936
    buffer_load_dword v170, v2, s[16:19], s35 offen
    s_add_u32 s35, s34, 46080
    buffer_load_dword v171, v2, s[16:19], s35 offen
    s_add_u32 s35, s34, 4096
    buffer_load_dword v172, v2, s[16:19], s35 offen
    s_add_u32 s35, s34, 10240
    buffer_load_dword v173, v2, s[16:19], s35 offen
    s_add_u32 s35, s34, 16384
    buffer_load_dword v174, v2, s[16:19], s35 offen
    s_add_u32 s35, s34, 22528
    buffer_load_dword v175, v2, s[16:19], s35 offen
    s_add_u32 s35, s34, 28672
    buffer_load_dword v176, v2, s[16:19], s35 offen
    s_add_u32 s35, s34, 34816
    buffer_load_dword v177, v2, s[16:19], s35 offen
    s_add_u32 s35, s34, 40960
    buffer_load_dword v178, v2, s[16:19], s35 offen
    s_add_u32 s35, s34, 47104
    buffer_load_dword v179, v2, s[16:19], s35 offen
    s_add_u32 s35, s34, 5120
    buffer_load_dword v180, v2, s[16:19], s35 offen
    s_add_u32 s35, s34, 11264
    buffer_load_dword v181, v2, s[16:19], s35 offen
    s_add_u32 s35, s34, 17408
    buffer_load_dword v182, v2, s[16:19], s35 offen
    s_add_u32 s35, s34, 23552
    buffer_load_dword v183, v2, s[16:19], s35 offen
    s_add_u32 s35, s34, 29696
    buffer_load_dword v184, v2, s[16:19], s35 offen
    s_add_u32 s35, s34, 35840
    buffer_load_dword v185, v2, s[16:19], s35 offen
    s_add_u32 s35, s34, 41984
    buffer_load_dword v186, v2, s[16:19], s35 offen
    s_add_u32 s35, s34, 48128
    buffer_load_dword v187, v2, s[16:19], s35 offen
    v_mov_b32 v8, 0
    v_mov_b32 v9, 0
    v_lshlrev_b32 v2, 3, v0
    ds_write_b64 v2, v[8:9] offset:0
    v_lshlrev_b32 v2, 2, v0
    v_add_u32 v2, s22, v2
    v_cmp_gt_u32 vcc, 162, v0
    s_and_saveexec_b64 s[24:25], vcc
    buffer_load_dword v3, v2, s[12:15], 0 offen
    s_mov_b64 exec, s[24:25]
    v_mul_u32_u24 v4, 57, v0
    v_lshrrev_b32 v4, 9, v4
    v_mul_u32_u24 v5, 9, v4
    v_sub_u32 v5, v0, v5
    v_lshlrev_b32 v5, 7, v5
    v_lshl_add_u32 v4, v4, 1, v5
    s_waitcnt lgkmcnt(0)
    s_barrier
    s_and_saveexec_b64 s[24:25], vcc
    s_waitcnt vmcnt(0)
    ds_write_b16 v4, v3 offset:0
    ds_write_b16_d16_hi v4, v3 offset:64
    s_mov_b64 exec, s[24:25]
    s_waitcnt lgkmcnt(0)
    s_barrier
    s_waitcnt vmcnt(0)
    v_add_f32 v140, v140, v141
    v_add_f32 v140, v140, v142
    v_add_f32 v140, v140, v143
    v_add_f32 v140, v140, v144
    v_add_f32 v140, v140, v145
    v_add_f32 v140, v140, v146
    v_add_f32 v140, v140, v147
    v_cvt_pk_bf16_f32 v140, v140, v140
    v_lshrrev_b32 v3, 5, v0
    v_add_u32 v3, 0, v3
    v_and_b32 v4, 31, v0
    v_lshlrev_b32 v5, 7, v4
    v_lshl_add_u32 v5, v3, 1, v5
    v_cmp_gt_u32 vcc, 36, v3
    v_cmp_gt_u32 s[24:25], 18, v4
    s_and_b64 s[24:25], s[24:25], vcc
    s_and_saveexec_b64 s[26:27], s[24:25]
    ds_write_b16 v5, v140 offset:14336
    s_mov_b64 exec, s[26:27]
    v_cmp_eq_u32 s[24:25], 18, v4
    s_and_b64 s[24:25], s[24:25], vcc
    s_and_saveexec_b64 s[26:27], s[24:25]
    ds_write_b16 v5, v140 offset:14336
    ds_write_b16 v5, v140 offset:14848
    ds_write_b16 v5, v140 offset:15360
    ds_write_b16 v5, v140 offset:15872
    s_mov_b64 exec, s[26:27]
    v_add_f32 v148, v148, v149
    v_add_f32 v148, v148, v150
    v_add_f32 v148, v148, v151
    v_add_f32 v148, v148, v152
    v_add_f32 v148, v148, v153
    v_add_f32 v148, v148, v154
    v_add_f32 v148, v148, v155
    v_cvt_pk_bf16_f32 v148, v148, v148
    v_lshrrev_b32 v3, 5, v0
    v_add_u32 v3, 8, v3
    v_and_b32 v4, 31, v0
    v_lshlrev_b32 v5, 7, v4
    v_lshl_add_u32 v5, v3, 1, v5
    v_cmp_gt_u32 vcc, 36, v3
    v_cmp_gt_u32 s[24:25], 18, v4
    s_and_b64 s[24:25], s[24:25], vcc
    s_and_saveexec_b64 s[26:27], s[24:25]
    ds_write_b16 v5, v148 offset:14336
    s_mov_b64 exec, s[26:27]
    v_cmp_eq_u32 s[24:25], 18, v4
    s_and_b64 s[24:25], s[24:25], vcc
    s_and_saveexec_b64 s[26:27], s[24:25]
    ds_write_b16 v5, v148 offset:14336
    ds_write_b16 v5, v148 offset:14848
    ds_write_b16 v5, v148 offset:15360
    ds_write_b16 v5, v148 offset:15872
    s_mov_b64 exec, s[26:27]
    v_add_f32 v156, v156, v157
    v_add_f32 v156, v156, v158
    v_add_f32 v156, v156, v159
    v_add_f32 v156, v156, v160
    v_add_f32 v156, v156, v161
    v_add_f32 v156, v156, v162
    v_add_f32 v156, v156, v163
    v_cvt_pk_bf16_f32 v156, v156, v156
    v_lshrrev_b32 v3, 5, v0
    v_add_u32 v3, 16, v3
    v_and_b32 v4, 31, v0
    v_lshlrev_b32 v5, 7, v4
    v_lshl_add_u32 v5, v3, 1, v5
    v_cmp_gt_u32 vcc, 36, v3
    v_cmp_gt_u32 s[24:25], 18, v4
    s_and_b64 s[24:25], s[24:25], vcc
    s_and_saveexec_b64 s[26:27], s[24:25]
    ds_write_b16 v5, v156 offset:14336
    s_mov_b64 exec, s[26:27]
    v_cmp_eq_u32 s[24:25], 18, v4
    s_and_b64 s[24:25], s[24:25], vcc
    s_and_saveexec_b64 s[26:27], s[24:25]
    ds_write_b16 v5, v156 offset:14336
    ds_write_b16 v5, v156 offset:14848
    ds_write_b16 v5, v156 offset:15360
    ds_write_b16 v5, v156 offset:15872
    s_mov_b64 exec, s[26:27]
    v_add_f32 v164, v164, v165
    v_add_f32 v164, v164, v166
    v_add_f32 v164, v164, v167
    v_add_f32 v164, v164, v168
    v_add_f32 v164, v164, v169
    v_add_f32 v164, v164, v170
    v_add_f32 v164, v164, v171
    v_cvt_pk_bf16_f32 v164, v164, v164
    v_lshrrev_b32 v3, 5, v0
    v_add_u32 v3, 24, v3
    v_and_b32 v4, 31, v0
    v_lshlrev_b32 v5, 7, v4
    v_lshl_add_u32 v5, v3, 1, v5
    v_cmp_gt_u32 vcc, 36, v3
    v_cmp_gt_u32 s[24:25], 18, v4
    s_and_b64 s[24:25], s[24:25], vcc
    s_and_saveexec_b64 s[26:27], s[24:25]
    ds_write_b16 v5, v164 offset:14336
    s_mov_b64 exec, s[26:27]
    v_cmp_eq_u32 s[24:25], 18, v4
    s_and_b64 s[24:25], s[24:25], vcc
    s_and_saveexec_b64 s[26:27], s[24:25]
    ds_write_b16 v5, v164 offset:14336
    ds_write_b16 v5, v164 offset:14848
    ds_write_b16 v5, v164 offset:15360
    ds_write_b16 v5, v164 offset:15872
    s_mov_b64 exec, s[26:27]
    v_add_f32 v172, v172, v173
    v_add_f32 v172, v172, v174
    v_add_f32 v172, v172, v175
    v_add_f32 v172, v172, v176
    v_add_f32 v172, v172, v177
    v_add_f32 v172, v172, v178
    v_add_f32 v172, v172, v179
    v_cvt_pk_bf16_f32 v172, v172, v172
    v_lshrrev_b32 v3, 5, v0
    v_add_u32 v3, 32, v3
    v_and_b32 v4, 31, v0
    v_lshlrev_b32 v5, 7, v4
    v_lshl_add_u32 v5, v3, 1, v5
    v_cmp_gt_u32 vcc, 36, v3
    v_cmp_gt_u32 s[24:25], 18, v4
    s_and_b64 s[24:25], s[24:25], vcc
    s_and_saveexec_b64 s[26:27], s[24:25]
    ds_write_b16 v5, v172 offset:14336
    s_mov_b64 exec, s[26:27]
    v_cmp_eq_u32 s[24:25], 18, v4
    s_and_b64 s[24:25], s[24:25], vcc
    s_and_saveexec_b64 s[26:27], s[24:25]
    ds_write_b16 v5, v172 offset:14336
    ds_write_b16 v5, v172 offset:14848
    ds_write_b16 v5, v172 offset:15360
    ds_write_b16 v5, v172 offset:15872
    s_mov_b64 exec, s[26:27]
    v_add_f32 v180, v180, v181
    v_add_f32 v180, v180, v182
    v_add_f32 v180, v180, v183
    v_add_f32 v180, v180, v184
    v_add_f32 v180, v180, v185
    v_add_f32 v180, v180, v186
    v_add_f32 v180, v180, v187
    v_cvt_pk_bf16_f32 v180, v180, v180
    v_lshrrev_b32 v3, 5, v0
    v_add_u32 v3, 40, v3
    v_and_b32 v4, 31, v0
    v_lshlrev_b32 v5, 7, v4
    v_lshl_add_u32 v5, v3, 1, v5
    v_cmp_gt_u32 vcc, 36, v3
    v_cmp_gt_u32 s[24:25], 18, v4
    s_and_b64 s[24:25], s[24:25], vcc
    s_and_saveexec_b64 s[26:27], s[24:25]
    ds_write_b16 v5, v180 offset:14336
    s_mov_b64 exec, s[26:27]
    v_cmp_eq_u32 s[24:25], 18, v4
    s_and_b64 s[24:25], s[24:25], vcc
    s_and_saveexec_b64 s[26:27], s[24:25]
    ds_write_b16 v5, v180 offset:14336
    ds_write_b16 v5, v180 offset:14848
    ds_write_b16 v5, v180 offset:15360
    ds_write_b16 v5, v180 offset:15872
    s_mov_b64 exec, s[26:27]
    v_and_b32 v1, 63, v0
    v_and_b32 v8, 15, v1
    v_lshrrev_b32 v9, 4, v1
    v_lshlrev_b32 v10, 6, v8
    v_lshl_add_u32 v10, v9, 4, v10
    ds_read_b128 v[12:15], v10 offset:0
    ds_read_b128 v[16:19], v10 offset:1024
    v_sub_u32 v11, v8, v1
    s_movk_i32 s23, 3456
    v_mul_lo_u32 v11, v11, s23
    v_add_u32 v11, v11, v7
    v_lshl_add_u32 v11, v9, 4, v11
    s_mov_b32 s23, 0
    buffer_load_dwordx4 v[100:103], v11, s[8:11], s23 offen offset:0
    s_mov_b32 s23, 55296
    buffer_load_dwordx4 v[104:107], v11, s[8:11], s23 offen offset:0
    s_mov_b32 s23, 110592
    buffer_load_dwordx4 v[108:111], v11, s[8:11], s23 offen offset:0
    s_mov_b32 s23, 165888
    buffer_load_dwordx4 v[112:115], v11, s[8:11], s23 offen offset:0
    v_and_b32 v10, 0xc0, v0
    v_add_u32 v10, v10, v8
    v_mul_u32_u24 v10, 48, v10
    v_lshl_add_u32 v10, v9, 3, v10
    v_cmp_eq_u32 vcc, 0, v9
    v_mov_b32 v40, 0
    v_mov_b32 v41, 0
    v_mov_b32 v42, 0
    v_mov_b32 v43, 0
    v_mov_b32 v44, 0
    v_mov_b32 v45, 0
    v_mov_b32 v46, 0
    v_mov_b32 v47, 0
    s_waitcnt vmcnt(3) lgkmcnt(0)
    v_mfma_f32_16x16x32_bf16 v[40:43], v[12:15], v[100:103], v[40:43]
    v_mfma_f32_16x16x32_bf16 v[44:47], v[16:19], v[100:103], v[44:47]
    s_nop 7
    s_nop 1
    v_cvt_pk_bf16_f32 v48, v40, v41
    v_cvt_pk_bf16_f32 v49, v42, v43
    v_cvt_pk_bf16_f32 v50, v44, v45
    ds_write_b64 v10, v[48:49] offset:2048
    s_and_saveexec_b64 s[24:25], vcc
    ds_write_b32 v10, v50 offset:2080
    s_mov_b64 exec, s[24:25]
    v_mov_b32 v40, 0
    v_mov_b32 v41, 0
    v_mov_b32 v42, 0
    v_mov_b32 v43, 0
    v_mov_b32 v44, 0
    v_mov_b32 v45, 0
    v_mov_b32 v46, 0
    v_mov_b32 v47, 0
    s_waitcnt vmcnt(2) lgkmcnt(0)
    v_mfma_f32_16x16x32_bf16 v[40:43], v[12:15], v[104:107], v[40:43]
    v_mfma_f32_16x16x32_bf16 v[44:47], v[16:19], v[104:107], v[44:47]
    s_nop 7
    s_nop 1
    v_cvt_pk_bf16_f32 v48, v40, v41
    v_cvt_pk_bf16_f32 v49, v42, v43
    v_cvt_pk_bf16_f32 v50, v44, v45
    ds_write_b64 v10, v[48:49] offset:2816
    s_and_saveexec_b64 s[24:25], vcc
    ds_write_b32 v10, v50 offset:2848
    s_mov_b64 exec, s[24:25]
    v_mov_b32 v40, 0
    v_mov_b32 v41, 0
    v_mov_b32 v42, 0
    v_mov_b32 v43, 0
    v_mov_b32 v44, 0
    v_mov_b32 v45, 0
    v_mov_b32 v46, 0
    v_mov_b32 v47, 0
    s_waitcnt vmcnt(1) lgkmcnt(0)
    v_mfma_f32_16x16x32_bf16 v[40:43], v[12:15], v[108:111], v[40:43]
    v_mfma_f32_16x16x32_bf16 v[44:47], v[16:19], v[108:111], v[44:47]
    s_nop 7
    s_nop 1
    v_cvt_pk_bf16_f32 v48, v40, v41
    v_cvt_pk_bf16_f32 v49, v42, v43
    v_cvt_pk_bf16_f32 v50, v44, v45
    ds_write_b64 v10, v[48:49] offset:3584
    s_and_saveexec_b64 s[24:25], vcc
    ds_write_b32 v10, v50 offset:3616
    s_mov_b64 exec, s[24:25]
    v_mov_b32 v40, 0
    v_mov_b32 v41, 0
    v_mov_b32 v42, 0
    v_mov_b32 v43, 0
    v_mov_b32 v44, 0
    v_mov_b32 v45, 0
    v_mov_b32 v46, 0
    v_mov_b32 v47, 0
    s_waitcnt vmcnt(0) lgkmcnt(0)
    v_mfma_f32_16x16x32_bf16 v[40:43], v[12:15], v[112:115], v[40:43]
    v_mfma_f32_16x16x32_bf16 v[44:47], v[16:19], v[112:115], v[44:47]
    s_nop 7
    s_nop 1
    v_cvt_pk_bf16_f32 v48, v40, v41
    v_cvt_pk_bf16_f32 v49, v42, v43
    v_cvt_pk_bf16_f32 v50, v44, v45
    ds_write_b64 v10, v[48:49] offset:4352
    s_and_saveexec_b64 s[24:25], vcc
    ds_write_b32 v10, v50 offset:4384
    s_mov_b64 exec, s[24:25]
    v_mul_u32_u24 v10, 48, v0
    s_waitcnt lgkmcnt(0)
    ds_read_b128 v[20:23], v10 offset:2048
    ds_read_b128 v[24:27], v10 offset:2064
    ds_read_b32 v28, v10 offset:2080
    s_waitcnt lgkmcnt(0)
    v_lshlrev_b32 v60, 16, v20
    v_and_b32 v61, 0xffff0000, v20
    v_lshlrev_b32 v62, 16, v21
    v_and_b32 v63, 0xffff0000, v21
    v_lshlrev_b32 v64, 16, v22
    v_and_b32 v65, 0xffff0000, v22
    v_lshlrev_b32 v66, 16, v23
    v_and_b32 v67, 0xffff0000, v23
    v_lshlrev_b32 v68, 16, v24
    v_and_b32 v69, 0xffff0000, v24
    v_lshlrev_b32 v70, 16, v25
    v_and_b32 v71, 0xffff0000, v25
    v_lshlrev_b32 v72, 16, v26
    v_and_b32 v73, 0xffff0000, v26
    v_lshlrev_b32 v74, 16, v27
    v_and_b32 v75, 0xffff0000, v27
    v_lshlrev_b32 v76, 16, v28
    v_and_b32 v77, 0xffff0000, v28
    v_max3_f32 v40, v60, v61, v62
    v_min3_f32 v41, v60, v61, v62
    v_max3_f32 v40, v40, v63, v64
    v_min3_f32 v41, v41, v63, v64
    v_max3_f32 v40, v40, v65, v66
    v_min3_f32 v41, v41, v65, v66
    v_max3_f32 v40, v40, v67, v68
    v_min3_f32 v41, v41, v67, v68
    v_max3_f32 v40, v40, v69, v70
    v_min3_f32 v41, v41, v69, v70
    v_max3_f32 v40, v40, v71, v72
    v_min3_f32 v41, v41, v71, v72
    v_max3_f32 v40, v40, v73, v74
    v_min3_f32 v41, v41, v73, v74
    v_max3_f32 v40, v40, v75, v76
    v_min3_f32 v41, v41, v75, v76
    v_max_f32 v40, v40, v77
    v_min_f32 v41, v41, v77
    s_mov_b32 s26, 0x3fb8aa3b
    v_mul_f32 v40, s26, v40
    v_mul_f32 v41, s26, v41
    v_fma_f32 v80, v60, s26, -v40
    v_fma_f32 v98, -v60, s26, v41
    v_fma_f32 v81, v61, s26, -v40
    v_fma_f32 v99, -v61, s26, v41
    v_fma_f32 v82, v62, s26, -v40
    v_fma_f32 v100, -v62, s26, v41
    v_fma_f32 v83, v63, s26, -v40
    v_fma_f32 v101, -v63, s26, v41
    v_fma_f32 v84, v64, s26, -v40
    v_fma_f32 v102, -v64, s26, v41
    v_fma_f32 v85, v65, s26, -v40
    v_fma_f32 v103, -v65, s26, v41
    v_fma_f32 v86, v66, s26, -v40
    v_fma_f32 v104, -v66, s26, v41
    v_fma_f32 v87, v67, s26, -v40
    v_fma_f32 v105, -v67, s26, v41
    v_fma_f32 v88, v68, s26, -v40
    v_fma_f32 v106, -v68, s26, v41
    v_fma_f32 v89, v69, s26, -v40
    v_fma_f32 v107, -v69, s26, v41
    v_fma_f32 v90, v70, s26, -v40
    v_fma_f32 v108, -v70, s26, v41
    v_fma_f32 v91, v71, s26, -v40
    v_fma_f32 v109, -v71, s26, v41
    v_fma_f32 v92, v72, s26, -v40
    v_fma_f32 v110, -v72, s26, v41
    v_fma_f32 v93, v73, s26, -v40
    v_fma_f32 v111, -v73, s26, v41
    v_fma_f32 v94, v74, s26, -v40
    v_fma_f32 v112, -v74, s26, v41
    v_fma_f32 v95, v75, s26, -v40
    v_fma_f32 v113, -v75, s26, v41
    v_fma_f32 v96, v76, s26, -v40
    v_fma_f32 v114, -v76, s26, v41
    v_fma_f32 v97, v77, s26, -v40
    v_fma_f32 v115, -v77, s26, v41
    v_exp_f32 v80, v80
    v_exp_f32 v81, v81
    v_exp_f32 v82, v82
    v_exp_f32 v83, v83
    v_exp_f32 v84, v84
    v_exp_f32 v85, v85
    v_exp_f32 v86, v86
    v_exp_f32 v87, v87
    v_exp_f32 v88, v88
    v_exp_f32 v89, v89
    v_exp_f32 v90, v90
    v_exp_f32 v91, v91
    v_exp_f32 v92, v92
    v_exp_f32 v93, v93
    v_exp_f32 v94, v94
    v_exp_f32 v95, v95
    v_exp_f32 v96, v96
    v_exp_f32 v97, v97
    v_exp_f32 v98, v98
    v_exp_f32 v99, v99
    v_exp_f32 v100, v100
    v_exp_f32 v101, v101
    v_exp_f32 v102, v102
    v_exp_f32 v103, v103
    v_exp_f32 v104, v104
    v_exp_f32 v105, v105
    v_exp_f32 v106, v106
    v_exp_f32 v107, v107
    v_exp_f32 v108, v108
    v_exp_f32 v109, v109
    v_exp_f32 v110, v110
    v_exp_f32 v111, v111
    v_exp_f32 v112, v112
    v_exp_f32 v113, v113
    v_exp_f32 v114, v114
    v_exp_f32 v115, v115
    v_add_f32 v42, v80, v81
    v_add_f32 v42, v42, v82
    v_add_f32 v42, v42, v83
    v_add_f32 v42, v42, v84
    v_add_f32 v42, v42, v85
    v_add_f32 v42, v42, v86
    v_add_f32 v42, v42, v87
    v_add_f32 v42, v42, v88
    v_add_f32 v42, v42, v89
    v_add_f32 v42, v42, v90
    v_add_f32 v42, v42, v91
    v_add_f32 v42, v42, v92
    v_add_f32 v42, v42, v93
    v_add_f32 v42, v42, v94
    v_add_f32 v42, v42, v95
    v_add_f32 v42, v42, v96
    v_add_f32 v42, v42, v97
    v_add_f32 v43, v98, v99
    v_add_f32 v43, v43, v100
    v_add_f32 v43, v43, v101
    v_add_f32 v43, v43, v102
    v_add_f32 v43, v43, v103
    v_add_f32 v43, v43, v104
    v_add_f32 v43, v43, v105
    v_add_f32 v43, v43, v106
    v_add_f32 v43, v43, v107
    v_add_f32 v43, v43, v108
    v_add_f32 v43, v43, v109
    v_add_f32 v43, v43, v110
    v_add_f32 v43, v43, v111
    v_add_f32 v43, v43, v112
    v_add_f32 v43, v43, v113
    v_add_f32 v43, v43, v114
    v_add_f32 v43, v43, v115
    v_rcp_f32 v42, v42
    v_rcp_f32 v43, v43
    s_nop 0
    v_mul_f32 v80, v80, v42
    v_mul_f32 v81, v81, v42
    v_mul_f32 v82, v82, v42
    v_mul_f32 v83, v83, v42
    v_mul_f32 v84, v84, v42
    v_mul_f32 v85, v85, v42
    v_mul_f32 v86, v86, v42
    v_mul_f32 v87, v87, v42
    v_mul_f32 v88, v88, v42
    v_mul_f32 v89, v89, v42
    v_mul_f32 v90, v90, v42
    v_mul_f32 v91, v91, v42
    v_mul_f32 v92, v92, v42
    v_mul_f32 v93, v93, v42
    v_mul_f32 v94, v94, v42
    v_mul_f32 v95, v95, v42
    v_mul_f32 v96, v96, v42
    v_mul_f32 v97, v97, v42
    v_mul_f32 v98, v98, v43
    v_mul_f32 v99, v99, v43
    v_mul_f32 v100, v100, v43
    v_mul_f32 v101, v101, v43
    v_mul_f32 v102, v102, v43
    v_mul_f32 v103, v103, v43
    v_mul_f32 v104, v104, v43
    v_mul_f32 v105, v105, v43
    v_mul_f32 v106, v106, v43
    v_mul_f32 v107, v107, v43
    v_mul_f32 v108, v108, v43
    v_mul_f32 v109, v109, v43
    v_mul_f32 v110, v110, v43
    v_mul_f32 v111, v111, v43
    v_mul_f32 v112, v112, v43
    v_mul_f32 v113, v113, v43
    v_mul_f32 v114, v114, v43
    v_mul_f32 v115, v115, v43
    v_cvt_pk_bf16_f32 v120, v80, v81
    v_cvt_pk_bf16_f32 v121, v82, v83
    v_cvt_pk_bf16_f32 v122, v84, v85
    v_cvt_pk_bf16_f32 v123, v86, v87
    v_cvt_pk_bf16_f32 v124, v88, v89
    v_cvt_pk_bf16_f32 v125, v90, v91
    v_cvt_pk_bf16_f32 v126, v92, v93
    v_cvt_pk_bf16_f32 v127, v94, v95
    v_cvt_pk_bf16_f32 v128, v96, v97
    v_cvt_pk_bf16_f32 v129, v98, v99
    v_cvt_pk_bf16_f32 v130, v100, v101
    v_cvt_pk_bf16_f32 v131, v102, v103
    v_cvt_pk_bf16_f32 v132, v104, v105
    v_cvt_pk_bf16_f32 v133, v106, v107
    v_cvt_pk_bf16_f32 v134, v108, v109
    v_cvt_pk_bf16_f32 v135, v110, v111
    v_cvt_pk_bf16_f32 v136, v112, v113
    v_cvt_pk_bf16_f32 v137, v114, v115
    v_lshlrev_b32 v2, 7, v0
    v_mov_b32 v138, 0
    v_mov_b32 v139, 0
    ds_write_b128 v2, v[120:123] offset:18432
    ds_write_b128 v2, v[124:127] offset:18448
    ds_write_b128 v2, v[128:131] offset:18464
    ds_write_b128 v2, v[132:135] offset:18480
    ds_write_b128 v2, v[136:139] offset:18496
    v_mov_b32 v8, 0
    v_mov_b32 v9, 0
    v_mov_b32 v10, 0
    v_mov_b32 v11, 0
    ds_write_b128 v2, v[8:11] offset:18512
    ds_write_b128 v2, v[8:11] offset:18528
    ds_write_b128 v2, v[8:11] offset:18544
    s_waitcnt lgkmcnt(0)
    s_barrier
    v_and_b32 v1, 63, v0
    v_and_b32 v2, 15, v1
    v_lshrrev_b32 v3, 4, v1
    v_lshlrev_b32 v4, 7, v2
    v_lshl_add_u32 v4, v3, 4, v4
    ds_read_b128 v[16:19], v4 offset:14336
    ds_read_b128 v[20:23], v4 offset:14400
    ds_read_b128 v[24:27], v4 offset:16384
    ds_read_b128 v[28:31], v4 offset:16448
    v_and_b32 v5, 0xc0, v0
    v_lshl_add_u32 v5, v5, 7, v4
    s_mov_b32 s36, s6
    s_mov_b32 s37, s7
    s_mov_b32 s38, 21233664
    s_mov_b32 s39, 0x00020000
    s_add_u32 s36, s36, 4194304
    s_addc_u32 s37, s37, 0
    s_lshl_b32 s23, s21, 8
    v_and_b32 v6, 0xc0, v0
    v_add_u32 v6, v6, v2
    v_add_u32 v6, s23, v6
    s_mov_b32 s23, 10368
    v_mul_lo_u32 v6, v6, s23
    s_mul_i32 s23, s20, 36
    v_add_u32 v6, s23, v6
    v_lshl_add_u32 v6, v3, 3, v6
    v_cmp_eq_u32 vcc, 0, v3
    ds_read_b128 v[32:35], v5 offset:18432
    ds_read_b128 v[36:39], v5 offset:18496
    v_mov_b32 v40, 0
    v_mov_b32 v41, 0
    v_mov_b32 v42, 0
    v_mov_b32 v43, 0
    v_mov_b32 v44, 0
    v_mov_b32 v45, 0
    v_mov_b32 v46, 0
    v_mov_b32 v47, 0
    s_waitcnt lgkmcnt(0)
    v_mfma_f32_16x16x32_bf16 v[40:43], v[16:19], v[32:35], v[40:43]
    v_mfma_f32_16x16x32_bf16 v[44:47], v[24:27], v[32:35], v[44:47]
    v_mfma_f32_16x16x32_bf16 v[40:43], v[20:23], v[36:39], v[40:43]
    v_mfma_f32_16x16x32_bf16 v[44:47], v[28:31], v[36:39], v[44:47]
    s_nop 7
    s_nop 1
    v_cvt_pk_bf16_f32 v48, v46, v46
    v_lshlrev_b32 v48, 16, v48
    v_add_f32 v48, 0x358637bd, v48
    v_cvt_pk_bf16_f32 v48, v48, v48
    v_lshlrev_b32 v48, 16, v48
    v_rcp_f32 v49, v48
    v_cvt_pk_bf16_f32 v50, v40, v41
    v_cvt_pk_bf16_f32 v51, v42, v43
    v_cvt_pk_bf16_f32 v52, v44, v45
    v_lshlrev_b32 v40, 16, v50
    v_and_b32 v41, 0xffff0000, v50
    v_lshlrev_b32 v42, 16, v51
    v_and_b32 v43, 0xffff0000, v51
    v_lshlrev_b32 v44, 16, v52
    v_and_b32 v45, 0xffff0000, v52
    v_mul_f32 v53, v40, v49
    v_fma_f32 v54, -v53, v48, v40
    v_fma_f32 v40, v54, v49, v53
    v_mul_f32 v53, v41, v49
    v_fma_f32 v54, -v53, v48, v41
    v_fma_f32 v41, v54, v49, v53
    v_mul_f32 v53, v42, v49
    v_fma_f32 v54, -v53, v48, v42
    v_fma_f32 v42, v54, v49, v53
    v_mul_f32 v53, v43, v49
    v_fma_f32 v54, -v53, v48, v43
    v_fma_f32 v43, v54, v49, v53
    v_mul_f32 v53, v44, v49
    v_fma_f32 v54, -v53, v48, v44
    v_fma_f32 v44, v54, v49, v53
    v_mul_f32 v53, v45, v49
    v_fma_f32 v54, -v53, v48, v45
    v_fma_f32 v45, v54, v49, v53
    v_cvt_pk_bf16_f32 v50, v40, v41
    v_cvt_pk_bf16_f32 v51, v42, v43
    v_cvt_pk_bf16_f32 v52, v44, v45
    s_mov_b32 s23, 0
    buffer_store_dwordx2 v[50:51], v6, s[36:39], s23 offen
    s_and_saveexec_b64 s[26:27], vcc
    buffer_store_dword v52, v6, s[36:39], s23 offen offset:32
    s_mov_b64 exec, s[26:27]
    ds_read_b128 v[32:35], v5 offset:20480
    ds_read_b128 v[36:39], v5 offset:20544
    v_mov_b32 v40, 0
    v_mov_b32 v41, 0
    v_mov_b32 v42, 0
    v_mov_b32 v43, 0
    v_mov_b32 v44, 0
    v_mov_b32 v45, 0
    v_mov_b32 v46, 0
    v_mov_b32 v47, 0
    s_waitcnt lgkmcnt(0)
    v_mfma_f32_16x16x32_bf16 v[40:43], v[16:19], v[32:35], v[40:43]
    v_mfma_f32_16x16x32_bf16 v[44:47], v[24:27], v[32:35], v[44:47]
    v_mfma_f32_16x16x32_bf16 v[40:43], v[20:23], v[36:39], v[40:43]
    v_mfma_f32_16x16x32_bf16 v[44:47], v[28:31], v[36:39], v[44:47]
    s_nop 7
    s_nop 1
    v_cvt_pk_bf16_f32 v48, v46, v46
    v_lshlrev_b32 v48, 16, v48
    v_add_f32 v48, 0x358637bd, v48
    v_cvt_pk_bf16_f32 v48, v48, v48
    v_lshlrev_b32 v48, 16, v48
    v_rcp_f32 v49, v48
    v_cvt_pk_bf16_f32 v50, v40, v41
    v_cvt_pk_bf16_f32 v51, v42, v43
    v_cvt_pk_bf16_f32 v52, v44, v45
    v_lshlrev_b32 v40, 16, v50
    v_and_b32 v41, 0xffff0000, v50
    v_lshlrev_b32 v42, 16, v51
    v_and_b32 v43, 0xffff0000, v51
    v_lshlrev_b32 v44, 16, v52
    v_and_b32 v45, 0xffff0000, v52
    v_mul_f32 v53, v40, v49
    v_fma_f32 v54, -v53, v48, v40
    v_fma_f32 v40, v54, v49, v53
    v_mul_f32 v53, v41, v49
    v_fma_f32 v54, -v53, v48, v41
    v_fma_f32 v41, v54, v49, v53
    v_mul_f32 v53, v42, v49
    v_fma_f32 v54, -v53, v48, v42
    v_fma_f32 v42, v54, v49, v53
    v_mul_f32 v53, v43, v49
    v_fma_f32 v54, -v53, v48, v43
    v_fma_f32 v43, v54, v49, v53
    v_mul_f32 v53, v44, v49
    v_fma_f32 v54, -v53, v48, v44
    v_fma_f32 v44, v54, v49, v53
    v_mul_f32 v53, v45, v49
    v_fma_f32 v54, -v53, v48, v45
    v_fma_f32 v45, v54, v49, v53
    v_cvt_pk_bf16_f32 v50, v40, v41
    v_cvt_pk_bf16_f32 v51, v42, v43
    v_cvt_pk_bf16_f32 v52, v44, v45
    s_mov_b32 s23, 165888
    buffer_store_dwordx2 v[50:51], v6, s[36:39], s23 offen
    s_and_saveexec_b64 s[26:27], vcc
    buffer_store_dword v52, v6, s[36:39], s23 offen offset:32
    s_mov_b64 exec, s[26:27]
    ds_read_b128 v[32:35], v5 offset:22528
    ds_read_b128 v[36:39], v5 offset:22592
    v_mov_b32 v40, 0
    v_mov_b32 v41, 0
    v_mov_b32 v42, 0
    v_mov_b32 v43, 0
    v_mov_b32 v44, 0
    v_mov_b32 v45, 0
    v_mov_b32 v46, 0
    v_mov_b32 v47, 0
    s_waitcnt lgkmcnt(0)
    v_mfma_f32_16x16x32_bf16 v[40:43], v[16:19], v[32:35], v[40:43]
    v_mfma_f32_16x16x32_bf16 v[44:47], v[24:27], v[32:35], v[44:47]
    v_mfma_f32_16x16x32_bf16 v[40:43], v[20:23], v[36:39], v[40:43]
    v_mfma_f32_16x16x32_bf16 v[44:47], v[28:31], v[36:39], v[44:47]
    s_nop 7
    s_nop 1
    v_cvt_pk_bf16_f32 v48, v46, v46
    v_lshlrev_b32 v48, 16, v48
    v_add_f32 v48, 0x358637bd, v48
    v_cvt_pk_bf16_f32 v48, v48, v48
    v_lshlrev_b32 v48, 16, v48
    v_rcp_f32 v49, v48
    v_cvt_pk_bf16_f32 v50, v40, v41
    v_cvt_pk_bf16_f32 v51, v42, v43
    v_cvt_pk_bf16_f32 v52, v44, v45
    v_lshlrev_b32 v40, 16, v50
    v_and_b32 v41, 0xffff0000, v50
    v_lshlrev_b32 v42, 16, v51
    v_and_b32 v43, 0xffff0000, v51
    v_lshlrev_b32 v44, 16, v52
    v_and_b32 v45, 0xffff0000, v52
    v_mul_f32 v53, v40, v49
    v_fma_f32 v54, -v53, v48, v40
    v_fma_f32 v40, v54, v49, v53
    v_mul_f32 v53, v41, v49
    v_fma_f32 v54, -v53, v48, v41
    v_fma_f32 v41, v54, v49, v53
    v_mul_f32 v53, v42, v49
    v_fma_f32 v54, -v53, v48, v42
    v_fma_f32 v42, v54, v49, v53
    v_mul_f32 v53, v43, v49
    v_fma_f32 v54, -v53, v48, v43
    v_fma_f32 v43, v54, v49, v53
    v_mul_f32 v53, v44, v49
    v_fma_f32 v54, -v53, v48, v44
    v_fma_f32 v44, v54, v49, v53
    v_mul_f32 v53, v45, v49
    v_fma_f32 v54, -v53, v48, v45
    v_fma_f32 v45, v54, v49, v53
    v_cvt_pk_bf16_f32 v50, v40, v41
    v_cvt_pk_bf16_f32 v51, v42, v43
    v_cvt_pk_bf16_f32 v52, v44, v45
    s_mov_b32 s23, 331776
    buffer_store_dwordx2 v[50:51], v6, s[36:39], s23 offen
    s_and_saveexec_b64 s[26:27], vcc
    buffer_store_dword v52, v6, s[36:39], s23 offen offset:32
    s_mov_b64 exec, s[26:27]
    ds_read_b128 v[32:35], v5 offset:24576
    ds_read_b128 v[36:39], v5 offset:24640
    v_mov_b32 v40, 0
    v_mov_b32 v41, 0
    v_mov_b32 v42, 0
    v_mov_b32 v43, 0
    v_mov_b32 v44, 0
    v_mov_b32 v45, 0
    v_mov_b32 v46, 0
    v_mov_b32 v47, 0
    s_waitcnt lgkmcnt(0)
    v_mfma_f32_16x16x32_bf16 v[40:43], v[16:19], v[32:35], v[40:43]
    v_mfma_f32_16x16x32_bf16 v[44:47], v[24:27], v[32:35], v[44:47]
    v_mfma_f32_16x16x32_bf16 v[40:43], v[20:23], v[36:39], v[40:43]
    v_mfma_f32_16x16x32_bf16 v[44:47], v[28:31], v[36:39], v[44:47]
    s_nop 7
    s_nop 1
    v_cvt_pk_bf16_f32 v48, v46, v46
    v_lshlrev_b32 v48, 16, v48
    v_add_f32 v48, 0x358637bd, v48
    v_cvt_pk_bf16_f32 v48, v48, v48
    v_lshlrev_b32 v48, 16, v48
    v_rcp_f32 v49, v48
    v_cvt_pk_bf16_f32 v50, v40, v41
    v_cvt_pk_bf16_f32 v51, v42, v43
    v_cvt_pk_bf16_f32 v52, v44, v45
    v_lshlrev_b32 v40, 16, v50
    v_and_b32 v41, 0xffff0000, v50
    v_lshlrev_b32 v42, 16, v51
    v_and_b32 v43, 0xffff0000, v51
    v_lshlrev_b32 v44, 16, v52
    v_and_b32 v45, 0xffff0000, v52
    v_mul_f32 v53, v40, v49
    v_fma_f32 v54, -v53, v48, v40
    v_fma_f32 v40, v54, v49, v53
    v_mul_f32 v53, v41, v49
    v_fma_f32 v54, -v53, v48, v41
    v_fma_f32 v41, v54, v49, v53
    v_mul_f32 v53, v42, v49
    v_fma_f32 v54, -v53, v48, v42
    v_fma_f32 v42, v54, v49, v53
    v_mul_f32 v53, v43, v49
    v_fma_f32 v54, -v53, v48, v43
    v_fma_f32 v43, v54, v49, v53
    v_mul_f32 v53, v44, v49
    v_fma_f32 v54, -v53, v48, v44
    v_fma_f32 v44, v54, v49, v53
    v_mul_f32 v53, v45, v49
    v_fma_f32 v54, -v53, v48, v45
    v_fma_f32 v45, v54, v49, v53
    v_cvt_pk_bf16_f32 v50, v40, v41
    v_cvt_pk_bf16_f32 v51, v42, v43
    v_cvt_pk_bf16_f32 v52, v44, v45
    s_mov_b32 s23, 497664
    buffer_store_dwordx2 v[50:51], v6, s[36:39], s23 offen
    s_and_saveexec_b64 s[26:27], vcc
    buffer_store_dword v52, v6, s[36:39], s23 offen offset:32
    s_mov_b64 exec, s[26:27]
L_o_end:
    s_endpgm
.globl gemm2_kernel
.p2align 8
.type gemm2_kernel,@function
gemm2_kernel:
    s_load_dwordx2 s[34:35], s[0:1], 24
    s_load_dwordx2 s[36:37], s[0:1], 48
    s_load_dwordx2 s[38:39], s[0:1], 72
    s_cmp_ge_u32 s2, 240
    s_cbranch_scc1 L_g2_end
    s_and_b32 s40, s2, 7
    s_lshr_b32 s41, s2, 3
    s_mul_i32 s42, s41, 43
    s_lshr_b32 s42, s42, 7
    s_mul_i32 s43, s42, 3
    s_sub_u32 s43, s41, s43
    s_mul_i32 s40, s40, 10
    s_add_u32 s40, s40, s42
    s_lshr_b32 s42, s40, 4
    s_and_b32 s40, s40, 15
    s_waitcnt lgkmcnt(0)
    s_mov_b32 s4, s38
    s_mov_b32 s5, s39
    s_mov_b32 s6, 21233664
    s_mov_b32 s7, 0x00020000
    s_add_u32 s4, s4, 4194304
    s_addc_u32 s5, s5, 0
    s_mov_b32 s11, 0x00020000
    s_mov_b32 s44, 663552
    s_mov_b32 s45, 5308416
    s_movk_i32 s46, 1152
    v_and_b32 v1, 63, v0
    v_lshrrev_b32 v10, 6, v0
    s_nop 0
    v_readfirstlane_b32 s30, v10
    v_lshrrev_b32 v10, 3, v1
    v_and_b32 v11, 7, v1
    v_xor_b32 v11, v11, v10
    v_lshlrev_b32 v11, 4, v11
    s_mov_b32 s31, 10368
    v_mul_lo_u32 v2, v10, s31
    v_add_u32 v2, v2, v11
    v_lshrrev_b32 v11, 4, v1
    v_and_b32 v11, 1, v11
    s_and_b32 s31, s30, 1
    s_lshl_b32 s31, s31, 1
    v_or_b32 v11, s31, v11
    v_bfe_u32 v12, v1, 1, 2
    v_xor_b32 v12, v12, v11
    v_lshlrev_b32 v12, 5, v12
    v_and_b32 v13, 1, v1
    v_lshl_add_u32 v12, v13, 4, v12
    v_mul_lo_u32 v3, v10, s46
    v_add_u32 v3, v3, v12
    v_and_b32 v10, 15, v1
    v_lshrrev_b32 v11, 4, v1
    v_and_b32 v12, 7, v10
    v_xor_b32 v12, v12, v11
    s_lshr_b32 s31, s30, 2
    s_lshl_b32 s31, s31, 13
    v_lshlrev_b32 v13, 7, v10
    v_add_u32 v13, s31, v13
    v_lshl_add_u32 v4, v12, 4, v13
    v_xor_b32 v12, 4, v12
    v_lshl_add_u32 v5, v12, 4, v13
    v_bfe_u32 v10, v1, 2, 2
    v_lshrrev_b32 v12, 1, v10
    v_and_b32 v13, 1, v11
    v_lshl_or_b32 v12, v13, 1, v12
    s_and_b32 s31, s30, 3
    v_xor_b32 v12, s31, v12
    v_lshlrev_b32 v12, 5, v12
    v_lshl_add_u32 v13, v11, 3, v10
    v_lshl_add_u32 v12, v13, 7, v12
    v_and_b32 v13, 3, v1
    v_lshl_add_u32 v12, v13, 3, v12
    v_add_u32 v6, 49152, v12
    v_add_u32 v7, 61440, v12
    v_add_u32 v8, 73728, v12
    v_add_u32 v9, 86016, v12
    s_lshl_b32 s28, s30, 10
    s_and_b32 s31, s30, 3
    s_mul_i32 s32, s31, s46
    s_lshl_b32 s32, s32, 3
    s_add_u32 s33, s30, 0
    s_lshr_b32 s33, s33, 2
    s_min_u32 s33, s33, 2
    s_lshl_b32 s20, s33, 7
    s_add_u32 s20, s20, s32
    s_lshl_b32 s24, s33, 12
    s_lshl_b32 s33, s31, 10
    s_add_u32 s24, s24, s33
    s_add_u32 s33, s30, 8
    s_lshr_b32 s33, s33, 2
    s_min_u32 s33, s33, 2
    s_lshl_b32 s21, s33, 7
    s_add_u32 s21, s21, s32
    s_lshl_b32 s25, s33, 12
    s_lshl_b32 s33, s31, 10
    s_add_u32 s25, s25, s33
    s_lshl_b32 s31, s40, 7
    s_lshl_b32 s32, s30, 3
    s_add_u32 s31, s31, s32
    s_mul_i32 s16, s31, 10368
    s_mul_i32 s31, s42, 2176
    s_add_u32 s16, s16, s31
    s_mov_b32 s29, 663552
    s_mov_b32 s18, 0
    s_mul_i32 s47, s42, 34
    s_mul_i32 s48, s43, 384
    v_accvgpr_write_b32 a0, 0
    v_accvgpr_write_b32 a1, 0
    v_accvgpr_write_b32 a2, 0
    v_accvgpr_write_b32 a3, 0
    v_accvgpr_write_b32 a4, 0
    v_accvgpr_write_b32 a5, 0
    v_accvgpr_write_b32 a6, 0
    v_accvgpr_write_b32 a7, 0
    v_accvgpr_write_b32 a8, 0
    v_accvgpr_write_b32 a9, 0
    v_accvgpr_write_b32 a10, 0
    v_accvgpr_write_b32 a11, 0
    v_accvgpr_write_b32 a12, 0
    v_accvgpr_write_b32 a13, 0
    v_accvgpr_write_b32 a14, 0
    v_accvgpr_write_b32 a15, 0
    v_accvgpr_write_b32 a16, 0
    v_accvgpr_write_b32 a17, 0
    v_accvgpr_write_b32 a18, 0
    v_accvgpr_write_b32 a19, 0
    v_accvgpr_write_b32 a20, 0
    v_accvgpr_write_b32 a21, 0
    v_accvgpr_write_b32 a22, 0
    v_accvgpr_write_b32 a23, 0
    v_accvgpr_write_b32 a24, 0
    v_accvgpr_write_b32 a25, 0
    v_accvgpr_write_b32 a26, 0
    v_accvgpr_write_b32 a27, 0
    v_accvgpr_write_b32 a28, 0
    v_accvgpr_write_b32 a29, 0
    v_accvgpr_write_b32 a30, 0
    v_accvgpr_write_b32 a31, 0
    v_accvgpr_write_b32 a32, 0
    v_accvgpr_write_b32 a33, 0
    v_accvgpr_write_b32 a34, 0
    v_accvgpr_write_b32 a35, 0
    v_accvgpr_write_b32 a36, 0
    v_accvgpr_write_b32 a37, 0
    v_accvgpr_write_b32 a38, 0
    v_accvgpr_write_b32 a39, 0
    v_accvgpr_write_b32 a40, 0
    v_accvgpr_write_b32 a41, 0
    v_accvgpr_write_b32 a42, 0
    v_accvgpr_write_b32 a43, 0
    v_accvgpr_write_b32 a44, 0
    v_accvgpr_write_b32 a45, 0
    v_accvgpr_write_b32 a46, 0
    v_accvgpr_write_b32 a47, 0
    s_sub_u32 s49, s47, 18
    s_cmp_lt_u32 s47, 18
    s_cselect_b32 s49, s47, s49
    s_cselect_b32 s8, s34, s36
    s_cselect_b32 s9, s35, s37
    s_cselect_b32 s10, s44, s45
    s_mul_i32 s17, s49, 36864
    s_add_u32 s17, s17, s48
    s_add_u32 s47, s47, 1
    s_add_u32 m0, s24, 49152
    s_add_u32 s19, s17, s20
    buffer_load_dwordx4 v3, s[8:11], s19 offen lds
    s_add_u32 m0, s25, 49152
    s_add_u32 s19, s17, s21
    buffer_load_dwordx4 v3, s[8:11], s19 offen lds
    s_add_u32 s17, s17, s18
    s_add_u32 m0, s28, 0
    s_add_u32 s19, s16, 0
    buffer_load_dwordx4 v2, s[4:7], s19 offen lds
    s_add_u32 m0, s28, 8192
    s_add_u32 s19, s16, 0
    s_add_u32 s19, s19, s29
    buffer_load_dwordx4 v2, s[4:7], s19 offen lds
    s_sub_u32 s49, s47, 18
    s_cmp_lt_u32 s47, 18
    s_cselect_b32 s49, s47, s49
    s_cselect_b32 s8, s34, s36
    s_cselect_b32 s9, s35, s37
    s_cselect_b32 s10, s44, s45
    s_mul_i32 s17, s49, 36864
    s_add_u32 s17, s17, s48
    s_add_u32 s47, s47, 1
    s_add_u32 m0, s24, 61440
    s_add_u32 s19, s17, s20
    buffer_load_dwordx4 v3, s[8:11], s19 offen lds
    s_add_u32 m0, s25, 61440
    s_add_u32 s19, s17, s21
    buffer_load_dwordx4 v3, s[8:11], s19 offen lds
    s_add_u32 s17, s17, s18
    s_add_u32 m0, s28, 16384
    s_add_u32 s19, s16, 128
    buffer_load_dwordx4 v2, s[4:7], s19 offen lds
    s_add_u32 m0, s28, 24576
    s_add_u32 s19, s16, 128
    s_add_u32 s19, s19, s29
    buffer_load_dwordx4 v2, s[4:7], s19 offen lds
    s_sub_u32 s49, s47, 18
    s_cmp_lt_u32 s47, 18
    s_cselect_b32 s49, s47, s49
    s_cselect_b32 s8, s34, s36
    s_cselect_b32 s9, s35, s37
    s_cselect_b32 s10, s44, s45
    s_mul_i32 s17, s49, 36864
    s_add_u32 s17, s17, s48
    s_add_u32 s47, s47, 1
    s_add_u32 m0, s24, 73728
    s_add_u32 s19, s17, s20
    buffer_load_dwordx4 v3, s[8:11], s19 offen lds
    s_add_u32 m0, s25, 73728
    s_add_u32 s19, s17, s21
    buffer_load_dwordx4 v3, s[8:11], s19 offen lds
    s_add_u32 s17, s17, s18
    s_add_u32 m0, s28, 32768
    s_add_u32 s19, s16, 256
    buffer_load_dwordx4 v2, s[4:7], s19 offen lds
    s_add_u32 m0, s28, 40960
    s_add_u32 s19, s16, 256
    s_add_u32 s19, s19, s29
    buffer_load_dwordx4 v2, s[4:7], s19 offen lds
    s_sub_u32 s49, s47, 18
    s_cmp_lt_u32 s47, 18
    s_cselect_b32 s49, s47, s49
    s_cselect_b32 s8, s34, s36
    s_cselect_b32 s9, s35, s37
    s_cselect_b32 s10, s44, s45
    s_mul_i32 s17, s49, 36864
    s_add_u32 s17, s17, s48
    s_add_u32 s47, s47, 1
    s_add_u32 m0, s24, 86016
    s_add_u32 s19, s17, s20
    buffer_load_dwordx4 v3, s[8:11], s19 offen lds
    s_add_u32 m0, s25, 86016
    s_add_u32 s19, s17, s21
    buffer_load_dwordx4 v3, s[8:11], s19 offen lds
    s_add_u32 s17, s17, s18
    s_waitcnt vmcnt(8)
    s_barrier
    ds_read_b128 v[16:19], v4 offset:0
    ds_read_b128 v[20:23], v4 offset:2048
    ds_read_b128 v[24:27], v4 offset:4096
    ds_read_b128 v[28:31], v4 offset:6144
    ds_read_b64_tr_b16 v[32:33], v6 offset:0
    ds_read_b64_tr_b16 v[34:35], v6 offset:512
    ds_read_b64_tr_b16 v[36:37], v6 offset:4096
    ds_read_b64_tr_b16 v[38:39], v6 offset:4608
    ds_read_b64_tr_b16 v[40:41], v6 offset:8192
    ds_read_b64_tr_b16 v[42:43], v6 offset:8704
    s_waitcnt lgkmcnt(0)
    s_barrier
    v_mfma_f32_16x16x32_bf16 a[0:3], v[32:35], v[16:19], a[0:3]
    ds_read_b128 v[44:47], v5 offset:0
    v_mfma_f32_16x16x32_bf16 a[4:7], v[32:35], v[20:23], a[4:7]
    ds_read_b128 v[48:51], v5 offset:2048
    v_mfma_f32_16x16x32_bf16 a[8:11], v[32:35], v[24:27], a[8:11]
    ds_read_b128 v[52:55], v5 offset:4096
    v_mfma_f32_16x16x32_bf16 a[12:15], v[32:35], v[28:31], a[12:15]
    ds_read_b128 v[56:59], v5 offset:6144
    v_mfma_f32_16x16x32_bf16 a[16:19], v[36:39], v[16:19], a[16:19]
    ds_read_b64_tr_b16 v[60:61], v7 offset:0
    v_mfma_f32_16x16x32_bf16 a[20:23], v[36:39], v[20:23], a[20:23]
    ds_read_b64_tr_b16 v[62:63], v7 offset:512
    v_mfma_f32_16x16x32_bf16 a[24:27], v[36:39], v[24:27], a[24:27]
    ds_read_b64_tr_b16 v[64:65], v7 offset:4096
    v_mfma_f32_16x16x32_bf16 a[28:31], v[36:39], v[28:31], a[28:31]
    ds_read_b64_tr_b16 v[66:67], v7 offset:4608
    v_mfma_f32_16x16x32_bf16 a[32:35], v[40:43], v[16:19], a[32:35]
    ds_read_b64_tr_b16 v[68:69], v7 offset:8192
    v_mfma_f32_16x16x32_bf16 a[36:39], v[40:43], v[20:23], a[36:39]
    ds_read_b64_tr_b16 v[70:71], v7 offset:8704
    v_mfma_f32_16x16x32_bf16 a[40:43], v[40:43], v[24:27], a[40:43]
    s_sub_u32 s49, s47, 18
    s_cmp_lt_u32 s47, 18
    s_cselect_b32 s49, s47, s49
    s_cselect_b32 s8, s34, s36
    s_cselect_b32 s9, s35, s37
    s_cselect_b32 s10, s44, s45
    s_mul_i32 s17, s49, 36864
    s_add_u32 s17, s17, s48
    s_add_u32 s47, s47, 1
    v_mfma_f32_16x16x32_bf16 a[44:47], v[40:43], v[28:31], a[44:47]
    s_add_u32 m0, s24, 49152
    s_add_u32 s19, s17, s20
    buffer_load_dwordx4 v3, s[8:11], s19 offen lds
    s_add_u32 m0, s25, 49152
    s_add_u32 s19, s17, s21
    buffer_load_dwordx4 v3, s[8:11], s19 offen lds
    s_add_u32 s17, s17, s18
    s_waitcnt vmcnt(6) lgkmcnt(0)
    s_barrier
    v_mfma_f32_16x16x32_bf16 a[0:3], v[60:63], v[44:47], a[0:3]
    ds_read_b128 v[16:19], v4 offset:16384
    v_mfma_f32_16x16x32_bf16 a[4:7], v[60:63], v[48:51], a[4:7]
    ds_read_b128 v[20:23], v4 offset:18432
    v_mfma_f32_16x16x32_bf16 a[8:11], v[60:63], v[52:55], a[8:11]
    ds_read_b128 v[24:27], v4 offset:20480
    v_mfma_f32_16x16x32_bf16 a[12:15], v[60:63], v[56:59], a[12:15]
    ds_read_b128 v[28:31], v4 offset:22528
    ds_read_b64_tr_b16 v[32:33], v8 offset:0
    v_mfma_f32_16x16x32_bf16 a[16:19], v[64:67], v[44:47], a[16:19]
    ds_read_b64_tr_b16 v[34:35], v8 offset:512
    v_mfma_f32_16x16x32_bf16 a[20:23], v[64:67], v[48:51], a[20:23]
    ds_read_b64_tr_b16 v[36:37], v8 offset:4096
    v_mfma_f32_16x16x32_bf16 a[24:27], v[64:67], v[52:55], a[24:27]
    ds_read_b64_tr_b16 v[38:39], v8 offset:4608
    v_mfma_f32_16x16x32_bf16 a[28:31], v[64:67], v[56:59], a[28:31]
    ds_read_b64_tr_b16 v[40:41], v8 offset:8192
    ds_read_b64_tr_b16 v[42:43], v8 offset:8704
    v_mfma_f32_16x16x32_bf16 a[32:35], v[68:71], v[44:47], a[32:35]
    s_sub_u32 s49, s47, 18
    s_cmp_lt_u32 s47, 18
    s_cselect_b32 s49, s47, s49
    s_cselect_b32 s8, s34, s36
    s_cselect_b32 s9, s35, s37
    s_cselect_b32 s10, s44, s45
    s_mul_i32 s17, s49, 36864
    s_add_u32 s17, s17, s48
    s_add_u32 s47, s47, 1
    v_mfma_f32_16x16x32_bf16 a[36:39], v[68:71], v[48:51], a[36:39]
    s_add_u32 m0, s24, 61440
    s_add_u32 s19, s17, s20
    buffer_load_dwordx4 v3, s[8:11], s19 offen lds
    v_mfma_f32_16x16x32_bf16 a[40:43], v[68:71], v[52:55], a[40:43]
    s_add_u32 m0, s25, 61440
    s_add_u32 s19, s17, s21
    buffer_load_dwordx4 v3, s[8:11], s19 offen lds
    s_add_u32 s17, s17, s18
    v_mfma_f32_16x16x32_bf16 a[44:47], v[68:71], v[56:59], a[44:47]
    s_add_u32 m0, s28, 0
    s_add_u32 s19, s16, 384
    buffer_load_dwordx4 v2, s[4:7], s19 offen lds
    s_add_u32 m0, s28, 8192
    s_add_u32 s19, s16, 384
    s_add_u32 s19, s19, s29
    buffer_load_dwordx4 v2, s[4:7], s19 offen lds
    s_waitcnt vmcnt(6) lgkmcnt(0)
    s_barrier
    v_mfma_f32_16x16x32_bf16 a[0:3], v[32:35], v[16:19], a[0:3]
    ds_read_b128 v[44:47], v5 offset:16384
    v_mfma_f32_16x16x32_bf16 a[4:7], v[32:35], v[20:23], a[4:7]
    ds_read_b128 v[48:51], v5 offset:18432
    v_mfma_f32_16x16x32_bf16 a[8:11], v[32:35], v[24:27], a[8:11]
    ds_read_b128 v[52:55], v5 offset:20480
    v_mfma_f32_16x16x32_bf16 a[12:15], v[32:35], v[28:31], a[12:15]
    ds_read_b128 v[56:59], v5 offset:22528
    v_mfma_f32_16x16x32_bf16 a[16:19], v[36:39], v[16:19], a[16:19]
    ds_read_b64_tr_b16 v[60:61], v9 offset:0
    v_mfma_f32_16x16x32_bf16 a[20:23], v[36:39], v[20:23], a[20:23]
    ds_read_b64_tr_b16 v[62:63], v9 offset:512
    v_mfma_f32_16x16x32_bf16 a[24:27], v[36:39], v[24:27], a[24:27]
    ds_read_b64_tr_b16 v[64:65], v9 offset:4096
    v_mfma_f32_16x16x32_bf16 a[28:31], v[36:39], v[28:31], a[28:31]
    ds_read_b64_tr_b16 v[66:67], v9 offset:4608
    v_mfma_f32_16x16x32_bf16 a[32:35], v[40:43], v[16:19], a[32:35]
    ds_read_b64_tr_b16 v[68:69], v9 offset:8192
    v_mfma_f32_16x16x32_bf16 a[36:39], v[40:43], v[20:23], a[36:39]
    ds_read_b64_tr_b16 v[70:71], v9 offset:8704
    v_mfma_f32_16x16x32_bf16 a[40:43], v[40:43], v[24:27], a[40:43]
    s_sub_u32 s49, s47, 18
    s_cmp_lt_u32 s47, 18
    s_cselect_b32 s49, s47, s49
    s_cselect_b32 s8, s34, s36
    s_cselect_b32 s9, s35, s37
    s_cselect_b32 s10, s44, s45
    s_mul_i32 s17, s49, 36864
    s_add_u32 s17, s17, s48
    s_add_u32 s47, s47, 1
    v_mfma_f32_16x16x32_bf16 a[44:47], v[40:43], v[28:31], a[44:47]
    s_add_u32 m0, s24, 73728
    s_add_u32 s19, s17, s20
    buffer_load_dwordx4 v3, s[8:11], s19 offen lds
    s_add_u32 m0, s25, 73728
    s_add_u32 s19, s17, s21
    buffer_load_dwordx4 v3, s[8:11], s19 offen lds
    s_add_u32 s17, s17, s18
    s_waitcnt vmcnt(6) lgkmcnt(0)
    s_barrier
    v_mfma_f32_16x16x32_bf16 a[0:3], v[60:63], v[44:47], a[0:3]
    ds_read_b128 v[16:19], v4 offset:32768
    v_mfma_f32_16x16x32_bf16 a[4:7], v[60:63], v[48:51], a[4:7]
    ds_read_b128 v[20:23], v4 offset:34816
    v_mfma_f32_16x16x32_bf16 a[8:11], v[60:63], v[52:55], a[8:11]
    ds_read_b128 v[24:27], v4 offset:36864
    v_mfma_f32_16x16x32_bf16 a[12:15], v[60:63], v[56:59], a[12:15]
    ds_read_b128 v[28:31], v4 offset:38912
    ds_read_b64_tr_b16 v[32:33], v6 offset:0
    v_mfma_f32_16x16x32_bf16 a[16:19], v[64:67], v[44:47], a[16:19]
    ds_read_b64_tr_b16 v[34:35], v6 offset:512
    v_mfma_f32_16x16x32_bf16 a[20:23], v[64:67], v[48:51], a[20:23]
    ds_read_b64_tr_b16 v[36:37], v6 offset:4096
    v_mfma_f32_16x16x32_bf16 a[24:27], v[64:67], v[52:55], a[24:27]
    ds_read_b64_tr_b16 v[38:39], v6 offset:4608
    v_mfma_f32_16x16x32_bf16 a[28:31], v[64:67], v[56:59], a[28:31]
    ds_read_b64_tr_b16 v[40:41], v6 offset:8192
    ds_read_b64_tr_b16 v[42:43], v6 offset:8704
    v_mfma_f32_16x16x32_bf16 a[32:35], v[68:71], v[44:47], a[32:35]
    s_sub_u32 s49, s47, 18
    s_cmp_lt_u32 s47, 18
    s_cselect_b32 s49, s47, s49
    s_cselect_b32 s8, s34, s36
    s_cselect_b32 s9, s35, s37
    s_cselect_b32 s10, s44, s45
    s_mul_i32 s17, s49, 36864
    s_add_u32 s17, s17, s48
    s_add_u32 s47, s47, 1
    v_mfma_f32_16x16x32_bf16 a[36:39], v[68:71], v[48:51], a[36:39]
    s_add_u32 m0, s24, 86016
    s_add_u32 s19, s17, s20
    buffer_load_dwordx4 v3, s[8:11], s19 offen lds
    v_mfma_f32_16x16x32_bf16 a[40:43], v[68:71], v[52:55], a[40:43]
    s_add_u32 m0, s25, 86016
    s_add_u32 s19, s17, s21
    buffer_load_dwordx4 v3, s[8:11], s19 offen lds
    s_add_u32 s17, s17, s18
    v_mfma_f32_16x16x32_bf16 a[44:47], v[68:71], v[56:59], a[44:47]
    s_add_u32 m0, s28, 16384
    s_add_u32 s19, s16, 512
    buffer_load_dwordx4 v2, s[4:7], s19 offen lds
    s_add_u32 m0, s28, 24576
    s_add_u32 s19, s16, 512
    s_add_u32 s19, s19, s29
    buffer_load_dwordx4 v2, s[4:7], s19 offen lds
    s_waitcnt vmcnt(8) lgkmcnt(0)
    s_barrier
    v_mfma_f32_16x16x32_bf16 a[0:3], v[32:35], v[16:19], a[0:3]
    ds_read_b128 v[44:47], v5 offset:32768
    v_mfma_f32_16x16x32_bf16 a[4:7], v[32:35], v[20:23], a[4:7]
    ds_read_b128 v[48:51], v5 offset:34816
    v_mfma_f32_16x16x32_bf16 a[8:11], v[32:35], v[24:27], a[8:11]
    ds_read_b128 v[52:55], v5 offset:36864
    v_mfma_f32_16x16x32_bf16 a[12:15], v[32:35], v[28:31], a[12:15]
    ds_read_b128 v[56:59], v5 offset:38912
    v_mfma_f32_16x16x32_bf16 a[16:19], v[36:39], v[16:19], a[16:19]
    ds_read_b64_tr_b16 v[60:61], v7 offset:0
    v_mfma_f32_16x16x32_bf16 a[20:23], v[36:39], v[20:23], a[20:23]
    ds_read_b64_tr_b16 v[62:63], v7 offset:512
    v_mfma_f32_16x16x32_bf16 a[24:27], v[36:39], v[24:27], a[24:27]
    ds_read_b64_tr_b16 v[64:65], v7 offset:4096
    v_mfma_f32_16x16x32_bf16 a[28:31], v[36:39], v[28:31], a[28:31]
    ds_read_b64_tr_b16 v[66:67], v7 offset:4608
    v_mfma_f32_16x16x32_bf16 a[32:35], v[40:43], v[16:19], a[32:35]
    ds_read_b64_tr_b16 v[68:69], v7 offset:8192
    v_mfma_f32_16x16x32_bf16 a[36:39], v[40:43], v[20:23], a[36:39]
    ds_read_b64_tr_b16 v[70:71], v7 offset:8704
    v_mfma_f32_16x16x32_bf16 a[40:43], v[40:43], v[24:27], a[40:43]
    s_sub_u32 s49, s47, 18
    s_cmp_lt_u32 s47, 18
    s_cselect_b32 s49, s47, s49
    s_cselect_b32 s8, s34, s36
    s_cselect_b32 s9, s35, s37
    s_cselect_b32 s10, s44, s45
    s_mul_i32 s17, s49, 36864
    s_add_u32 s17, s17, s48
    s_add_u32 s47, s47, 1
    v_mfma_f32_16x16x32_bf16 a[44:47], v[40:43], v[28:31], a[44:47]
    s_add_u32 m0, s24, 49152
    s_add_u32 s19, s17, s20
    buffer_load_dwordx4 v3, s[8:11], s19 offen lds
    s_add_u32 m0, s25, 49152
    s_add_u32 s19, s17, s21
    buffer_load_dwordx4 v3, s[8:11], s19 offen lds
    s_add_u32 s17, s17, s18
    s_waitcnt vmcnt(6) lgkmcnt(0)
    s_barrier
    v_mfma_f32_16x16x32_bf16 a[0:3], v[60:63], v[44:47], a[0:3]
    ds_read_b128 v[16:19], v4 offset:0
    v_mfma_f32_16x16x32_bf16 a[4:7], v[60:63], v[48:51], a[4:7]
    ds_read_b128 v[20:23], v4 offset:2048
    v_mfma_f32_16x16x32_bf16 a[8:11], v[60:63], v[52:55], a[8:11]
    ds_read_b128 v[24:27], v4 offset:4096
    v_mfma_f32_16x16x32_bf16 a[12:15], v[60:63], v[56:59], a[12:15]
    ds_read_b128 v[28:31], v4 offset:6144
    ds_read_b64_tr_b16 v[32:33], v8 offset:0
    v_mfma_f32_16x16x32_bf16 a[16:19], v[64:67], v[44:47], a[16:19]
    ds_read_b64_tr_b16 v[34:35], v8 offset:512
    v_mfma_f32_16x16x32_bf16 a[20:23], v[64:67], v[48:51], a[20:23]
    ds_read_b64_tr_b16 v[36:37], v8 offset:4096
    v_mfma_f32_16x16x32_bf16 a[24:27], v[64:67], v[52:55], a[24:27]
    ds_read_b64_tr_b16 v[38:39], v8 offset:4608
    v_mfma_f32_16x16x32_bf16 a[28:31], v[64:67], v[56:59], a[28:31]
    ds_read_b64_tr_b16 v[40:41], v8 offset:8192
    ds_read_b64_tr_b16 v[42:43], v8 offset:8704
    v_mfma_f32_16x16x32_bf16 a[32:35], v[68:71], v[44:47], a[32:35]
    s_sub_u32 s49, s47, 18
    s_cmp_lt_u32 s47, 18
    s_cselect_b32 s49, s47, s49
    s_cselect_b32 s8, s34, s36
    s_cselect_b32 s9, s35, s37
    s_cselect_b32 s10, s44, s45
    s_mul_i32 s17, s49, 36864
    s_add_u32 s17, s17, s48
    s_add_u32 s47, s47, 1
    v_mfma_f32_16x16x32_bf16 a[36:39], v[68:71], v[48:51], a[36:39]
    s_add_u32 m0, s24, 61440
    s_add_u32 s19, s17, s20
    buffer_load_dwordx4 v3, s[8:11], s19 offen lds
    v_mfma_f32_16x16x32_bf16 a[40:43], v[68:71], v[52:55], a[40:43]
    s_add_u32 m0, s25, 61440
    s_add_u32 s19, s17, s21
    buffer_load_dwordx4 v3, s[8:11], s19 offen lds
    s_add_u32 s17, s17, s18
    v_mfma_f32_16x16x32_bf16 a[44:47], v[68:71], v[56:59], a[44:47]
    s_add_u32 m0, s28, 32768
    s_add_u32 s19, s16, 640
    buffer_load_dwordx4 v2, s[4:7], s19 offen lds
    s_add_u32 m0, s28, 40960
    s_add_u32 s19, s16, 640
    s_add_u32 s19, s19, s29
    buffer_load_dwordx4 v2, s[4:7], s19 offen lds
    s_waitcnt vmcnt(8) lgkmcnt(0)
    s_barrier
    v_mfma_f32_16x16x32_bf16 a[0:3], v[32:35], v[16:19], a[0:3]
    ds_read_b128 v[44:47], v5 offset:0
    v_mfma_f32_16x16x32_bf16 a[4:7], v[32:35], v[20:23], a[4:7]
    ds_read_b128 v[48:51], v5 offset:2048
    v_mfma_f32_16x16x32_bf16 a[8:11], v[32:35], v[24:27], a[8:11]
    ds_read_b128 v[52:55], v5 offset:4096
    v_mfma_f32_16x16x32_bf16 a[12:15], v[32:35], v[28:31], a[12:15]
    ds_read_b128 v[56:59], v5 offset:6144
    v_mfma_f32_16x16x32_bf16 a[16:19], v[36:39], v[16:19], a[16:19]
    ds_read_b64_tr_b16 v[60:61], v9 offset:0
    v_mfma_f32_16x16x32_bf16 a[20:23], v[36:39], v[20:23], a[20:23]
    ds_read_b64_tr_b16 v[62:63], v9 offset:512
    v_mfma_f32_16x16x32_bf16 a[24:27], v[36:39], v[24:27], a[24:27]
    ds_read_b64_tr_b16 v[64:65], v9 offset:4096
    v_mfma_f32_16x16x32_bf16 a[28:31], v[36:39], v[28:31], a[28:31]
    ds_read_b64_tr_b16 v[66:67], v9 offset:4608
    v_mfma_f32_16x16x32_bf16 a[32:35], v[40:43], v[16:19], a[32:35]
    ds_read_b64_tr_b16 v[68:69], v9 offset:8192
    v_mfma_f32_16x16x32_bf16 a[36:39], v[40:43], v[20:23], a[36:39]
    ds_read_b64_tr_b16 v[70:71], v9 offset:8704
    v_mfma_f32_16x16x32_bf16 a[40:43], v[40:43], v[24:27], a[40:43]
    s_sub_u32 s49, s47, 18
    s_cmp_lt_u32 s47, 18
    s_cselect_b32 s49, s47, s49
    s_cselect_b32 s8, s34, s36
    s_cselect_b32 s9, s35, s37
    s_cselect_b32 s10, s44, s45
    s_mul_i32 s17, s49, 36864
    s_add_u32 s17, s17, s48
    s_add_u32 s47, s47, 1
    v_mfma_f32_16x16x32_bf16 a[44:47], v[40:43], v[28:31], a[44:47]
    s_add_u32 m0, s24, 73728
    s_add_u32 s19, s17, s20
    buffer_load_dwordx4 v3, s[8:11], s19 offen lds
    s_add_u32 m0, s25, 73728
    s_add_u32 s19, s17, s21
    buffer_load_dwordx4 v3, s[8:11], s19 offen lds
    s_add_u32 s17, s17, s18
    s_waitcnt vmcnt(6) lgkmcnt(0)
    s_barrier
    v_mfma_f32_16x16x32_bf16 a[0:3], v[60:63], v[44:47], a[0:3]
    ds_read_b128 v[16:19], v4 offset:16384
    v_mfma_f32_16x16x32_bf16 a[4:7], v[60:63], v[48:51], a[4:7]
    ds_read_b128 v[20:23], v4 offset:18432
    v_mfma_f32_16x16x32_bf16 a[8:11], v[60:63], v[52:55], a[8:11]
    ds_read_b128 v[24:27], v4 offset:20480
    v_mfma_f32_16x16x32_bf16 a[12:15], v[60:63], v[56:59], a[12:15]
    ds_read_b128 v[28:31], v4 offset:22528
    ds_read_b64_tr_b16 v[32:33], v6 offset:0
    v_mfma_f32_16x16x32_bf16 a[16:19], v[64:67], v[44:47], a[16:19]
    ds_read_b64_tr_b16 v[34:35], v6 offset:512
    v_mfma_f32_16x16x32_bf16 a[20:23], v[64:67], v[48:51], a[20:23]
    ds_read_b64_tr_b16 v[36:37], v6 offset:4096
    v_mfma_f32_16x16x32_bf16 a[24:27], v[64:67], v[52:55], a[24:27]
    ds_read_b64_tr_b16 v[38:39], v6 offset:4608
    v_mfma_f32_16x16x32_bf16 a[28:31], v[64:67], v[56:59], a[28:31]
    ds_read_b64_tr_b16 v[40:41], v6 offset:8192
    ds_read_b64_tr_b16 v[42:43], v6 offset:8704
    v_mfma_f32_16x16x32_bf16 a[32:35], v[68:71], v[44:47], a[32:35]
    s_sub_u32 s49, s47, 18
    s_cmp_lt_u32 s47, 18
    s_cselect_b32 s49, s47, s49
    s_cselect_b32 s8, s34, s36
    s_cselect_b32 s9, s35, s37
    s_cselect_b32 s10, s44, s45
    s_mul_i32 s17, s49, 36864
    s_add_u32 s17, s17, s48
    s_add_u32 s47, s47, 1
    v_mfma_f32_16x16x32_bf16 a[36:39], v[68:71], v[48:51], a[36:39]
    s_add_u32 m0, s24, 86016
    s_add_u32 s19, s17, s20
    buffer_load_dwordx4 v3, s[8:11], s19 offen lds
    v_mfma_f32_16x16x32_bf16 a[40:43], v[68:71], v[52:55], a[40:43]
    s_add_u32 m0, s25, 86016
    s_add_u32 s19, s17, s21
    buffer_load_dwordx4 v3, s[8:11], s19 offen lds
    s_add_u32 s17, s17, s18
    v_mfma_f32_16x16x32_bf16 a[44:47], v[68:71], v[56:59], a[44:47]
    s_add_u32 m0, s28, 0
    s_add_u32 s19, s16, 768
    buffer_load_dwordx4 v2, s[4:7], s19 offen lds
    s_add_u32 m0, s28, 8192
    s_add_u32 s19, s16, 768
    s_add_u32 s19, s19, s29
    buffer_load_dwordx4 v2, s[4:7], s19 offen lds
    s_waitcnt vmcnt(8) lgkmcnt(0)
    s_barrier
    v_mfma_f32_16x16x32_bf16 a[0:3], v[32:35], v[16:19], a[0:3]
    ds_read_b128 v[44:47], v5 offset:16384
    v_mfma_f32_16x16x32_bf16 a[4:7], v[32:35], v[20:23], a[4:7]
    ds_read_b128 v[48:51], v5 offset:18432
    v_mfma_f32_16x16x32_bf16 a[8:11], v[32:35], v[24:27], a[8:11]
    ds_read_b128 v[52:55], v5 offset:20480
    v_mfma_f32_16x16x32_bf16 a[12:15], v[32:35], v[28:31], a[12:15]
    ds_read_b128 v[56:59], v5 offset:22528
    v_mfma_f32_16x16x32_bf16 a[16:19], v[36:39], v[16:19], a[16:19]
    ds_read_b64_tr_b16 v[60:61], v7 offset:0
    v_mfma_f32_16x16x32_bf16 a[20:23], v[36:39], v[20:23], a[20:23]
    ds_read_b64_tr_b16 v[62:63], v7 offset:512
    v_mfma_f32_16x16x32_bf16 a[24:27], v[36:39], v[24:27], a[24:27]
    ds_read_b64_tr_b16 v[64:65], v7 offset:4096
    v_mfma_f32_16x16x32_bf16 a[28:31], v[36:39], v[28:31], a[28:31]
    ds_read_b64_tr_b16 v[66:67], v7 offset:4608
    v_mfma_f32_16x16x32_bf16 a[32:35], v[40:43], v[16:19], a[32:35]
    ds_read_b64_tr_b16 v[68:69], v7 offset:8192
    v_mfma_f32_16x16x32_bf16 a[36:39], v[40:43], v[20:23], a[36:39]
    ds_read_b64_tr_b16 v[70:71], v7 offset:8704
    v_mfma_f32_16x16x32_bf16 a[40:43], v[40:43], v[24:27], a[40:43]
    s_sub_u32 s49, s47, 18
    s_cmp_lt_u32 s47, 18
    s_cselect_b32 s49, s47, s49
    s_cselect_b32 s8, s34, s36
    s_cselect_b32 s9, s35, s37
    s_cselect_b32 s10, s44, s45
    s_mul_i32 s17, s49, 36864
    s_add_u32 s17, s17, s48
    s_add_u32 s47, s47, 1
    v_mfma_f32_16x16x32_bf16 a[44:47], v[40:43], v[28:31], a[44:47]
    s_add_u32 m0, s24, 49152
    s_add_u32 s19, s17, s20
    buffer_load_dwordx4 v3, s[8:11], s19 offen lds
    s_add_u32 m0, s25, 49152
    s_add_u32 s19, s17, s21
    buffer_load_dwordx4 v3, s[8:11], s19 offen lds
    s_add_u32 s17, s17, s18
    s_waitcnt vmcnt(6) lgkmcnt(0)
    s_barrier
    v_mfma_f32_16x16x32_bf16 a[0:3], v[60:63], v[44:47], a[0:3]
    ds_read_b128 v[16:19], v4 offset:32768
    v_mfma_f32_16x16x32_bf16 a[4:7], v[60:63], v[48:51], a[4:7]
    ds_read_b128 v[20:23], v4 offset:34816
    v_mfma_f32_16x16x32_bf16 a[8:11], v[60:63], v[52:55], a[8:11]
    ds_read_b128 v[24:27], v4 offset:36864
    v_mfma_f32_16x16x32_bf16 a[12:15], v[60:63], v[56:59], a[12:15]
    ds_read_b128 v[28:31], v4 offset:38912
    ds_read_b64_tr_b16 v[32:33], v8 offset:0
    v_mfma_f32_16x16x32_bf16 a[16:19], v[64:67], v[44:47], a[16:19]
    ds_read_b64_tr_b16 v[34:35], v8 offset:512
    v_mfma_f32_16x16x32_bf16 a[20:23], v[64:67], v[48:51], a[20:23]
    ds_read_b64_tr_b16 v[36:37], v8 offset:4096
    v_mfma_f32_16x16x32_bf16 a[24:27], v[64:67], v[52:55], a[24:27]
    ds_read_b64_tr_b16 v[38:39], v8 offset:4608
    v_mfma_f32_16x16x32_bf16 a[28:31], v[64:67], v[56:59], a[28:31]
    ds_read_b64_tr_b16 v[40:41], v8 offset:8192
    ds_read_b64_tr_b16 v[42:43], v8 offset:8704
    v_mfma_f32_16x16x32_bf16 a[32:35], v[68:71], v[44:47], a[32:35]
    s_sub_u32 s49, s47, 18
    s_cmp_lt_u32 s47, 18
    s_cselect_b32 s49, s47, s49
    s_cselect_b32 s8, s34, s36
    s_cselect_b32 s9, s35, s37
    s_cselect_b32 s10, s44, s45
    s_mul_i32 s17, s49, 36864
    s_add_u32 s17, s17, s48
    s_add_u32 s47, s47, 1
    v_mfma_f32_16x16x32_bf16 a[36:39], v[68:71], v[48:51], a[36:39]
    s_add_u32 m0, s24, 61440
    s_add_u32 s19, s17, s20
    buffer_load_dwordx4 v3, s[8:11], s19 offen lds
    v_mfma_f32_16x16x32_bf16 a[40:43], v[68:71], v[52:55], a[40:43]
    s_add_u32 m0, s25, 61440
    s_add_u32 s19, s17, s21
    buffer_load_dwordx4 v3, s[8:11], s19 offen lds
    s_add_u32 s17, s17, s18
    v_mfma_f32_16x16x32_bf16 a[44:47], v[68:71], v[56:59], a[44:47]
    s_add_u32 m0, s28, 16384
    s_add_u32 s19, s16, 896
    buffer_load_dwordx4 v2, s[4:7], s19 offen lds
    s_add_u32 m0, s28, 24576
    s_add_u32 s19, s16, 896
    s_add_u32 s19, s19, s29
    buffer_load_dwordx4 v2, s[4:7], s19 offen lds
    s_waitcnt vmcnt(8) lgkmcnt(0)
    s_barrier
    v_mfma_f32_16x16x32_bf16 a[0:3], v[32:35], v[16:19], a[0:3]
    ds_read_b128 v[44:47], v5 offset:32768
    v_mfma_f32_16x16x32_bf16 a[4:7], v[32:35], v[20:23], a[4:7]
    ds_read_b128 v[48:51], v5 offset:34816
    v_mfma_f32_16x16x32_bf16 a[8:11], v[32:35], v[24:27], a[8:11]
    ds_read_b128 v[52:55], v5 offset:36864
    v_mfma_f32_16x16x32_bf16 a[12:15], v[32:35], v[28:31], a[12:15]
    ds_read_b128 v[56:59], v5 offset:38912
    v_mfma_f32_16x16x32_bf16 a[16:19], v[36:39], v[16:19], a[16:19]
    ds_read_b64_tr_b16 v[60:61], v9 offset:0
    v_mfma_f32_16x16x32_bf16 a[20:23], v[36:39], v[20:23], a[20:23]
    ds_read_b64_tr_b16 v[62:63], v9 offset:512
    v_mfma_f32_16x16x32_bf16 a[24:27], v[36:39], v[24:27], a[24:27]
    ds_read_b64_tr_b16 v[64:65], v9 offset:4096
    v_mfma_f32_16x16x32_bf16 a[28:31], v[36:39], v[28:31], a[28:31]
    ds_read_b64_tr_b16 v[66:67], v9 offset:4608
    v_mfma_f32_16x16x32_bf16 a[32:35], v[40:43], v[16:19], a[32:35]
    ds_read_b64_tr_b16 v[68:69], v9 offset:8192
    v_mfma_f32_16x16x32_bf16 a[36:39], v[40:43], v[20:23], a[36:39]
    ds_read_b64_tr_b16 v[70:71], v9 offset:8704
    v_mfma_f32_16x16x32_bf16 a[40:43], v[40:43], v[24:27], a[40:43]
    s_sub_u32 s49, s47, 18
    s_cmp_lt_u32 s47, 18
    s_cselect_b32 s49, s47, s49
    s_cselect_b32 s8, s34, s36
    s_cselect_b32 s9, s35, s37
    s_cselect_b32 s10, s44, s45
    s_mul_i32 s17, s49, 36864
    s_add_u32 s17, s17, s48
    s_add_u32 s47, s47, 1
    v_mfma_f32_16x16x32_bf16 a[44:47], v[40:43], v[28:31], a[44:47]
    s_add_u32 m0, s24, 73728
    s_add_u32 s19, s17, s20
    buffer_load_dwordx4 v3, s[8:11], s19 offen lds
    s_add_u32 m0, s25, 73728
    s_add_u32 s19, s17, s21
    buffer_load_dwordx4 v3, s[8:11], s19 offen lds
    s_add_u32 s17, s17, s18
    s_waitcnt vmcnt(6) lgkmcnt(0)
    s_barrier
    v_mfma_f32_16x16x32_bf16 a[0:3], v[60:63], v[44:47], a[0:3]
    ds_read_b128 v[16:19], v4 offset:0
    v_mfma_f32_16x16x32_bf16 a[4:7], v[60:63], v[48:51], a[4:7]
    ds_read_b128 v[20:23], v4 offset:2048
    v_mfma_f32_16x16x32_bf16 a[8:11], v[60:63], v[52:55], a[8:11]
    ds_read_b128 v[24:27], v4 offset:4096
    v_mfma_f32_16x16x32_bf16 a[12:15], v[60:63], v[56:59], a[12:15]
    ds_read_b128 v[28:31], v4 offset:6144
    ds_read_b64_tr_b16 v[32:33], v6 offset:0
    v_mfma_f32_16x16x32_bf16 a[16:19], v[64:67], v[44:47], a[16:19]
    ds_read_b64_tr_b16 v[34:35], v6 offset:512
    v_mfma_f32_16x16x32_bf16 a[20:23], v[64:67], v[48:51], a[20:23]
    ds_read_b64_tr_b16 v[36:37], v6 offset:4096
    v_mfma_f32_16x16x32_bf16 a[24:27], v[64:67], v[52:55], a[24:27]
    ds_read_b64_tr_b16 v[38:39], v6 offset:4608
    v_mfma_f32_16x16x32_bf16 a[28:31], v[64:67], v[56:59], a[28:31]
    ds_read_b64_tr_b16 v[40:41], v6 offset:8192
    ds_read_b64_tr_b16 v[42:43], v6 offset:8704
    v_mfma_f32_16x16x32_bf16 a[32:35], v[68:71], v[44:47], a[32:35]
    s_sub_u32 s49, s47, 18
    s_cmp_lt_u32 s47, 18
    s_cselect_b32 s49, s47, s49
    s_cselect_b32 s8, s34, s36
    s_cselect_b32 s9, s35, s37
    s_cselect_b32 s10, s44, s45
    s_mul_i32 s17, s49, 36864
    s_add_u32 s17, s17, s48
    s_add_u32 s47, s47, 1
    v_mfma_f32_16x16x32_bf16 a[36:39], v[68:71], v[48:51], a[36:39]
    s_add_u32 m0, s24, 86016
    s_add_u32 s19, s17, s20
    buffer_load_dwordx4 v3, s[8:11], s19 offen lds
    v_mfma_f32_16x16x32_bf16 a[40:43], v[68:71], v[52:55], a[40:43]
    s_add_u32 m0, s25, 86016
    s_add_u32 s19, s17, s21
    buffer_load_dwordx4 v3, s[8:11], s19 offen lds
    s_add_u32 s17, s17, s18
    v_mfma_f32_16x16x32_bf16 a[44:47], v[68:71], v[56:59], a[44:47]
    s_add_u32 m0, s28, 32768
    s_add_u32 s19, s16, 1024
    buffer_load_dwordx4 v2, s[4:7], s19 offen lds
    s_add_u32 m0, s28, 40960
    s_add_u32 s19, s16, 1024
    s_add_u32 s19, s19, s29
    buffer_load_dwordx4 v2, s[4:7], s19 offen lds
    s_waitcnt vmcnt(8) lgkmcnt(0)
    s_barrier
    v_mfma_f32_16x16x32_bf16 a[0:3], v[32:35], v[16:19], a[0:3]
    ds_read_b128 v[44:47], v5 offset:0
    v_mfma_f32_16x16x32_bf16 a[4:7], v[32:35], v[20:23], a[4:7]
    ds_read_b128 v[48:51], v5 offset:2048
    v_mfma_f32_16x16x32_bf16 a[8:11], v[32:35], v[24:27], a[8:11]
    ds_read_b128 v[52:55], v5 offset:4096
    v_mfma_f32_16x16x32_bf16 a[12:15], v[32:35], v[28:31], a[12:15]
    ds_read_b128 v[56:59], v5 offset:6144
    v_mfma_f32_16x16x32_bf16 a[16:19], v[36:39], v[16:19], a[16:19]
    ds_read_b64_tr_b16 v[60:61], v7 offset:0
    v_mfma_f32_16x16x32_bf16 a[20:23], v[36:39], v[20:23], a[20:23]
    ds_read_b64_tr_b16 v[62:63], v7 offset:512
    v_mfma_f32_16x16x32_bf16 a[24:27], v[36:39], v[24:27], a[24:27]
    ds_read_b64_tr_b16 v[64:65], v7 offset:4096
    v_mfma_f32_16x16x32_bf16 a[28:31], v[36:39], v[28:31], a[28:31]
    ds_read_b64_tr_b16 v[66:67], v7 offset:4608
    v_mfma_f32_16x16x32_bf16 a[32:35], v[40:43], v[16:19], a[32:35]
    ds_read_b64_tr_b16 v[68:69], v7 offset:8192
    v_mfma_f32_16x16x32_bf16 a[36:39], v[40:43], v[20:23], a[36:39]
    ds_read_b64_tr_b16 v[70:71], v7 offset:8704
    v_mfma_f32_16x16x32_bf16 a[40:43], v[40:43], v[24:27], a[40:43]
    s_sub_u32 s49, s47, 18
    s_cmp_lt_u32 s47, 18
    s_cselect_b32 s49, s47, s49
    s_cselect_b32 s8, s34, s36
    s_cselect_b32 s9, s35, s37
    s_cselect_b32 s10, s44, s45
    s_mul_i32 s17, s49, 36864
    s_add_u32 s17, s17, s48
    s_add_u32 s47, s47, 1
    v_mfma_f32_16x16x32_bf16 a[44:47], v[40:43], v[28:31], a[44:47]
    s_add_u32 m0, s24, 49152
    s_add_u32 s19, s17, s20
    buffer_load_dwordx4 v3, s[8:11], s19 offen lds
    s_add_u32 m0, s25, 49152
    s_add_u32 s19, s17, s21
    buffer_load_dwordx4 v3, s[8:11], s19 offen lds
    s_add_u32 s17, s17, s18
    s_waitcnt vmcnt(6) lgkmcnt(0)
    s_barrier
    v_mfma_f32_16x16x32_bf16 a[0:3], v[60:63], v[44:47], a[0:3]
    ds_read_b128 v[16:19], v4 offset:16384
    v_mfma_f32_16x16x32_bf16 a[4:7], v[60:63], v[48:51], a[4:7]
    ds_read_b128 v[20:23], v4 offset:18432
    v_mfma_f32_16x16x32_bf16 a[8:11], v[60:63], v[52:55], a[8:11]
    ds_read_b128 v[24:27], v4 offset:20480
    v_mfma_f32_16x16x32_bf16 a[12:15], v[60:63], v[56:59], a[12:15]
    ds_read_b128 v[28:31], v4 offset:22528
    ds_read_b64_tr_b16 v[32:33], v8 offset:0
    v_mfma_f32_16x16x32_bf16 a[16:19], v[64:67], v[44:47], a[16:19]
    ds_read_b64_tr_b16 v[34:35], v8 offset:512
    v_mfma_f32_16x16x32_bf16 a[20:23], v[64:67], v[48:51], a[20:23]
    ds_read_b64_tr_b16 v[36:37], v8 offset:4096
    v_mfma_f32_16x16x32_bf16 a[24:27], v[64:67], v[52:55], a[24:27]
    ds_read_b64_tr_b16 v[38:39], v8 offset:4608
    v_mfma_f32_16x16x32_bf16 a[28:31], v[64:67], v[56:59], a[28:31]
    ds_read_b64_tr_b16 v[40:41], v8 offset:8192
    ds_read_b64_tr_b16 v[42:43], v8 offset:8704
    v_mfma_f32_16x16x32_bf16 a[32:35], v[68:71], v[44:47], a[32:35]
    s_sub_u32 s49, s47, 18
    s_cmp_lt_u32 s47, 18
    s_cselect_b32 s49, s47, s49
    s_cselect_b32 s8, s34, s36
    s_cselect_b32 s9, s35, s37
    s_cselect_b32 s10, s44, s45
    s_mul_i32 s17, s49, 36864
    s_add_u32 s17, s17, s48
    s_add_u32 s47, s47, 1
    v_mfma_f32_16x16x32_bf16 a[36:39], v[68:71], v[48:51], a[36:39]
    s_add_u32 m0, s24, 61440
    s_add_u32 s19, s17, s20
    buffer_load_dwordx4 v3, s[8:11], s19 offen lds
    v_mfma_f32_16x16x32_bf16 a[40:43], v[68:71], v[52:55], a[40:43]
    s_add_u32 m0, s25, 61440
    s_add_u32 s19, s17, s21
    buffer_load_dwordx4 v3, s[8:11], s19 offen lds
    s_add_u32 s17, s17, s18
    v_mfma_f32_16x16x32_bf16 a[44:47], v[68:71], v[56:59], a[44:47]
    s_add_u32 m0, s28, 0
    s_add_u32 s19, s16, 1152
    buffer_load_dwordx4 v2, s[4:7], s19 offen lds
    s_add_u32 m0, s28, 8192
    s_add_u32 s19, s16, 1152
    s_add_u32 s19, s19, s29
    buffer_load_dwordx4 v2, s[4:7], s19 offen lds
    s_waitcnt vmcnt(8) lgkmcnt(0)
    s_barrier
    v_mfma_f32_16x16x32_bf16 a[0:3], v[32:35], v[16:19], a[0:3]
    ds_read_b128 v[44:47], v5 offset:16384
    v_mfma_f32_16x16x32_bf16 a[4:7], v[32:35], v[20:23], a[4:7]
    ds_read_b128 v[48:51], v5 offset:18432
    v_mfma_f32_16x16x32_bf16 a[8:11], v[32:35], v[24:27], a[8:11]
    ds_read_b128 v[52:55], v5 offset:20480
    v_mfma_f32_16x16x32_bf16 a[12:15], v[32:35], v[28:31], a[12:15]
    ds_read_b128 v[56:59], v5 offset:22528
    v_mfma_f32_16x16x32_bf16 a[16:19], v[36:39], v[16:19], a[16:19]
    ds_read_b64_tr_b16 v[60:61], v9 offset:0
    v_mfma_f32_16x16x32_bf16 a[20:23], v[36:39], v[20:23], a[20:23]
    ds_read_b64_tr_b16 v[62:63], v9 offset:512
    v_mfma_f32_16x16x32_bf16 a[24:27], v[36:39], v[24:27], a[24:27]
    ds_read_b64_tr_b16 v[64:65], v9 offset:4096
    v_mfma_f32_16x16x32_bf16 a[28:31], v[36:39], v[28:31], a[28:31]
    ds_read_b64_tr_b16 v[66:67], v9 offset:4608
    v_mfma_f32_16x16x32_bf16 a[32:35], v[40:43], v[16:19], a[32:35]
    ds_read_b64_tr_b16 v[68:69], v9 offset:8192
    v_mfma_f32_16x16x32_bf16 a[36:39], v[40:43], v[20:23], a[36:39]
    ds_read_b64_tr_b16 v[70:71], v9 offset:8704
    v_mfma_f32_16x16x32_bf16 a[40:43], v[40:43], v[24:27], a[40:43]
    s_sub_u32 s49, s47, 18
    s_cmp_lt_u32 s47, 18
    s_cselect_b32 s49, s47, s49
    s_cselect_b32 s8, s34, s36
    s_cselect_b32 s9, s35, s37
    s_cselect_b32 s10, s44, s45
    s_mul_i32 s17, s49, 36864
    s_add_u32 s17, s17, s48
    s_add_u32 s47, s47, 1
    v_mfma_f32_16x16x32_bf16 a[44:47], v[40:43], v[28:31], a[44:47]
    s_add_u32 m0, s24, 73728
    s_add_u32 s19, s17, s20
    buffer_load_dwordx4 v3, s[8:11], s19 offen lds
    s_add_u32 m0, s25, 73728
    s_add_u32 s19, s17, s21
    buffer_load_dwordx4 v3, s[8:11], s19 offen lds
    s_add_u32 s17, s17, s18
    s_waitcnt vmcnt(6) lgkmcnt(0)
    s_barrier
    v_mfma_f32_16x16x32_bf16 a[0:3], v[60:63], v[44:47], a[0:3]
    ds_read_b128 v[16:19], v4 offset:32768
    v_mfma_f32_16x16x32_bf16 a[4:7], v[60:63], v[48:51], a[4:7]
    ds_read_b128 v[20:23], v4 offset:34816
    v_mfma_f32_16x16x32_bf16 a[8:11], v[60:63], v[52:55], a[8:11]
    ds_read_b128 v[24:27], v4 offset:36864
    v_mfma_f32_16x16x32_bf16 a[12:15], v[60:63], v[56:59], a[12:15]
    ds_read_b128 v[28:31], v4 offset:38912
    ds_read_b64_tr_b16 v[32:33], v6 offset:0
    v_mfma_f32_16x16x32_bf16 a[16:19], v[64:67], v[44:47], a[16:19]
    ds_read_b64_tr_b16 v[34:35], v6 offset:512
    v_mfma_f32_16x16x32_bf16 a[20:23], v[64:67], v[48:51], a[20:23]
    ds_read_b64_tr_b16 v[36:37], v6 offset:4096
    v_mfma_f32_16x16x32_bf16 a[24:27], v[64:67], v[52:55], a[24:27]
    ds_read_b64_tr_b16 v[38:39], v6 offset:4608
    v_mfma_f32_16x16x32_bf16 a[28:31], v[64:67], v[56:59], a[28:31]
    ds_read_b64_tr_b16 v[40:41], v6 offset:8192
    ds_read_b64_tr_b16 v[42:43], v6 offset:8704
    v_mfma_f32_16x16x32_bf16 a[32:35], v[68:71], v[44:47], a[32:35]
    s_sub_u32 s49, s47, 18
    s_cmp_lt_u32 s47, 18
    s_cselect_b32 s49, s47, s49
    s_cselect_b32 s8, s34, s36
    s_cselect_b32 s9, s35, s37
    s_cselect_b32 s10, s44, s45
    s_mul_i32 s17, s49, 36864
    s_add_u32 s17, s17, s48
    s_add_u32 s47, s47, 1
    v_mfma_f32_16x16x32_bf16 a[36:39], v[68:71], v[48:51], a[36:39]
    s_add_u32 m0, s24, 86016
    s_add_u32 s19, s17, s20
    buffer_load_dwordx4 v3, s[8:11], s19 offen lds
    v_mfma_f32_16x16x32_bf16 a[40:43], v[68:71], v[52:55], a[40:43]
    s_add_u32 m0, s25, 86016
    s_add_u32 s19, s17, s21
    buffer_load_dwordx4 v3, s[8:11], s19 offen lds
    s_add_u32 s17, s17, s18
    v_mfma_f32_16x16x32_bf16 a[44:47], v[68:71], v[56:59], a[44:47]
    s_add_u32 m0, s28, 16384
    s_add_u32 s19, s16, 1280
    buffer_load_dwordx4 v2, s[4:7], s19 offen lds
    s_add_u32 m0, s28, 24576
    s_add_u32 s19, s16, 1280
    s_add_u32 s19, s19, s29
    buffer_load_dwordx4 v2, s[4:7], s19 offen lds
    s_waitcnt vmcnt(8) lgkmcnt(0)
    s_barrier
    v_mfma_f32_16x16x32_bf16 a[0:3], v[32:35], v[16:19], a[0:3]
    ds_read_b128 v[44:47], v5 offset:32768
    v_mfma_f32_16x16x32_bf16 a[4:7], v[32:35], v[20:23], a[4:7]
    ds_read_b128 v[48:51], v5 offset:34816
    v_mfma_f32_16x16x32_bf16 a[8:11], v[32:35], v[24:27], a[8:11]
    ds_read_b128 v[52:55], v5 offset:36864
    v_mfma_f32_16x16x32_bf16 a[12:15], v[32:35], v[28:31], a[12:15]
    ds_read_b128 v[56:59], v5 offset:38912
    v_mfma_f32_16x16x32_bf16 a[16:19], v[36:39], v[16:19], a[16:19]
    ds_read_b64_tr_b16 v[60:61], v7 offset:0
    v_mfma_f32_16x16x32_bf16 a[20:23], v[36:39], v[20:23], a[20:23]
    ds_read_b64_tr_b16 v[62:63], v7 offset:512
    v_mfma_f32_16x16x32_bf16 a[24:27], v[36:39], v[24:27], a[24:27]
    ds_read_b64_tr_b16 v[64:65], v7 offset:4096
    v_mfma_f32_16x16x32_bf16 a[28:31], v[36:39], v[28:31], a[28:31]
    ds_read_b64_tr_b16 v[66:67], v7 offset:4608
    v_mfma_f32_16x16x32_bf16 a[32:35], v[40:43], v[16:19], a[32:35]
    ds_read_b64_tr_b16 v[68:69], v7 offset:8192
    v_mfma_f32_16x16x32_bf16 a[36:39], v[40:43], v[20:23], a[36:39]
    ds_read_b64_tr_b16 v[70:71], v7 offset:8704
    v_mfma_f32_16x16x32_bf16 a[40:43], v[40:43], v[24:27], a[40:43]
    s_sub_u32 s49, s47, 18
    s_cmp_lt_u32 s47, 18
    s_cselect_b32 s49, s47, s49
    s_cselect_b32 s8, s34, s36
    s_cselect_b32 s9, s35, s37
    s_cselect_b32 s10, s44, s45
    s_mul_i32 s17, s49, 36864
    s_add_u32 s17, s17, s48
    s_add_u32 s47, s47, 1
    v_mfma_f32_16x16x32_bf16 a[44:47], v[40:43], v[28:31], a[44:47]
    s_add_u32 m0, s24, 49152
    s_add_u32 s19, s17, s20
    buffer_load_dwordx4 v3, s[8:11], s19 offen lds
    s_add_u32 m0, s25, 49152
    s_add_u32 s19, s17, s21
    buffer_load_dwordx4 v3, s[8:11], s19 offen lds
    s_add_u32 s17, s17, s18
    s_waitcnt vmcnt(6) lgkmcnt(0)
    s_barrier
    v_mfma_f32_16x16x32_bf16 a[0:3], v[60:63], v[44:47], a[0:3]
    ds_read_b128 v[16:19], v4 offset:0
    v_mfma_f32_16x16x32_bf16 a[4:7], v[60:63], v[48:51], a[4:7]
    ds_read_b128 v[20:23], v4 offset:2048
    v_mfma_f32_16x16x32_bf16 a[8:11], v[60:63], v[52:55], a[8:11]
    ds_read_b128 v[24:27], v4 offset:4096
    v_mfma_f32_16x16x32_bf16 a[12:15], v[60:63], v[56:59], a[12:15]
    ds_read_b128 v[28:31], v4 offset:6144
    ds_read_b64_tr_b16 v[32:33], v8 offset:0
    v_mfma_f32_16x16x32_bf16 a[16:19], v[64:67], v[44:47], a[16:19]
    ds_read_b64_tr_b16 v[34:35], v8 offset:512
    v_mfma_f32_16x16x32_bf16 a[20:23], v[64:67], v[48:51], a[20:23]
    ds_read_b64_tr_b16 v[36:37], v8 offset:4096
    v_mfma_f32_16x16x32_bf16 a[24:27], v[64:67], v[52:55], a[24:27]
    ds_read_b64_tr_b16 v[38:39], v8 offset:4608
    v_mfma_f32_16x16x32_bf16 a[28:31], v[64:67], v[56:59], a[28:31]
    ds_read_b64_tr_b16 v[40:41], v8 offset:8192
    ds_read_b64_tr_b16 v[42:43], v8 offset:8704
    v_mfma_f32_16x16x32_bf16 a[32:35], v[68:71], v[44:47], a[32:35]
    s_sub_u32 s49, s47, 18
    s_cmp_lt_u32 s47, 18
    s_cselect_b32 s49, s47, s49
    s_cselect_b32 s8, s34, s36
    s_cselect_b32 s9, s35, s37
    s_cselect_b32 s10, s44, s45
    s_mul_i32 s17, s49, 36864
    s_add_u32 s17, s17, s48
    s_add_u32 s47, s47, 1
    v_mfma_f32_16x16x32_bf16 a[36:39], v[68:71], v[48:51], a[36:39]
    s_add_u32 m0, s24, 61440
    s_add_u32 s19, s17, s20
    buffer_load_dwordx4 v3, s[8:11], s19 offen lds
    v_mfma_f32_16x16x32_bf16 a[40:43], v[68:71], v[52:55], a[40:43]
    s_add_u32 m0, s25, 61440
    s_add_u32 s19, s17, s21
    buffer_load_dwordx4 v3, s[8:11], s19 offen lds
    s_add_u32 s17, s17, s18
    v_mfma_f32_16x16x32_bf16 a[44:47], v[68:71], v[56:59], a[44:47]
    s_add_u32 m0, s28, 32768
    s_add_u32 s19, s16, 1408
    buffer_load_dwordx4 v2, s[4:7], s19 offen lds
    s_add_u32 m0, s28, 40960
    s_add_u32 s19, s16, 1408
    s_add_u32 s19, s19, s29
    buffer_load_dwordx4 v2, s[4:7], s19 offen lds
    s_waitcnt vmcnt(8) lgkmcnt(0)
    s_barrier
    v_mfma_f32_16x16x32_bf16 a[0:3], v[32:35], v[16:19], a[0:3]
    ds_read_b128 v[44:47], v5 offset:0
    v_mfma_f32_16x16x32_bf16 a[4:7], v[32:35], v[20:23], a[4:7]
    ds_read_b128 v[48:51], v5 offset:2048
    v_mfma_f32_16x16x32_bf16 a[8:11], v[32:35], v[24:27], a[8:11]
    ds_read_b128 v[52:55], v5 offset:4096
    v_mfma_f32_16x16x32_bf16 a[12:15], v[32:35], v[28:31], a[12:15]
    ds_read_b128 v[56:59], v5 offset:6144
    v_mfma_f32_16x16x32_bf16 a[16:19], v[36:39], v[16:19], a[16:19]
    ds_read_b64_tr_b16 v[60:61], v9 offset:0
    v_mfma_f32_16x16x32_bf16 a[20:23], v[36:39], v[20:23], a[20:23]
    ds_read_b64_tr_b16 v[62:63], v9 offset:512
    v_mfma_f32_16x16x32_bf16 a[24:27], v[36:39], v[24:27], a[24:27]
    ds_read_b64_tr_b16 v[64:65], v9 offset:4096
    v_mfma_f32_16x16x32_bf16 a[28:31], v[36:39], v[28:31], a[28:31]
    ds_read_b64_tr_b16 v[66:67], v9 offset:4608
    v_mfma_f32_16x16x32_bf16 a[32:35], v[40:43], v[16:19], a[32:35]
    ds_read_b64_tr_b16 v[68:69], v9 offset:8192
    v_mfma_f32_16x16x32_bf16 a[36:39], v[40:43], v[20:23], a[36:39]
    ds_read_b64_tr_b16 v[70:71], v9 offset:8704
    v_mfma_f32_16x16x32_bf16 a[40:43], v[40:43], v[24:27], a[40:43]
    s_sub_u32 s49, s47, 18
    s_cmp_lt_u32 s47, 18
    s_cselect_b32 s49, s47, s49
    s_cselect_b32 s8, s34, s36
    s_cselect_b32 s9, s35, s37
    s_cselect_b32 s10, s44, s45
    s_mul_i32 s17, s49, 36864
    s_add_u32 s17, s17, s48
    s_add_u32 s47, s47, 1
    v_mfma_f32_16x16x32_bf16 a[44:47], v[40:43], v[28:31], a[44:47]
    s_add_u32 m0, s24, 73728
    s_add_u32 s19, s17, s20
    buffer_load_dwordx4 v3, s[8:11], s19 offen lds
    s_add_u32 m0, s25, 73728
    s_add_u32 s19, s17, s21
    buffer_load_dwordx4 v3, s[8:11], s19 offen lds
    s_add_u32 s17, s17, s18
    s_waitcnt vmcnt(6) lgkmcnt(0)
    s_barrier
    v_mfma_f32_16x16x32_bf16 a[0:3], v[60:63], v[44:47], a[0:3]
    ds_read_b128 v[16:19], v4 offset:16384
    v_mfma_f32_16x16x32_bf16 a[4:7], v[60:63], v[48:51], a[4:7]
    ds_read_b128 v[20:23], v4 offset:18432
    v_mfma_f32_16x16x32_bf16 a[8:11], v[60:63], v[52:55], a[8:11]
    ds_read_b128 v[24:27], v4 offset:20480
    v_mfma_f32_16x16x32_bf16 a[12:15], v[60:63], v[56:59], a[12:15]
    ds_read_b128 v[28:31], v4 offset:22528
    ds_read_b64_tr_b16 v[32:33], v6 offset:0
    v_mfma_f32_16x16x32_bf16 a[16:19], v[64:67], v[44:47], a[16:19]
    ds_read_b64_tr_b16 v[34:35], v6 offset:512
    v_mfma_f32_16x16x32_bf16 a[20:23], v[64:67], v[48:51], a[20:23]
    ds_read_b64_tr_b16 v[36:37], v6 offset:4096
    v_mfma_f32_16x16x32_bf16 a[24:27], v[64:67], v[52:55], a[24:27]
    ds_read_b64_tr_b16 v[38:39], v6 offset:4608
    v_mfma_f32_16x16x32_bf16 a[28:31], v[64:67], v[56:59], a[28:31]
    ds_read_b64_tr_b16 v[40:41], v6 offset:8192
    ds_read_b64_tr_b16 v[42:43], v6 offset:8704
    v_mfma_f32_16x16x32_bf16 a[32:35], v[68:71], v[44:47], a[32:35]
    s_sub_u32 s49, s47, 18
    s_cmp_lt_u32 s47, 18
    s_cselect_b32 s49, s47, s49
    s_cselect_b32 s8, s34, s36
    s_cselect_b32 s9, s35, s37
    s_cselect_b32 s10, s44, s45
    s_mul_i32 s17, s49, 36864
    s_add_u32 s17, s17, s48
    s_add_u32 s47, s47, 1
    v_mfma_f32_16x16x32_bf16 a[36:39], v[68:71], v[48:51], a[36:39]
    s_add_u32 m0, s24, 86016
    s_add_u32 s19, s17, s20
    buffer_load_dwordx4 v3, s[8:11], s19 offen lds
    v_mfma_f32_16x16x32_bf16 a[40:43], v[68:71], v[52:55], a[40:43]
    s_add_u32 m0, s25, 86016
    s_add_u32 s19, s17, s21
    buffer_load_dwordx4 v3, s[8:11], s19 offen lds
    s_add_u32 s17, s17, s18
    v_mfma_f32_16x16x32_bf16 a[44:47], v[68:71], v[56:59], a[44:47]
    s_add_u32 m0, s28, 0
    s_add_u32 s19, s16, 1536
    buffer_load_dwordx4 v2, s[4:7], s19 offen lds
    s_add_u32 m0, s28, 8192
    s_add_u32 s19, s16, 1536
    s_add_u32 s19, s19, s29
    buffer_load_dwordx4 v2, s[4:7], s19 offen lds
    s_waitcnt vmcnt(8) lgkmcnt(0)
    s_barrier
    v_mfma_f32_16x16x32_bf16 a[0:3], v[32:35], v[16:19], a[0:3]
    ds_read_b128 v[44:47], v5 offset:16384
    v_mfma_f32_16x16x32_bf16 a[4:7], v[32:35], v[20:23], a[4:7]
    ds_read_b128 v[48:51], v5 offset:18432
    v_mfma_f32_16x16x32_bf16 a[8:11], v[32:35], v[24:27], a[8:11]
    ds_read_b128 v[52:55], v5 offset:20480
    v_mfma_f32_16x16x32_bf16 a[12:15], v[32:35], v[28:31], a[12:15]
    ds_read_b128 v[56:59], v5 offset:22528
    v_mfma_f32_16x16x32_bf16 a[16:19], v[36:39], v[16:19], a[16:19]
    ds_read_b64_tr_b16 v[60:61], v7 offset:0
    v_mfma_f32_16x16x32_bf16 a[20:23], v[36:39], v[20:23], a[20:23]
    ds_read_b64_tr_b16 v[62:63], v7 offset:512
    v_mfma_f32_16x16x32_bf16 a[24:27], v[36:39], v[24:27], a[24:27]
    ds_read_b64_tr_b16 v[64:65], v7 offset:4096
    v_mfma_f32_16x16x32_bf16 a[28:31], v[36:39], v[28:31], a[28:31]
    ds_read_b64_tr_b16 v[66:67], v7 offset:4608
    v_mfma_f32_16x16x32_bf16 a[32:35], v[40:43], v[16:19], a[32:35]
    ds_read_b64_tr_b16 v[68:69], v7 offset:8192
    v_mfma_f32_16x16x32_bf16 a[36:39], v[40:43], v[20:23], a[36:39]
    ds_read_b64_tr_b16 v[70:71], v7 offset:8704
    v_mfma_f32_16x16x32_bf16 a[40:43], v[40:43], v[24:27], a[40:43]
    s_sub_u32 s49, s47, 18
    s_cmp_lt_u32 s47, 18
    s_cselect_b32 s49, s47, s49
    s_cselect_b32 s8, s34, s36
    s_cselect_b32 s9, s35, s37
    s_cselect_b32 s10, s44, s45
    s_mul_i32 s17, s49, 36864
    s_add_u32 s17, s17, s48
    s_add_u32 s47, s47, 1
    v_mfma_f32_16x16x32_bf16 a[44:47], v[40:43], v[28:31], a[44:47]
    s_add_u32 m0, s24, 49152
    s_add_u32 s19, s17, s20
    buffer_load_dwordx4 v3, s[8:11], s19 offen lds
    s_add_u32 m0, s25, 49152
    s_add_u32 s19, s17, s21
    buffer_load_dwordx4 v3, s[8:11], s19 offen lds
    s_add_u32 s17, s17, s18
    s_waitcnt vmcnt(6) lgkmcnt(0)
    s_barrier
    v_mfma_f32_16x16x32_bf16 a[0:3], v[60:63], v[44:47], a[0:3]
    ds_read_b128 v[16:19], v4 offset:32768
    v_mfma_f32_16x16x32_bf16 a[4:7], v[60:63], v[48:51], a[4:7]
    ds_read_b128 v[20:23], v4 offset:34816
    v_mfma_f32_16x16x32_bf16 a[8:11], v[60:63], v[52:55], a[8:11]
    ds_read_b128 v[24:27], v4 offset:36864
    v_mfma_f32_16x16x32_bf16 a[12:15], v[60:63], v[56:59], a[12:15]
    ds_read_b128 v[28:31], v4 offset:38912
    ds_read_b64_tr_b16 v[32:33], v8 offset:0
    v_mfma_f32_16x16x32_bf16 a[16:19], v[64:67], v[44:47], a[16:19]
    ds_read_b64_tr_b16 v[34:35], v8 offset:512
    v_mfma_f32_16x16x32_bf16 a[20:23], v[64:67], v[48:51], a[20:23]
    ds_read_b64_tr_b16 v[36:37], v8 offset:4096
    v_mfma_f32_16x16x32_bf16 a[24:27], v[64:67], v[52:55], a[24:27]
    ds_read_b64_tr_b16 v[38:39], v8 offset:4608
    v_mfma_f32_16x16x32_bf16 a[28:31], v[64:67], v[56:59], a[28:31]
    ds_read_b64_tr_b16 v[40:41], v8 offset:8192
    ds_read_b64_tr_b16 v[42:43], v8 offset:8704
    v_mfma_f32_16x16x32_bf16 a[32:35], v[68:71], v[44:47], a[32:35]
    s_sub_u32 s49, s47, 18
    s_cmp_lt_u32 s47, 18
    s_cselect_b32 s49, s47, s49
    s_cselect_b32 s8, s34, s36
    s_cselect_b32 s9, s35, s37
    s_cselect_b32 s10, s44, s45
    s_mul_i32 s17, s49, 36864
    s_add_u32 s17, s17, s48
    s_add_u32 s47, s47, 1
    v_mfma_f32_16x16x32_bf16 a[36:39], v[68:71], v[48:51], a[36:39]
    s_add_u32 m0, s24, 61440
    s_add_u32 s19, s17, s20
    buffer_load_dwordx4 v3, s[8:11], s19 offen lds
    v_mfma_f32_16x16x32_bf16 a[40:43], v[68:71], v[52:55], a[40:43]
    s_add_u32 m0, s25, 61440
    s_add_u32 s19, s17, s21
    buffer_load_dwordx4 v3, s[8:11], s19 offen lds
    s_add_u32 s17, s17, s18
    v_mfma_f32_16x16x32_bf16 a[44:47], v[68:71], v[56:59], a[44:47]
    s_add_u32 m0, s28, 16384
    s_add_u32 s19, s16, 1664
    buffer_load_dwordx4 v2, s[4:7], s19 offen lds
    s_add_u32 m0, s28, 24576
    s_add_u32 s19, s16, 1664
    s_add_u32 s19, s19, s29
    buffer_load_dwordx4 v2, s[4:7], s19 offen lds
    s_waitcnt vmcnt(8) lgkmcnt(0)
    s_barrier
    v_mfma_f32_16x16x32_bf16 a[0:3], v[32:35], v[16:19], a[0:3]
    ds_read_b128 v[44:47], v5 offset:32768
    v_mfma_f32_16x16x32_bf16 a[4:7], v[32:35], v[20:23], a[4:7]
    ds_read_b128 v[48:51], v5 offset:34816
    v_mfma_f32_16x16x32_bf16 a[8:11], v[32:35], v[24:27], a[8:11]
    ds_read_b128 v[52:55], v5 offset:36864
    v_mfma_f32_16x16x32_bf16 a[12:15], v[32:35], v[28:31], a[12:15]
    ds_read_b128 v[56:59], v5 offset:38912
    v_mfma_f32_16x16x32_bf16 a[16:19], v[36:39], v[16:19], a[16:19]
    ds_read_b64_tr_b16 v[60:61], v9 offset:0
    v_mfma_f32_16x16x32_bf16 a[20:23], v[36:39], v[20:23], a[20:23]
    ds_read_b64_tr_b16 v[62:63], v9 offset:512
    v_mfma_f32_16x16x32_bf16 a[24:27], v[36:39], v[24:27], a[24:27]
    ds_read_b64_tr_b16 v[64:65], v9 offset:4096
    v_mfma_f32_16x16x32_bf16 a[28:31], v[36:39], v[28:31], a[28:31]
    ds_read_b64_tr_b16 v[66:67], v9 offset:4608
    v_mfma_f32_16x16x32_bf16 a[32:35], v[40:43], v[16:19], a[32:35]
    ds_read_b64_tr_b16 v[68:69], v9 offset:8192
    v_mfma_f32_16x16x32_bf16 a[36:39], v[40:43], v[20:23], a[36:39]
    ds_read_b64_tr_b16 v[70:71], v9 offset:8704
    v_mfma_f32_16x16x32_bf16 a[40:43], v[40:43], v[24:27], a[40:43]
    s_sub_u32 s49, s47, 18
    s_cmp_lt_u32 s47, 18
    s_cselect_b32 s49, s47, s49
    s_cselect_b32 s8, s34, s36
    s_cselect_b32 s9, s35, s37
    s_cselect_b32 s10, s44, s45
    s_mul_i32 s17, s49, 36864
    s_add_u32 s17, s17, s48
    s_add_u32 s47, s47, 1
    v_mfma_f32_16x16x32_bf16 a[44:47], v[40:43], v[28:31], a[44:47]
    s_add_u32 m0, s24, 73728
    s_add_u32 s19, s17, s20
    buffer_load_dwordx4 v3, s[8:11], s19 offen lds
    s_add_u32 m0, s25, 73728
    s_add_u32 s19, s17, s21
    buffer_load_dwordx4 v3, s[8:11], s19 offen lds
    s_add_u32 s17, s17, s18
    s_waitcnt vmcnt(6) lgkmcnt(0)
    s_barrier
    v_mfma_f32_16x16x32_bf16 a[0:3], v[60:63], v[44:47], a[0:3]
    ds_read_b128 v[16:19], v4 offset:0
    v_mfma_f32_16x16x32_bf16 a[4:7], v[60:63], v[48:51], a[4:7]
    ds_read_b128 v[20:23], v4 offset:2048
    v_mfma_f32_16x16x32_bf16 a[8:11], v[60:63], v[52:55], a[8:11]
    ds_read_b128 v[24:27], v4 offset:4096
    v_mfma_f32_16x16x32_bf16 a[12:15], v[60:63], v[56:59], a[12:15]
    ds_read_b128 v[28:31], v4 offset:6144
    ds_read_b64_tr_b16 v[32:33], v6 offset:0
    v_mfma_f32_16x16x32_bf16 a[16:19], v[64:67], v[44:47], a[16:19]
    ds_read_b64_tr_b16 v[34:35], v6 offset:512
    v_mfma_f32_16x16x32_bf16 a[20:23], v[64:67], v[48:51], a[20:23]
    ds_read_b64_tr_b16 v[36:37], v6 offset:4096
    v_mfma_f32_16x16x32_bf16 a[24:27], v[64:67], v[52:55], a[24:27]
    ds_read_b64_tr_b16 v[38:39], v6 offset:4608
    v_mfma_f32_16x16x32_bf16 a[28:31], v[64:67], v[56:59], a[28:31]
    ds_read_b64_tr_b16 v[40:41], v6 offset:8192
    ds_read_b64_tr_b16 v[42:43], v6 offset:8704
    v_mfma_f32_16x16x32_bf16 a[32:35], v[68:71], v[44:47], a[32:35]
    s_sub_u32 s49, s47, 18
    s_cmp_lt_u32 s47, 18
    s_cselect_b32 s49, s47, s49
    s_cselect_b32 s8, s34, s36
    s_cselect_b32 s9, s35, s37
    s_cselect_b32 s10, s44, s45
    s_mul_i32 s17, s49, 36864
    s_add_u32 s17, s17, s48
    s_add_u32 s47, s47, 1
    v_mfma_f32_16x16x32_bf16 a[36:39], v[68:71], v[48:51], a[36:39]
    s_add_u32 m0, s24, 86016
    s_add_u32 s19, s17, s20
    buffer_load_dwordx4 v3, s[8:11], s19 offen lds
    v_mfma_f32_16x16x32_bf16 a[40:43], v[68:71], v[52:55], a[40:43]
    s_add_u32 m0, s25, 86016
    s_add_u32 s19, s17, s21
    buffer_load_dwordx4 v3, s[8:11], s19 offen lds
    s_add_u32 s17, s17, s18
    v_mfma_f32_16x16x32_bf16 a[44:47], v[68:71], v[56:59], a[44:47]
    s_add_u32 m0, s28, 32768
    s_add_u32 s19, s16, 1792
    buffer_load_dwordx4 v2, s[4:7], s19 offen lds
    s_add_u32 m0, s28, 40960
    s_add_u32 s19, s16, 1792
    s_add_u32 s19, s19, s29
    buffer_load_dwordx4 v2, s[4:7], s19 offen lds
    s_waitcnt vmcnt(8) lgkmcnt(0)
    s_barrier
    v_mfma_f32_16x16x32_bf16 a[0:3], v[32:35], v[16:19], a[0:3]
    ds_read_b128 v[44:47], v5 offset:0
    v_mfma_f32_16x16x32_bf16 a[4:7], v[32:35], v[20:23], a[4:7]
    ds_read_b128 v[48:51], v5 offset:2048
    v_mfma_f32_16x16x32_bf16 a[8:11], v[32:35], v[24:27], a[8:11]
    ds_read_b128 v[52:55], v5 offset:4096
    v_mfma_f32_16x16x32_bf16 a[12:15], v[32:35], v[28:31], a[12:15]
    ds_read_b128 v[56:59], v5 offset:6144
    v_mfma_f32_16x16x32_bf16 a[16:19], v[36:39], v[16:19], a[16:19]
    ds_read_b64_tr_b16 v[60:61], v7 offset:0
    v_mfma_f32_16x16x32_bf16 a[20:23], v[36:39], v[20:23], a[20:23]
    ds_read_b64_tr_b16 v[62:63], v7 offset:512
    v_mfma_f32_16x16x32_bf16 a[24:27], v[36:39], v[24:27], a[24:27]
    ds_read_b64_tr_b16 v[64:65], v7 offset:4096
    v_mfma_f32_16x16x32_bf16 a[28:31], v[36:39], v[28:31], a[28:31]
    ds_read_b64_tr_b16 v[66:67], v7 offset:4608
    v_mfma_f32_16x16x32_bf16 a[32:35], v[40:43], v[16:19], a[32:35]
    ds_read_b64_tr_b16 v[68:69], v7 offset:8192
    v_mfma_f32_16x16x32_bf16 a[36:39], v[40:43], v[20:23], a[36:39]
    ds_read_b64_tr_b16 v[70:71], v7 offset:8704
    v_mfma_f32_16x16x32_bf16 a[40:43], v[40:43], v[24:27], a[40:43]
    s_sub_u32 s49, s47, 18
    s_cmp_lt_u32 s47, 18
    s_cselect_b32 s49, s47, s49
    s_cselect_b32 s8, s34, s36
    s_cselect_b32 s9, s35, s37
    s_cselect_b32 s10, s44, s45
    s_mul_i32 s17, s49, 36864
    s_add_u32 s17, s17, s48
    s_add_u32 s47, s47, 1
    v_mfma_f32_16x16x32_bf16 a[44:47], v[40:43], v[28:31], a[44:47]
    s_add_u32 m0, s24, 49152
    s_add_u32 s19, s17, s20
    buffer_load_dwordx4 v3, s[8:11], s19 offen lds
    s_add_u32 m0, s25, 49152
    s_add_u32 s19, s17, s21
    buffer_load_dwordx4 v3, s[8:11], s19 offen lds
    s_add_u32 s17, s17, s18
    s_waitcnt vmcnt(6) lgkmcnt(0)
    s_barrier
    v_mfma_f32_16x16x32_bf16 a[0:3], v[60:63], v[44:47], a[0:3]
    ds_read_b128 v[16:19], v4 offset:16384
    v_mfma_f32_16x16x32_bf16 a[4:7], v[60:63], v[48:51], a[4:7]
    ds_read_b128 v[20:23], v4 offset:18432
    v_mfma_f32_16x16x32_bf16 a[8:11], v[60:63], v[52:55], a[8:11]
    ds_read_b128 v[24:27], v4 offset:20480
    v_mfma_f32_16x16x32_bf16 a[12:15], v[60:63], v[56:59], a[12:15]
    ds_read_b128 v[28:31], v4 offset:22528
    ds_read_b64_tr_b16 v[32:33], v8 offset:0
    v_mfma_f32_16x16x32_bf16 a[16:19], v[64:67], v[44:47], a[16:19]
    ds_read_b64_tr_b16 v[34:35], v8 offset:512
    v_mfma_f32_16x16x32_bf16 a[20:23], v[64:67], v[48:51], a[20:23]
    ds_read_b64_tr_b16 v[36:37], v8 offset:4096
    v_mfma_f32_16x16x32_bf16 a[24:27], v[64:67], v[52:55], a[24:27]
    ds_read_b64_tr_b16 v[38:39], v8 offset:4608
    v_mfma_f32_16x16x32_bf16 a[28:31], v[64:67], v[56:59], a[28:31]
    ds_read_b64_tr_b16 v[40:41], v8 offset:8192
    ds_read_b64_tr_b16 v[42:43], v8 offset:8704
    v_mfma_f32_16x16x32_bf16 a[32:35], v[68:71], v[44:47], a[32:35]
    s_sub_u32 s49, s47, 18
    s_cmp_lt_u32 s47, 18
    s_cselect_b32 s49, s47, s49
    s_cselect_b32 s8, s34, s36
    s_cselect_b32 s9, s35, s37
    s_cselect_b32 s10, s44, s45
    s_mul_i32 s17, s49, 36864
    s_add_u32 s17, s17, s48
    s_add_u32 s47, s47, 1
    v_mfma_f32_16x16x32_bf16 a[36:39], v[68:71], v[48:51], a[36:39]
    s_add_u32 m0, s24, 61440
    s_add_u32 s19, s17, s20
    buffer_load_dwordx4 v3, s[8:11], s19 offen lds
    v_mfma_f32_16x16x32_bf16 a[40:43], v[68:71], v[52:55], a[40:43]
    s_add_u32 m0, s25, 61440
    s_add_u32 s19, s17, s21
    buffer_load_dwordx4 v3, s[8:11], s19 offen lds
    s_add_u32 s17, s17, s18
    v_mfma_f32_16x16x32_bf16 a[44:47], v[68:71], v[56:59], a[44:47]
    s_add_u32 m0, s28, 0
    s_add_u32 s19, s16, 1920
    buffer_load_dwordx4 v2, s[4:7], s19 offen lds
    s_add_u32 m0, s28, 8192
    s_add_u32 s19, s16, 1920
    s_add_u32 s19, s19, s29
    buffer_load_dwordx4 v2, s[4:7], s19 offen lds
    s_waitcnt vmcnt(8) lgkmcnt(0)
    s_barrier
    v_mfma_f32_16x16x32_bf16 a[0:3], v[32:35], v[16:19], a[0:3]
    ds_read_b128 v[44:47], v5 offset:16384
    v_mfma_f32_16x16x32_bf16 a[4:7], v[32:35], v[20:23], a[4:7]
    ds_read_b128 v[48:51], v5 offset:18432
    v_mfma_f32_16x16x32_bf16 a[8:11], v[32:35], v[24:27], a[8:11]
    ds_read_b128 v[52:55], v5 offset:20480
    v_mfma_f32_16x16x32_bf16 a[12:15], v[32:35], v[28:31], a[12:15]
    ds_read_b128 v[56:59], v5 offset:22528
    v_mfma_f32_16x16x32_bf16 a[16:19], v[36:39], v[16:19], a[16:19]
    ds_read_b64_tr_b16 v[60:61], v9 offset:0
    v_mfma_f32_16x16x32_bf16 a[20:23], v[36:39], v[20:23], a[20:23]
    ds_read_b64_tr_b16 v[62:63], v9 offset:512
    v_mfma_f32_16x16x32_bf16 a[24:27], v[36:39], v[24:27], a[24:27]
    ds_read_b64_tr_b16 v[64:65], v9 offset:4096
    v_mfma_f32_16x16x32_bf16 a[28:31], v[36:39], v[28:31], a[28:31]
    ds_read_b64_tr_b16 v[66:67], v9 offset:4608
    v_mfma_f32_16x16x32_bf16 a[32:35], v[40:43], v[16:19], a[32:35]
    ds_read_b64_tr_b16 v[68:69], v9 offset:8192
    v_mfma_f32_16x16x32_bf16 a[36:39], v[40:43], v[20:23], a[36:39]
    ds_read_b64_tr_b16 v[70:71], v9 offset:8704
    v_mfma_f32_16x16x32_bf16 a[40:43], v[40:43], v[24:27], a[40:43]
    s_sub_u32 s49, s47, 18
    s_cmp_lt_u32 s47, 18
    s_cselect_b32 s49, s47, s49
    s_cselect_b32 s8, s34, s36
    s_cselect_b32 s9, s35, s37
    s_cselect_b32 s10, s44, s45
    s_mul_i32 s17, s49, 36864
    s_add_u32 s17, s17, s48
    s_add_u32 s47, s47, 1
    v_mfma_f32_16x16x32_bf16 a[44:47], v[40:43], v[28:31], a[44:47]
    s_add_u32 m0, s24, 73728
    s_add_u32 s19, s17, s20
    buffer_load_dwordx4 v3, s[8:11], s19 offen lds
    s_add_u32 m0, s25, 73728
    s_add_u32 s19, s17, s21
    buffer_load_dwordx4 v3, s[8:11], s19 offen lds
    s_add_u32 s17, s17, s18
    s_waitcnt vmcnt(6) lgkmcnt(0)
    s_barrier
    v_mfma_f32_16x16x32_bf16 a[0:3], v[60:63], v[44:47], a[0:3]
    ds_read_b128 v[16:19], v4 offset:32768
    v_mfma_f32_16x16x32_bf16 a[4:7], v[60:63], v[48:51], a[4:7]
    ds_read_b128 v[20:23], v4 offset:34816
    v_mfma_f32_16x16x32_bf16 a[8:11], v[60:63], v[52:55], a[8:11]
    ds_read_b128 v[24:27], v4 offset:36864
    v_mfma_f32_16x16x32_bf16 a[12:15], v[60:63], v[56:59], a[12:15]
    ds_read_b128 v[28:31], v4 offset:38912
    ds_read_b64_tr_b16 v[32:33], v6 offset:0
    v_mfma_f32_16x16x32_bf16 a[16:19], v[64:67], v[44:47], a[16:19]
    ds_read_b64_tr_b16 v[34:35], v6 offset:512
    v_mfma_f32_16x16x32_bf16 a[20:23], v[64:67], v[48:51], a[20:23]
    ds_read_b64_tr_b16 v[36:37], v6 offset:4096
    v_mfma_f32_16x16x32_bf16 a[24:27], v[64:67], v[52:55], a[24:27]
    ds_read_b64_tr_b16 v[38:39], v6 offset:4608
    v_mfma_f32_16x16x32_bf16 a[28:31], v[64:67], v[56:59], a[28:31]
    ds_read_b64_tr_b16 v[40:41], v6 offset:8192
    ds_read_b64_tr_b16 v[42:43], v6 offset:8704
    v_mfma_f32_16x16x32_bf16 a[32:35], v[68:71], v[44:47], a[32:35]
    s_sub_u32 s49, s47, 18
    s_cmp_lt_u32 s47, 18
    s_cselect_b32 s49, s47, s49
    s_cselect_b32 s8, s34, s36
    s_cselect_b32 s9, s35, s37
    s_cselect_b32 s10, s44, s45
    s_mul_i32 s17, s49, 36864
    s_add_u32 s17, s17, s48
    s_add_u32 s47, s47, 1
    v_mfma_f32_16x16x32_bf16 a[36:39], v[68:71], v[48:51], a[36:39]
    s_add_u32 m0, s24, 86016
    s_add_u32 s19, s17, s20
    buffer_load_dwordx4 v3, s[8:11], s19 offen lds
    v_mfma_f32_16x16x32_bf16 a[40:43], v[68:71], v[52:55], a[40:43]
    s_add_u32 m0, s25, 86016
    s_add_u32 s19, s17, s21
    buffer_load_dwordx4 v3, s[8:11], s19 offen lds
    s_add_u32 s17, s17, s18
    v_mfma_f32_16x16x32_bf16 a[44:47], v[68:71], v[56:59], a[44:47]
    s_add_u32 m0, s28, 16384
    s_add_u32 s19, s16, 2048
    buffer_load_dwordx4 v2, s[4:7], s19 offen lds
    s_add_u32 m0, s28, 24576
    s_add_u32 s19, s16, 2048
    s_add_u32 s19, s19, s29
    buffer_load_dwordx4 v2, s[4:7], s19 offen lds
    s_waitcnt vmcnt(8) lgkmcnt(0)
    s_barrier
    v_mfma_f32_16x16x32_bf16 a[0:3], v[32:35], v[16:19], a[0:3]
    ds_read_b128 v[44:47], v5 offset:32768
    v_mfma_f32_16x16x32_bf16 a[4:7], v[32:35], v[20:23], a[4:7]
    ds_read_b128 v[48:51], v5 offset:34816
    v_mfma_f32_16x16x32_bf16 a[8:11], v[32:35], v[24:27], a[8:11]
    ds_read_b128 v[52:55], v5 offset:36864
    v_mfma_f32_16x16x32_bf16 a[12:15], v[32:35], v[28:31], a[12:15]
    ds_read_b128 v[56:59], v5 offset:38912
    v_mfma_f32_16x16x32_bf16 a[16:19], v[36:39], v[16:19], a[16:19]
    ds_read_b64_tr_b16 v[60:61], v7 offset:0
    v_mfma_f32_16x16x32_bf16 a[20:23], v[36:39], v[20:23], a[20:23]
    ds_read_b64_tr_b16 v[62:63], v7 offset:512
    v_mfma_f32_16x16x32_bf16 a[24:27], v[36:39], v[24:27], a[24:27]
    ds_read_b64_tr_b16 v[64:65], v7 offset:4096
    v_mfma_f32_16x16x32_bf16 a[28:31], v[36:39], v[28:31], a[28:31]
    ds_read_b64_tr_b16 v[66:67], v7 offset:4608
    v_mfma_f32_16x16x32_bf16 a[32:35], v[40:43], v[16:19], a[32:35]
    ds_read_b64_tr_b16 v[68:69], v7 offset:8192
    v_mfma_f32_16x16x32_bf16 a[36:39], v[40:43], v[20:23], a[36:39]
    ds_read_b64_tr_b16 v[70:71], v7 offset:8704
    v_mfma_f32_16x16x32_bf16 a[40:43], v[40:43], v[24:27], a[40:43]
    s_sub_u32 s49, s47, 18
    s_cmp_lt_u32 s47, 18
    s_cselect_b32 s49, s47, s49
    s_cselect_b32 s8, s34, s36
    s_cselect_b32 s9, s35, s37
    s_cselect_b32 s10, s44, s45
    s_mul_i32 s17, s49, 36864
    s_add_u32 s17, s17, s48
    s_add_u32 s47, s47, 1
    v_mfma_f32_16x16x32_bf16 a[44:47], v[40:43], v[28:31], a[44:47]
    s_add_u32 m0, s24, 49152
    s_add_u32 s19, s17, s20
    buffer_load_dwordx4 v3, s[8:11], s19 offen lds
    s_add_u32 m0, s25, 49152
    s_add_u32 s19, s17, s21
    buffer_load_dwordx4 v3, s[8:11], s19 offen lds
    s_add_u32 s17, s17, s18
    s_waitcnt vmcnt(6) lgkmcnt(0)
    s_barrier
    v_mfma_f32_16x16x32_bf16 a[0:3], v[60:63], v[44:47], a[0:3]
    ds_read_b128 v[16:19], v4 offset:0
    v_mfma_f32_16x16x32_bf16 a[4:7], v[60:63], v[48:51], a[4:7]
    ds_read_b128 v[20:23], v4 offset:2048
    v_mfma_f32_16x16x32_bf16 a[8:11], v[60:63], v[52:55], a[8:11]
    ds_read_b128 v[24:27], v4 offset:4096
    v_mfma_f32_16x16x32_bf16 a[12:15], v[60:63], v[56:59], a[12:15]
    ds_read_b128 v[28:31], v4 offset:6144
    v_mfma_f32_16x16x32_bf16 a[16:19], v[64:67], v[44:47], a[16:19]
    ds_read_b64_tr_b16 v[32:33], v8 offset:0
    v_mfma_f32_16x16x32_bf16 a[20:23], v[64:67], v[48:51], a[20:23]
    ds_read_b64_tr_b16 v[34:35], v8 offset:512
    v_mfma_f32_16x16x32_bf16 a[24:27], v[64:67], v[52:55], a[24:27]
    ds_read_b64_tr_b16 v[36:37], v8 offset:4096
    v_mfma_f32_16x16x32_bf16 a[28:31], v[64:67], v[56:59], a[28:31]
    ds_read_b64_tr_b16 v[38:39], v8 offset:4608
    v_mfma_f32_16x16x32_bf16 a[32:35], v[68:71], v[44:47], a[32:35]
    ds_read_b64_tr_b16 v[40:41], v8 offset:8192
    v_mfma_f32_16x16x32_bf16 a[36:39], v[68:71], v[48:51], a[36:39]
    ds_read_b64_tr_b16 v[42:43], v8 offset:8704
    v_mfma_f32_16x16x32_bf16 a[40:43], v[68:71], v[52:55], a[40:43]
    s_sub_u32 s49, s47, 18
    s_cmp_lt_u32 s47, 18
    s_cselect_b32 s49, s47, s49
    s_cselect_b32 s8, s34, s36
    s_cselect_b32 s9, s35, s37
    s_cselect_b32 s10, s44, s45
    s_mul_i32 s17, s49, 36864
    s_add_u32 s17, s17, s48
    s_add_u32 s47, s47, 1
    v_mfma_f32_16x16x32_bf16 a[44:47], v[68:71], v[56:59], a[44:47]
    s_add_u32 m0, s24, 61440
    s_add_u32 s19, s17, s20
    buffer_load_dwordx4 v3, s[8:11], s19 offen lds
    s_add_u32 m0, s25, 61440
    s_add_u32 s19, s17, s21
    buffer_load_dwordx4 v3, s[8:11], s19 offen lds
    s_add_u32 s17, s17, s18
    s_waitcnt vmcnt(6) lgkmcnt(0)
    s_barrier
    v_mfma_f32_16x16x32_bf16 a[0:3], v[32:35], v[16:19], a[0:3]
    v_mfma_f32_16x16x32_bf16 a[4:7], v[32:35], v[20:23], a[4:7]
    ds_read_b128 v[44:47], v5 offset:0
    v_mfma_f32_16x16x32_bf16 a[8:11], v[32:35], v[24:27], a[8:11]
    ds_read_b128 v[48:51], v5 offset:2048
    v_mfma_f32_16x16x32_bf16 a[12:15], v[32:35], v[28:31], a[12:15]
    ds_read_b128 v[52:55], v5 offset:4096
    v_mfma_f32_16x16x32_bf16 a[16:19], v[36:39], v[16:19], a[16:19]
    ds_read_b128 v[56:59], v5 offset:6144
    v_mfma_f32_16x16x32_bf16 a[20:23], v[36:39], v[20:23], a[20:23]
    ds_read_b64_tr_b16 v[60:61], v9 offset:0
    v_mfma_f32_16x16x32_bf16 a[24:27], v[36:39], v[24:27], a[24:27]
    v_mfma_f32_16x16x32_bf16 a[28:31], v[36:39], v[28:31], a[28:31]
    ds_read_b64_tr_b16 v[62:63], v9 offset:512
    v_mfma_f32_16x16x32_bf16 a[32:35], v[40:43], v[16:19], a[32:35]
    ds_read_b64_tr_b16 v[64:65], v9 offset:4096
    v_mfma_f32_16x16x32_bf16 a[36:39], v[40:43], v[20:23], a[36:39]
    ds_read_b64_tr_b16 v[66:67], v9 offset:4608
    v_mfma_f32_16x16x32_bf16 a[40:43], v[40:43], v[24:27], a[40:43]
    ds_read_b64_tr_b16 v[68:69], v9 offset:8192
    v_mfma_f32_16x16x32_bf16 a[44:47], v[40:43], v[28:31], a[44:47]
    ds_read_b64_tr_b16 v[70:71], v9 offset:8704
    s_waitcnt vmcnt(2) lgkmcnt(0)
    s_barrier
    v_mfma_f32_16x16x32_bf16 a[0:3], v[60:63], v[44:47], a[0:3]
    v_mfma_f32_16x16x32_bf16 a[4:7], v[60:63], v[48:51], a[4:7]
    ds_read_b128 v[16:19], v4 offset:16384
    v_mfma_f32_16x16x32_bf16 a[8:11], v[60:63], v[52:55], a[8:11]
    ds_read_b128 v[20:23], v4 offset:18432
    v_mfma_f32_16x16x32_bf16 a[12:15], v[60:63], v[56:59], a[12:15]
    ds_read_b128 v[24:27], v4 offset:20480
    v_mfma_f32_16x16x32_bf16 a[16:19], v[64:67], v[44:47], a[16:19]
    ds_read_b128 v[28:31], v4 offset:22528
    v_mfma_f32_16x16x32_bf16 a[20:23], v[64:67], v[48:51], a[20:23]
    ds_read_b64_tr_b16 v[32:33], v6 offset:0
    v_mfma_f32_16x16x32_bf16 a[24:27], v[64:67], v[52:55], a[24:27]
    v_mfma_f32_16x16x32_bf16 a[28:31], v[64:67], v[56:59], a[28:31]
    ds_read_b64_tr_b16 v[34:35], v6 offset:512
    v_mfma_f32_16x16x32_bf16 a[32:35], v[68:71], v[44:47], a[32:35]
    ds_read_b64_tr_b16 v[36:37], v6 offset:4096
    v_mfma_f32_16x16x32_bf16 a[36:39], v[68:71], v[48:51], a[36:39]
    ds_read_b64_tr_b16 v[38:39], v6 offset:4608
    v_mfma_f32_16x16x32_bf16 a[40:43], v[68:71], v[52:55], a[40:43]
    ds_read_b64_tr_b16 v[40:41], v6 offset:8192
    v_mfma_f32_16x16x32_bf16 a[44:47], v[68:71], v[56:59], a[44:47]
    ds_read_b64_tr_b16 v[42:43], v6 offset:8704
    s_waitcnt vmcnt(0) lgkmcnt(0)
    s_barrier
    v_mfma_f32_16x16x32_bf16 a[0:3], v[32:35], v[16:19], a[0:3]
    v_mfma_f32_16x16x32_bf16 a[4:7], v[32:35], v[20:23], a[4:7]
    ds_read_b128 v[44:47], v5 offset:16384
    v_mfma_f32_16x16x32_bf16 a[8:11], v[32:35], v[24:27], a[8:11]
    ds_read_b128 v[48:51], v5 offset:18432
    v_mfma_f32_16x16x32_bf16 a[12:15], v[32:35], v[28:31], a[12:15]
    ds_read_b128 v[52:55], v5 offset:20480
    v_mfma_f32_16x16x32_bf16 a[16:19], v[36:39], v[16:19], a[16:19]
    ds_read_b128 v[56:59], v5 offset:22528
    v_mfma_f32_16x16x32_bf16 a[20:23], v[36:39], v[20:23], a[20:23]
    ds_read_b64_tr_b16 v[60:61], v7 offset:0
    v_mfma_f32_16x16x32_bf16 a[24:27], v[36:39], v[24:27], a[24:27]
    v_mfma_f32_16x16x32_bf16 a[28:31], v[36:39], v[28:31], a[28:31]
    ds_read_b64_tr_b16 v[62:63], v7 offset:512
    v_mfma_f32_16x16x32_bf16 a[32:35], v[40:43], v[16:19], a[32:35]
    ds_read_b64_tr_b16 v[64:65], v7 offset:4096
    v_mfma_f32_16x16x32_bf16 a[36:39], v[40:43], v[20:23], a[36:39]
    ds_read_b64_tr_b16 v[66:67], v7 offset:4608
    v_mfma_f32_16x16x32_bf16 a[40:43], v[40:43], v[24:27], a[40:43]
    ds_read_b64_tr_b16 v[68:69], v7 offset:8192
    v_mfma_f32_16x16x32_bf16 a[44:47], v[40:43], v[28:31], a[44:47]
    ds_read_b64_tr_b16 v[70:71], v7 offset:8704
    s_waitcnt vmcnt(0) lgkmcnt(0)
    s_barrier
    v_mfma_f32_16x16x32_bf16 a[0:3], v[60:63], v[44:47], a[0:3]
    v_mfma_f32_16x16x32_bf16 a[4:7], v[60:63], v[48:51], a[4:7]
    v_mfma_f32_16x16x32_bf16 a[8:11], v[60:63], v[52:55], a[8:11]
    v_mfma_f32_16x16x32_bf16 a[12:15], v[60:63], v[56:59], a[12:15]
    v_mfma_f32_16x16x32_bf16 a[16:19], v[64:67], v[44:47], a[16:19]
    v_mfma_f32_16x16x32_bf16 a[20:23], v[64:67], v[48:51], a[20:23]
    v_mfma_f32_16x16x32_bf16 a[24:27], v[64:67], v[52:55], a[24:27]
    v_mfma_f32_16x16x32_bf16 a[28:31], v[64:67], v[56:59], a[28:31]
    v_mfma_f32_16x16x32_bf16 a[32:35], v[68:71], v[44:47], a[32:35]
    v_mfma_f32_16x16x32_bf16 a[36:39], v[68:71], v[48:51], a[36:39]
    v_mfma_f32_16x16x32_bf16 a[40:43], v[68:71], v[52:55], a[40:43]
    v_mfma_f32_16x16x32_bf16 a[44:47], v[68:71], v[56:59], a[44:47]
    v_and_b32 v10, 15, v1
    s_lshr_b32 s31, s30, 2
    s_lshl_b32 s31, s31, 6
    v_add_u32 v10, s31, v10
    v_mul_u32_u24 v10, 768, v10
    v_lshrrev_b32 v11, 4, v1
    v_lshl_add_u32 v10, v11, 4, v10
    s_and_b32 s31, s30, 3
    s_lshl_b32 s31, s31, 6
    v_add_u32 v10, s31, v10
    s_mul_i32 s50, s40, 3
    s_add_u32 s50, s50, s43
    s_mov_b32 s12, s38
    s_mov_b32 s13, s39
    s_mov_b32 s14, 23592960
    s_mov_b32 s15, 0x00020000
    s_add_u32 s12, s12, 50331648
    s_addc_u32 s13, s13, 0
    s_mul_i32 s51, s50, 5
    s_mul_i32 s52, s51, 98304
    s_mul_i32 s53, s42, 98304
    s_add_u32 s53, s53, s52
    s_nop 7
    s_add_u32 s54, s53, 0
    buffer_store_dwordx4 a[0:3], v10, s[12:15], s54 offen offset:0
    buffer_store_dwordx4 a[16:19], v10, s[12:15], s54 offen offset:256
    buffer_store_dwordx4 a[32:35], v10, s[12:15], s54 offen offset:512
    s_add_u32 s54, s53, 12288
    buffer_store_dwordx4 a[4:7], v10, s[12:15], s54 offen offset:0
    buffer_store_dwordx4 a[20:23], v10, s[12:15], s54 offen offset:256
    buffer_store_dwordx4 a[36:39], v10, s[12:15], s54 offen offset:512
    s_add_u32 s54, s53, 24576
    buffer_store_dwordx4 a[8:11], v10, s[12:15], s54 offen offset:0
    buffer_store_dwordx4 a[24:27], v10, s[12:15], s54 offen offset:256
    buffer_store_dwordx4 a[40:43], v10, s[12:15], s54 offen offset:512
    s_add_u32 s54, s53, 36864
    buffer_store_dwordx4 a[12:15], v10, s[12:15], s54 offen offset:0
    buffer_store_dwordx4 a[28:31], v10, s[12:15], s54 offen offset:256
    buffer_store_dwordx4 a[44:47], v10, s[12:15], s54 offen offset:512
L_g2_fin:
    s_waitcnt vmcnt(0)
L_g2_end:
    s_endpgm
.globl combine_kernel
.p2align 8
.type combine_kernel,@function
combine_kernel:
    s_load_dwordx2 s[4:5], s[0:1], 0
    s_load_dwordx2 s[6:7], s[0:1], 56
    s_load_dwordx2 s[8:9], s[0:1], 72
    s_cmp_ge_u32 s2, 256
    s_cbranch_scc1 L_cb_end
    v_mul_u32_u24 v2, 171, v0
    v_lshrrev_b32 v2, 13, v2
    v_mul_u32_u24 v3, 48, v2
    v_sub_u32 v3, v0, v3
    s_lshl_b32 s3, s2, 3
    v_add_u32 v2, s3, v2
    s_waitcnt lgkmcnt(0)
    s_mov_b32 s12, s4
    s_mov_b32 s13, s5
    s_mov_b32 s14, 2359296
    s_mov_b32 s15, 0x00020000
    s_mov_b32 s16, s6
    s_mov_b32 s17, s7
    s_mov_b32 s18, 2359296
    s_mov_b32 s19, 0x00020000
    s_mov_b32 s20, s8
    s_mov_b32 s21, s9
    s_mov_b32 s22, 23592960
    s_mov_b32 s23, 0x00020000
    s_add_u32 s20, s20, 50331648
    s_addc_u32 s21, s21, 0
    v_mul_u32_u24 v4, 1152, v2
    v_lshl_add_u32 v4, v3, 3, v4
    v_lshrrev_b32 v5, 7, v2
    s_mov_b32 s3, 1474560
    v_mul_lo_u32 v5, v5, s3
    v_and_b32 v6, 127, v2
    v_mul_u32_u24 v6, 768, v6
    v_add_u32 v5, v5, v6
    v_lshl_add_u32 v5, v3, 4, v5
    s_mov_b32 s3, 0
    buffer_load_dwordx4 v[8:11], v5, s[20:23], s3 offen
    s_mov_b32 s3, 98304
    buffer_load_dwordx4 v[12:15], v5, s[20:23], s3 offen
    s_mov_b32 s3, 196608
    buffer_load_dwordx4 v[16:19], v5, s[20:23], s3 offen
    s_mov_b32 s3, 294912
    buffer_load_dwordx4 v[20:23], v5, s[20:23], s3 offen
    s_mov_b32 s3, 393216
    buffer_load_dwordx4 v[24:27], v5, s[20:23], s3 offen
    buffer_load_dwordx2 v[68:69], v4, s[12:15], 0 offen offset:0
    s_mov_b32 s3, 491520
    buffer_load_dwordx4 v[28:31], v5, s[20:23], s3 offen
    s_mov_b32 s3, 589824
    buffer_load_dwordx4 v[32:35], v5, s[20:23], s3 offen
    s_mov_b32 s3, 688128
    buffer_load_dwordx4 v[36:39], v5, s[20:23], s3 offen
    s_mov_b32 s3, 786432
    buffer_load_dwordx4 v[40:43], v5, s[20:23], s3 offen
    s_mov_b32 s3, 884736
    buffer_load_dwordx4 v[44:47], v5, s[20:23], s3 offen
    buffer_load_dwordx2 v[70:71], v4, s[12:15], 0 offen offset:384
    s_mov_b32 s3, 983040
    buffer_load_dwordx4 v[48:51], v5, s[20:23], s3 offen
    s_mov_b32 s3, 1081344
    buffer_load_dwordx4 v[52:55], v5, s[20:23], s3 offen
    s_mov_b32 s3, 1179648
    buffer_load_dwordx4 v[56:59], v5, s[20:23], s3 offen
    s_mov_b32 s3, 1277952
    buffer_load_dwordx4 v[60:63], v5, s[20:23], s3 offen
    s_mov_b32 s3, 1376256
    buffer_load_dwordx4 v[64:67], v5, s[20:23], s3 offen
    buffer_load_dwordx2 v[72:73], v4, s[12:15], 0 offen offset:768
    s_waitcnt vmcnt(12)
    v_add_f32 v8, v8, v12
    v_add_f32 v9, v9, v13
    v_add_f32 v10, v10, v14
    v_add_f32 v11, v11, v15
    v_add_f32 v8, v8, v16
    v_add_f32 v9, v9, v17
    v_add_f32 v10, v10, v18
    v_add_f32 v11, v11, v19
    v_add_f32 v8, v8, v20
    v_add_f32 v9, v9, v21
    v_add_f32 v10, v10, v22
    v_add_f32 v11, v11, v23
    v_add_f32 v8, v8, v24
    v_add_f32 v9, v9, v25
    v_add_f32 v10, v10, v26
    v_add_f32 v11, v11, v27
    v_lshlrev_b32 v76, 16, v68
    v_and_b32 v77, 0xffff0000, v68
    v_lshlrev_b32 v78, 16, v69
    v_and_b32 v79, 0xffff0000, v69
    v_add_f32 v8, v8, v76
    v_add_f32 v9, v9, v77
    v_add_f32 v10, v10, v78
    v_add_f32 v11, v11, v79
    v_cvt_pk_bf16_f32 v76, v8, v9
    v_cvt_pk_bf16_f32 v77, v10, v11
    buffer_store_dwordx2 v[76:77], v4, s[16:19], 0 offen offset:0
    s_waitcnt vmcnt(7)
    v_add_f32 v28, v28, v32
    v_add_f32 v29, v29, v33
    v_add_f32 v30, v30, v34
    v_add_f32 v31, v31, v35
    v_add_f32 v28, v28, v36
    v_add_f32 v29, v29, v37
    v_add_f32 v30, v30, v38
    v_add_f32 v31, v31, v39
    v_add_f32 v28, v28, v40
    v_add_f32 v29, v29, v41
    v_add_f32 v30, v30, v42
    v_add_f32 v31, v31, v43
    v_add_f32 v28, v28, v44
    v_add_f32 v29, v29, v45
    v_add_f32 v30, v30, v46
    v_add_f32 v31, v31, v47
    v_lshlrev_b32 v76, 16, v70
    v_and_b32 v77, 0xffff0000, v70
    v_lshlrev_b32 v78, 16, v71
    v_and_b32 v79, 0xffff0000, v71
    v_add_f32 v28, v28, v76
    v_add_f32 v29, v29, v77
    v_add_f32 v30, v30, v78
    v_add_f32 v31, v31, v79
    v_cvt_pk_bf16_f32 v76, v28, v29
    v_cvt_pk_bf16_f32 v77, v30, v31
    buffer_store_dwordx2 v[76:77], v4, s[16:19], 0 offen offset:384
    s_waitcnt vmcnt(2)
    v_add_f32 v48, v48, v52
    v_add_f32 v49, v49, v53
    v_add_f32 v50, v50, v54
    v_add_f32 v51, v51, v55
    v_add_f32 v48, v48, v56
    v_add_f32 v49, v49, v57
    v_add_f32 v50, v50, v58
    v_add_f32 v51, v51, v59
    v_add_f32 v48, v48, v60
    v_add_f32 v49, v49, v61
    v_add_f32 v50, v50, v62
    v_add_f32 v51, v51, v63
    v_add_f32 v48, v48, v64
    v_add_f32 v49, v49, v65
    v_add_f32 v50, v50, v66
    v_add_f32 v51, v51, v67
    v_lshlrev_b32 v76, 16, v72
    v_and_b32 v77, 0xffff0000, v72
    v_lshlrev_b32 v78, 16, v73
    v_and_b32 v79, 0xffff0000, v73
    v_add_f32 v48, v48, v76
    v_add_f32 v49, v49, v77
    v_add_f32 v50, v50, v78
    v_add_f32 v51, v51, v79
    v_cvt_pk_bf16_f32 v76, v48, v49
    v_cvt_pk_bf16_f32 v77, v50, v51
    buffer_store_dwordx2 v[76:77], v4, s[16:19], 0 offen offset:768
L_cb_end:
    s_endpgm
.section .rodata,"a"
.p2align 6
.amdhsa_kernel ln_kernel
  .amdhsa_next_free_vgpr 32
  .amdhsa_next_free_sgpr 96
  .amdhsa_accum_offset 32
  .amdhsa_group_segment_fixed_size 0
  .amdhsa_kernarg_size 80
  .amdhsa_user_sgpr_count 2
  .amdhsa_user_sgpr_kernarg_segment_ptr 1
  .amdhsa_system_sgpr_workgroup_id_x 1
.end_amdhsa_kernel
.amdhsa_kernel gemm1_kernel
  .amdhsa_next_free_vgpr 216
  .amdhsa_next_free_sgpr 96
  .amdhsa_accum_offset 104
  .amdhsa_group_segment_fixed_size 0
  .amdhsa_kernarg_size 80
  .amdhsa_user_sgpr_count 2
  .amdhsa_user_sgpr_kernarg_segment_ptr 1
  .amdhsa_system_sgpr_workgroup_id_x 1
.end_amdhsa_kernel
.amdhsa_kernel attn_kv_kernel
  .amdhsa_next_free_vgpr 140
  .amdhsa_next_free_sgpr 96
  .amdhsa_accum_offset 140
  .amdhsa_group_segment_fixed_size 0
  .amdhsa_kernarg_size 80
  .amdhsa_user_sgpr_count 2
  .amdhsa_user_sgpr_kernarg_segment_ptr 1
  .amdhsa_system_sgpr_workgroup_id_x 1
.end_amdhsa_kernel
.amdhsa_kernel attn_o_kernel
  .amdhsa_next_free_vgpr 192
  .amdhsa_next_free_sgpr 96
  .amdhsa_accum_offset 192
  .amdhsa_group_segment_fixed_size 0
  .amdhsa_kernarg_size 80
  .amdhsa_user_sgpr_count 2
  .amdhsa_user_sgpr_kernarg_segment_ptr 1
  .amdhsa_system_sgpr_workgroup_id_x 1
.end_amdhsa_kernel
.amdhsa_kernel gemm2_kernel
  .amdhsa_next_free_vgpr 236
  .amdhsa_next_free_sgpr 96
  .amdhsa_accum_offset 188
  .amdhsa_group_segment_fixed_size 0
  .amdhsa_kernarg_size 80
  .amdhsa_user_sgpr_count 2
  .amdhsa_user_sgpr_kernarg_segment_ptr 1
  .amdhsa_system_sgpr_workgroup_id_x 1
.end_amdhsa_kernel
.amdhsa_kernel combine_kernel
  .amdhsa_next_free_vgpr 80
  .amdhsa_next_free_sgpr 96
  .amdhsa_accum_offset 80
  .amdhsa_group_segment_fixed_size 0
  .amdhsa_kernarg_size 80
  .amdhsa_user_sgpr_count 2
  .amdhsa_user_sgpr_kernarg_segment_ptr 1
  .amdhsa_system_sgpr_workgroup_id_x 1
.end_amdhsa_kernel
```
